```python
import torch

def _softmax(x, axis=-1):
    return torch.softmax(x, dim=axis)

def _gelu(x):
    return torch.nn.functional.gelu(x, approximate='tanh')

def _silu(x):
    return torch.nn.functional.silu(x)

def _sigmoid(x):
    return torch.sigmoid(x)

def _layernorm(x, axis=-1, eps=1e-05):
    m = x.mean(dim=axis, keepdim=True)
    v = x.var(dim=axis, keepdim=True, unbiased=False)
    return (x - m) / torch.sqrt(v + eps)

def _scatter_add(tgt, idx, src, axis=0):
    return tgt.clone().index_add_(axis, idx, src)

def _segment_sum(src, seg, n):
    out = torch.zeros((n,) + src.shape[1:], dtype=src.dtype)
    return out.index_add_(0, seg, src)

def _pad(x, pw):
    flat = tuple((v for pair in reversed(pw) for v in pair))
    return torch.nn.functional.pad(x, flat)
kernel_name = 'sequential_preLN__memory_aug_recurrent_mem_tr__glu_gated_geglu__prompt'

def setup_inputs():

    _w = lambda a: (lambda t: t.to(torch.bfloat16) if t.is_floating_point() else t)(torch.as_tensor(a))

    def _A_setup():
        B, S, Dm = (1, 2048, 512)
        H, Dh = (32, 128)
        M, seg = (8, 32)
        seg = min(seg, S)
        S = S // seg * seg
        return {'x': _w((lambda *s: torch.randn(*s, dtype=torch.bfloat16) * 0.05)(B, S, Dm)), 'mem0': _w((lambda *s: torch.randn(*s, dtype=torch.bfloat16) * 0.2)(B, M, Dm)), 'Wq': _w((lambda *s: torch.randn(*s, dtype=torch.bfloat16) * 1.6)(Dm, H, Dh) * Dm ** (-0.5)), 'Wk': _w((lambda *s: torch.randn(*s, dtype=torch.bfloat16) * 1.6)(Dm, H, Dh) * Dm ** (-0.5)), 'Wv': _w((lambda *s: torch.randn(*s, dtype=torch.bfloat16) * 0.2)(Dm, H, Dh) * Dm ** (-0.5)), 'Wo': _w((lambda *s: torch.randn(*s, dtype=torch.bfloat16) * 0.2)(H, Dh, Dm) * (H * Dh) ** (-0.5)), 'seg_len': seg}
    _A_in = _A_setup()

    def _B_setup():
        B, S, Dm, Df = (1, 2048, 512, 1376)
        return {'x': _w((lambda *s: torch.randn(*s, dtype=torch.bfloat16) * 0.05)(B, S, Dm)), 'w_gate': _w((lambda *s: torch.randn(*s, dtype=torch.bfloat16) * 0.4)(Dm, Df) * Dm ** (-0.5)), 'w_up': _w((lambda *s: torch.randn(*s, dtype=torch.bfloat16) * 0.4)(Dm, Df) * Dm ** (-0.5)), 'w_down': _w((lambda *s: torch.randn(*s, dtype=torch.bfloat16) * 0.4)(Df, Dm) * Df ** (-0.5))}
    _B_in = _B_setup()
    return {'A_x': _A_in['x'], 'A_mem0': _A_in['mem0'], 'A_Wq': _A_in['Wq'], 'A_Wk': _A_in['Wk'], 'A_Wv': _A_in['Wv'], 'A_Wo': _A_in['Wo'], 'A_seg_len': _A_in['seg_len'], 'B_x': _B_in['x'], 'B_w_gate': _B_in['w_gate'], 'B_w_up': _B_in['w_up'], 'B_w_down': _B_in['w_down']}

def reference(A_x, A_mem0, A_Wq, A_Wk, A_Wv, A_Wo, A_seg_len, B_x, B_w_gate, B_w_up, B_w_down):

    def _A_ref(x, mem0, Wq, Wk, Wv, Wo, seg_len):
        B, S, Dm = x.shape
        H, Dh = (Wq.shape[1], Wq.shape[2])
        M = mem0.shape[1]
        scale = Dh ** (-0.5)
        n_seg = S // seg_len
        L = M + seg_len
        idx = torch.arange(L)
        mask = (idx[:, None] < M) | (idx[:, None] >= idx[None, :])
        mem = mem0
        outs = []
        for s in range(n_seg):
            xs = x[:, s * seg_len:(s + 1) * seg_len, :].clone()
            h = torch.concatenate([mem, xs], axis=1)
            q = torch.einsum('btd,dhe->bhte', h, Wq)
            k = torch.einsum('btd,dhe->bhte', h, Wk)
            v = torch.einsum('btd,dhe->bhte', h, Wv)
            scores = torch.einsum('bhqe,bhke->bhqk', q, k) * scale
            scores = torch.where(mask[None, None], scores, -1000000000.0)
            p = _softmax(scores, axis=-1)
            o = torch.einsum('bhqk,bhke->bhqe', p, v)
            o = torch.einsum('bhte,hed->btd', o, Wo)
            mem = o[:, :M, :].clone()
            outs.append(o[:, M:, :])
        return torch.concatenate(outs, axis=1)

    def _B_ref(x, w_gate, w_up, w_down):
        g = torch.einsum('bsd,df->bsf', x, w_gate)
        u = torch.einsum('bsd,df->bsf', x, w_up)
        h = _gelu(g) * u
        return torch.einsum('bsf,fd->bsd', h, w_down)
    x = A_x
    h = x + _A_ref(_layernorm(x, axis=-1), A_mem0, A_Wq, A_Wk, A_Wv, A_Wo, A_seg_len)
    h2 = h + _B_ref(_layernorm(h, axis=-1), B_w_gate, B_w_up, B_w_down)
    return h2
```

```asm
; @launch kernel=fused_kernel grid=(256,1,1) block=(256,1,1) lds=163840
.amdgcn_target "amdgcn-amd-amdhsa--gfx950"
.text
.globl fused_kernel
.p2align 8
.type fused_kernel,@function
fused_kernel:
    s_cmp_ge_u32 s2, 256
    s_cbranch_scc1 L_fused_done_1
    v_lshrrev_b32 v1, 6, v0
    s_nop 0
    v_readfirstlane_b32 s20, v1
    s_load_dwordx2 s[8:9], s[0:1], 104
    s_waitcnt lgkmcnt(0)
    s_and_b32 s9, s9, 0xffff
    s_mov_b32 s10, 268435456
    s_mov_b32 s11, 0x00020000
    s_load_dwordx2 s[12:13], s[0:1], 96
    s_waitcnt lgkmcnt(0)
    s_and_b32 s13, s13, 0xffff
    s_mov_b32 s14, 256
    s_mov_b32 s15, 0x00020000
    s_load_dwordx2 s[16:17], s[0:1], 8
    s_waitcnt lgkmcnt(0)
    s_and_b32 s17, s17, 0xffff
    s_mov_b32 s18, 8192
    s_mov_b32 s19, 0x00020000
    s_getreg_b32 s21, hwreg(HW_REG_XCC_ID)
    s_and_b32 s21, s21, 15
    s_cmp_lg_u32 s20, 0
    s_cbranch_scc1 L_role_bar_2
    v_mov_b32 v6, 1
    v_mov_b32 v7, 0
    v_mov_b32 v8, 4
    s_mov_b64 s[22:23], exec
    s_mov_b64 exec, 1
    s_cmp_lg_u32 s21, 0
    s_cbranch_scc1 L_notx0_3
    buffer_atomic_add v6, v7, s[12:15], 0 offen sc0
    s_waitcnt vmcnt(0)
    v_readfirstlane_b32 s24, v6
    s_cmp_lt_u32 s24, 32
    s_cbranch_scc1 L_gotrole_4
    v_mov_b32 v6, 1
    buffer_atomic_add v6, v8, s[12:15], 0 offen sc0
    s_waitcnt vmcnt(0)
    v_readfirstlane_b32 s24, v6
    s_add_u32 s24, s24, 32
    s_branch L_gotrole_4
L_notx0_3:
    buffer_atomic_add v6, v8, s[12:15], 0 offen sc0
    s_waitcnt vmcnt(0)
    v_readfirstlane_b32 s24, v6
    s_cmp_ge_u32 s24, 224
    s_cbranch_scc1 L_takeA_5
    s_add_u32 s24, s24, 32
    s_branch L_gotrole_4
L_takeA_5:
    v_mov_b32 v6, 1
    buffer_atomic_add v6, v7, s[12:15], 0 offen sc0
    s_waitcnt vmcnt(0)
    v_readfirstlane_b32 s24, v6
L_gotrole_4:
    v_mov_b32 v6, s24
    v_mov_b32 v7, 26624
    ds_write_b32 v7, v6
    s_waitcnt lgkmcnt(0)
    s_mov_b64 exec, s[22:23]
L_role_bar_2:
    s_barrier
    v_mov_b32 v7, 26624
    ds_read_b32 v6, v7
    s_waitcnt lgkmcnt(0)
    v_readfirstlane_b32 s24, v6
    s_barrier
    s_cmp_ge_u32 s24, 32
    s_cbranch_scc1 L_worker_6
    s_cmp_lg_u32 s20, 0
    s_cbranch_scc1 L_nopub_7
    s_cmp_eq_u32 s21, 0
    s_cselect_b32 s25, 1, 2
    v_mov_b32 v6, s25
    s_lshl_b32 s25, s24, 2
    s_add_u32 s25, s25, 64
    v_mov_b32 v7, s25
    s_mov_b64 s[22:23], exec
    s_mov_b64 exec, 1
    buffer_store_dword v6, v7, s[12:15], 0 offen sc1
    s_mov_b64 exec, s[22:23]
L_nopub_7:
    v_and_b32 v1, 63, v0
    v_and_b32 v2, 15, v1
    v_lshrrev_b32 v3, 4, v1
    v_lshlrev_b32 v4, 4, v1
    s_lshl_b32 s56, s20, 13
    v_add_u32 v5, s56, v4
    v_lshrrev_b32 v6, 2, v1
    v_lshlrev_b32 v6, 13, v6
    v_and_b32 v7, 3, v1
    v_lshl_add_u32 v6, v7, 4, v6
    v_lshlrev_b32 v122, 10, v3
    v_lshl_add_u32 v122, v2, 4, v122
    v_lshrrev_b32 v123, 2, v2
    v_lshl_add_u32 v124, v3, 3, v123
    v_lshlrev_b32 v124, 6, v124
    v_lshl_add_u32 v124, v7, 3, v124
    v_add_u32 v124, s56, v124
    v_lshl_add_u32 v125, v3, 2, v123
    v_lshlrev_b32 v125, 8, v125
    v_lshl_add_u32 v125, v7, 3, v125
    v_add_u32 v125, s56, v125
    s_lshl_b32 s25, s20, 15
    s_add_u32 s25, s25, 32768
    v_add_u32 v126, s25, v4
    s_load_dwordx2 s[64:65], s[0:1], 16
    s_waitcnt lgkmcnt(0)
    s_and_b32 s65, s65, 0xffff
    s_mov_b32 s66, 4194304
    s_mov_b32 s67, 0x00020000
    s_load_dwordx2 s[68:69], s[0:1], 24
    s_waitcnt lgkmcnt(0)
    s_and_b32 s69, s69, 0xffff
    s_mov_b32 s70, 4194304
    s_mov_b32 s71, 0x00020000
    s_load_dwordx2 s[72:73], s[0:1], 32
    s_waitcnt lgkmcnt(0)
    s_and_b32 s73, s73, 0xffff
    s_mov_b32 s74, 4194304
    s_mov_b32 s75, 0x00020000
    s_load_dwordx2 s[76:77], s[0:1], 40
    s_waitcnt lgkmcnt(0)
    s_and_b32 s77, s77, 0xffff
    s_mov_b32 s78, 4194304
    s_mov_b32 s79, 0x00020000
    s_lshl_b32 s57, s24, 8
    s_lshl_b32 s25, s20, 6
    s_add_u32 s57, s57, s25
    s_lshl_b32 s58, s24, 17
    s_lshl_b32 s25, s20, 8
    s_add_u32 s58, s58, s25
    s_add_u32 s25, s57, 0
    buffer_load_dwordx4 v[8:11], v6, s[64:67], s25 offen
    s_add_u32 s25, s57, 131072
    buffer_load_dwordx4 v[12:15], v6, s[64:67], s25 offen
    s_add_u32 s25, s57, 262144
    buffer_load_dwordx4 v[16:19], v6, s[64:67], s25 offen
    s_add_u32 s25, s57, 393216
    buffer_load_dwordx4 v[20:23], v6, s[64:67], s25 offen
    s_add_u32 s25, s57, 524288
    buffer_load_dwordx4 v[24:27], v6, s[64:67], s25 offen
    s_add_u32 s25, s57, 655360
    buffer_load_dwordx4 v[28:31], v6, s[64:67], s25 offen
    s_add_u32 s25, s57, 786432
    buffer_load_dwordx4 v[32:35], v6, s[64:67], s25 offen
    s_add_u32 s25, s57, 917504
    buffer_load_dwordx4 v[36:39], v6, s[64:67], s25 offen
    s_add_u32 s25, s57, 1048576
    buffer_load_dwordx4 v[40:43], v6, s[64:67], s25 offen
    s_add_u32 s25, s57, 1179648
    buffer_load_dwordx4 v[44:47], v6, s[64:67], s25 offen
    s_add_u32 s25, s57, 1310720
    buffer_load_dwordx4 v[48:51], v6, s[64:67], s25 offen
    s_add_u32 s25, s57, 1441792
    buffer_load_dwordx4 v[52:55], v6, s[64:67], s25 offen
    s_add_u32 s25, s57, 1572864
    buffer_load_dwordx4 v[56:59], v6, s[64:67], s25 offen
    s_add_u32 s25, s57, 1703936
    buffer_load_dwordx4 v[60:63], v6, s[64:67], s25 offen
    s_add_u32 s25, s57, 1835008
    buffer_load_dwordx4 v[64:67], v6, s[64:67], s25 offen
    s_add_u32 s25, s57, 1966080
    buffer_load_dwordx4 v[68:71], v6, s[64:67], s25 offen
    s_add_u32 s25, s57, 2097152
    buffer_load_dwordx4 v[72:75], v6, s[64:67], s25 offen
    s_add_u32 s25, s57, 2228224
    buffer_load_dwordx4 v[76:79], v6, s[64:67], s25 offen
    s_add_u32 s25, s57, 2359296
    buffer_load_dwordx4 v[80:83], v6, s[64:67], s25 offen
    s_add_u32 s25, s57, 2490368
    buffer_load_dwordx4 v[84:87], v6, s[64:67], s25 offen
    s_add_u32 s25, s57, 2621440
    buffer_load_dwordx4 v[88:91], v6, s[64:67], s25 offen
    s_add_u32 s25, s57, 2752512
    buffer_load_dwordx4 v[92:95], v6, s[64:67], s25 offen
    s_add_u32 s25, s57, 2883584
    buffer_load_dwordx4 v[96:99], v6, s[64:67], s25 offen
    s_add_u32 s25, s57, 3014656
    buffer_load_dwordx4 v[100:103], v6, s[64:67], s25 offen
    s_waitcnt vmcnt(16)
    ds_write_b128 v5, v[8:11] offset:0
    ds_write_b128 v5, v[12:15] offset:1024
    ds_write_b128 v5, v[16:19] offset:2048
    ds_write_b128 v5, v[20:23] offset:3072
    ds_write_b128 v5, v[24:27] offset:4096
    ds_write_b128 v5, v[28:31] offset:5120
    ds_write_b128 v5, v[32:35] offset:6144
    ds_write_b128 v5, v[36:39] offset:7168
    s_waitcnt lgkmcnt(0)
    ds_read_b64_tr_b16 a[0:1], v124 offset:0
    ds_read_b64_tr_b16 a[2:3], v124 offset:256
    ds_read_b64_tr_b16 a[64:65], v124 offset:32
    ds_read_b64_tr_b16 a[66:67], v124 offset:288
    ds_read_b64_tr_b16 a[4:5], v124 offset:2048
    ds_read_b64_tr_b16 a[6:7], v124 offset:2304
    ds_read_b64_tr_b16 a[68:69], v124 offset:2080
    ds_read_b64_tr_b16 a[70:71], v124 offset:2336
    ds_read_b64_tr_b16 a[8:9], v124 offset:4096
    ds_read_b64_tr_b16 a[10:11], v124 offset:4352
    ds_read_b64_tr_b16 a[72:73], v124 offset:4128
    ds_read_b64_tr_b16 a[74:75], v124 offset:4384
    ds_read_b64_tr_b16 a[12:13], v124 offset:6144
    ds_read_b64_tr_b16 a[14:15], v124 offset:6400
    ds_read_b64_tr_b16 a[76:77], v124 offset:6176
    ds_read_b64_tr_b16 a[78:79], v124 offset:6432
    s_waitcnt lgkmcnt(0)
    s_add_u32 s25, s57, 3145728
    buffer_load_dwordx4 v[8:11], v6, s[64:67], s25 offen
    s_add_u32 s25, s57, 3276800
    buffer_load_dwordx4 v[12:15], v6, s[64:67], s25 offen
    s_add_u32 s25, s57, 3407872
    buffer_load_dwordx4 v[16:19], v6, s[64:67], s25 offen
    s_add_u32 s25, s57, 3538944
    buffer_load_dwordx4 v[20:23], v6, s[64:67], s25 offen
    s_add_u32 s25, s57, 3670016
    buffer_load_dwordx4 v[24:27], v6, s[64:67], s25 offen
    s_add_u32 s25, s57, 3801088
    buffer_load_dwordx4 v[28:31], v6, s[64:67], s25 offen
    s_add_u32 s25, s57, 3932160
    buffer_load_dwordx4 v[32:35], v6, s[64:67], s25 offen
    s_add_u32 s25, s57, 4063232
    buffer_load_dwordx4 v[36:39], v6, s[64:67], s25 offen
    s_waitcnt vmcnt(16)
    ds_write_b128 v5, v[40:43] offset:0
    ds_write_b128 v5, v[44:47] offset:1024
    ds_write_b128 v5, v[48:51] offset:2048
    ds_write_b128 v5, v[52:55] offset:3072
    ds_write_b128 v5, v[56:59] offset:4096
    ds_write_b128 v5, v[60:63] offset:5120
    ds_write_b128 v5, v[64:67] offset:6144
    ds_write_b128 v5, v[68:71] offset:7168
    s_waitcnt lgkmcnt(0)
    ds_read_b64_tr_b16 a[16:17], v124 offset:0
    ds_read_b64_tr_b16 a[18:19], v124 offset:256
    ds_read_b64_tr_b16 a[80:81], v124 offset:32
    ds_read_b64_tr_b16 a[82:83], v124 offset:288
    ds_read_b64_tr_b16 a[20:21], v124 offset:2048
    ds_read_b64_tr_b16 a[22:23], v124 offset:2304
    ds_read_b64_tr_b16 a[84:85], v124 offset:2080
    ds_read_b64_tr_b16 a[86:87], v124 offset:2336
    ds_read_b64_tr_b16 a[24:25], v124 offset:4096
    ds_read_b64_tr_b16 a[26:27], v124 offset:4352
    ds_read_b64_tr_b16 a[88:89], v124 offset:4128
    ds_read_b64_tr_b16 a[90:91], v124 offset:4384
    ds_read_b64_tr_b16 a[28:29], v124 offset:6144
    ds_read_b64_tr_b16 a[30:31], v124 offset:6400
    ds_read_b64_tr_b16 a[92:93], v124 offset:6176
    ds_read_b64_tr_b16 a[94:95], v124 offset:6432
    s_waitcnt lgkmcnt(0)
    s_add_u32 s25, s57, 0
    buffer_load_dwordx4 v[40:43], v6, s[68:71], s25 offen
    s_add_u32 s25, s57, 131072
    buffer_load_dwordx4 v[44:47], v6, s[68:71], s25 offen
    s_add_u32 s25, s57, 262144
    buffer_load_dwordx4 v[48:51], v6, s[68:71], s25 offen
    s_add_u32 s25, s57, 393216
    buffer_load_dwordx4 v[52:55], v6, s[68:71], s25 offen
    s_add_u32 s25, s57, 524288
    buffer_load_dwordx4 v[56:59], v6, s[68:71], s25 offen
    s_add_u32 s25, s57, 655360
    buffer_load_dwordx4 v[60:63], v6, s[68:71], s25 offen
    s_add_u32 s25, s57, 786432
    buffer_load_dwordx4 v[64:67], v6, s[68:71], s25 offen
    s_add_u32 s25, s57, 917504
    buffer_load_dwordx4 v[68:71], v6, s[68:71], s25 offen
    s_waitcnt vmcnt(16)
    ds_write_b128 v5, v[72:75] offset:0
    ds_write_b128 v5, v[76:79] offset:1024
    ds_write_b128 v5, v[80:83] offset:2048
    ds_write_b128 v5, v[84:87] offset:3072
    ds_write_b128 v5, v[88:91] offset:4096
    ds_write_b128 v5, v[92:95] offset:5120
    ds_write_b128 v5, v[96:99] offset:6144
    ds_write_b128 v5, v[100:103] offset:7168
    s_waitcnt lgkmcnt(0)
    ds_read_b64_tr_b16 a[32:33], v124 offset:0
    ds_read_b64_tr_b16 a[34:35], v124 offset:256
    ds_read_b64_tr_b16 a[96:97], v124 offset:32
    ds_read_b64_tr_b16 a[98:99], v124 offset:288
    ds_read_b64_tr_b16 a[36:37], v124 offset:2048
    ds_read_b64_tr_b16 a[38:39], v124 offset:2304
    ds_read_b64_tr_b16 a[100:101], v124 offset:2080
    ds_read_b64_tr_b16 a[102:103], v124 offset:2336
    ds_read_b64_tr_b16 a[40:41], v124 offset:4096
    ds_read_b64_tr_b16 a[42:43], v124 offset:4352
    ds_read_b64_tr_b16 a[104:105], v124 offset:4128
    ds_read_b64_tr_b16 a[106:107], v124 offset:4384
    ds_read_b64_tr_b16 a[44:45], v124 offset:6144
    ds_read_b64_tr_b16 a[46:47], v124 offset:6400
    ds_read_b64_tr_b16 a[108:109], v124 offset:6176
    ds_read_b64_tr_b16 a[110:111], v124 offset:6432
    s_waitcnt lgkmcnt(0)
    s_add_u32 s25, s57, 1048576
    buffer_load_dwordx4 v[72:75], v6, s[68:71], s25 offen
    s_add_u32 s25, s57, 1179648
    buffer_load_dwordx4 v[76:79], v6, s[68:71], s25 offen
    s_add_u32 s25, s57, 1310720
    buffer_load_dwordx4 v[80:83], v6, s[68:71], s25 offen
    s_add_u32 s25, s57, 1441792
    buffer_load_dwordx4 v[84:87], v6, s[68:71], s25 offen
    s_add_u32 s25, s57, 1572864
    buffer_load_dwordx4 v[88:91], v6, s[68:71], s25 offen
    s_add_u32 s25, s57, 1703936
    buffer_load_dwordx4 v[92:95], v6, s[68:71], s25 offen
    s_add_u32 s25, s57, 1835008
    buffer_load_dwordx4 v[96:99], v6, s[68:71], s25 offen
    s_add_u32 s25, s57, 1966080
    buffer_load_dwordx4 v[100:103], v6, s[68:71], s25 offen
    s_waitcnt vmcnt(16)
    ds_write_b128 v5, v[8:11] offset:0
    ds_write_b128 v5, v[12:15] offset:1024
    ds_write_b128 v5, v[16:19] offset:2048
    ds_write_b128 v5, v[20:23] offset:3072
    ds_write_b128 v5, v[24:27] offset:4096
    ds_write_b128 v5, v[28:31] offset:5120
    ds_write_b128 v5, v[32:35] offset:6144
    ds_write_b128 v5, v[36:39] offset:7168
    s_waitcnt lgkmcnt(0)
    ds_read_b64_tr_b16 a[48:49], v124 offset:0
    ds_read_b64_tr_b16 a[50:51], v124 offset:256
    ds_read_b64_tr_b16 a[112:113], v124 offset:32
    ds_read_b64_tr_b16 a[114:115], v124 offset:288
    ds_read_b64_tr_b16 a[52:53], v124 offset:2048
    ds_read_b64_tr_b16 a[54:55], v124 offset:2304
    ds_read_b64_tr_b16 a[116:117], v124 offset:2080
    ds_read_b64_tr_b16 a[118:119], v124 offset:2336
    ds_read_b64_tr_b16 a[56:57], v124 offset:4096
    ds_read_b64_tr_b16 a[58:59], v124 offset:4352
    ds_read_b64_tr_b16 a[120:121], v124 offset:4128
    ds_read_b64_tr_b16 a[122:123], v124 offset:4384
    ds_read_b64_tr_b16 a[60:61], v124 offset:6144
    ds_read_b64_tr_b16 a[62:63], v124 offset:6400
    ds_read_b64_tr_b16 a[124:125], v124 offset:6176
    ds_read_b64_tr_b16 a[126:127], v124 offset:6432
    s_waitcnt lgkmcnt(0)
    s_add_u32 s25, s57, 2097152
    buffer_load_dwordx4 v[8:11], v6, s[68:71], s25 offen
    s_add_u32 s25, s57, 2228224
    buffer_load_dwordx4 v[12:15], v6, s[68:71], s25 offen
    s_add_u32 s25, s57, 2359296
    buffer_load_dwordx4 v[16:19], v6, s[68:71], s25 offen
    s_add_u32 s25, s57, 2490368
    buffer_load_dwordx4 v[20:23], v6, s[68:71], s25 offen
    s_add_u32 s25, s57, 2621440
    buffer_load_dwordx4 v[24:27], v6, s[68:71], s25 offen
    s_add_u32 s25, s57, 2752512
    buffer_load_dwordx4 v[28:31], v6, s[68:71], s25 offen
    s_add_u32 s25, s57, 2883584
    buffer_load_dwordx4 v[32:35], v6, s[68:71], s25 offen
    s_add_u32 s25, s57, 3014656
    buffer_load_dwordx4 v[36:39], v6, s[68:71], s25 offen
    s_waitcnt vmcnt(16)
    ds_write_b128 v5, v[40:43] offset:0
    ds_write_b128 v5, v[44:47] offset:1024
    ds_write_b128 v5, v[48:51] offset:2048
    ds_write_b128 v5, v[52:55] offset:3072
    ds_write_b128 v5, v[56:59] offset:4096
    ds_write_b128 v5, v[60:63] offset:5120
    ds_write_b128 v5, v[64:67] offset:6144
    ds_write_b128 v5, v[68:71] offset:7168
    s_waitcnt lgkmcnt(0)
    ds_read_b64_tr_b16 a[128:129], v124 offset:0
    ds_read_b64_tr_b16 a[130:131], v124 offset:256
    ds_read_b64_tr_b16 a[192:193], v124 offset:32
    ds_read_b64_tr_b16 a[194:195], v124 offset:288
    ds_read_b64_tr_b16 a[132:133], v124 offset:2048
    ds_read_b64_tr_b16 a[134:135], v124 offset:2304
    ds_read_b64_tr_b16 a[196:197], v124 offset:2080
    ds_read_b64_tr_b16 a[198:199], v124 offset:2336
    ds_read_b64_tr_b16 a[136:137], v124 offset:4096
    ds_read_b64_tr_b16 a[138:139], v124 offset:4352
    ds_read_b64_tr_b16 a[200:201], v124 offset:4128
    ds_read_b64_tr_b16 a[202:203], v124 offset:4384
    ds_read_b64_tr_b16 a[140:141], v124 offset:6144
    ds_read_b64_tr_b16 a[142:143], v124 offset:6400
    ds_read_b64_tr_b16 a[204:205], v124 offset:6176
    ds_read_b64_tr_b16 a[206:207], v124 offset:6432
    s_waitcnt lgkmcnt(0)
    s_add_u32 s25, s57, 3145728
    buffer_load_dwordx4 v[40:43], v6, s[68:71], s25 offen
    s_add_u32 s25, s57, 3276800
    buffer_load_dwordx4 v[44:47], v6, s[68:71], s25 offen
    s_add_u32 s25, s57, 3407872
    buffer_load_dwordx4 v[48:51], v6, s[68:71], s25 offen
    s_add_u32 s25, s57, 3538944
    buffer_load_dwordx4 v[52:55], v6, s[68:71], s25 offen
    s_add_u32 s25, s57, 3670016
    buffer_load_dwordx4 v[56:59], v6, s[68:71], s25 offen
    s_add_u32 s25, s57, 3801088
    buffer_load_dwordx4 v[60:63], v6, s[68:71], s25 offen
    s_add_u32 s25, s57, 3932160
    buffer_load_dwordx4 v[64:67], v6, s[68:71], s25 offen
    s_add_u32 s25, s57, 4063232
    buffer_load_dwordx4 v[68:71], v6, s[68:71], s25 offen
    s_waitcnt vmcnt(16)
    ds_write_b128 v5, v[72:75] offset:0
    ds_write_b128 v5, v[76:79] offset:1024
    ds_write_b128 v5, v[80:83] offset:2048
    ds_write_b128 v5, v[84:87] offset:3072
    ds_write_b128 v5, v[88:91] offset:4096
    ds_write_b128 v5, v[92:95] offset:5120
    ds_write_b128 v5, v[96:99] offset:6144
    ds_write_b128 v5, v[100:103] offset:7168
    s_waitcnt lgkmcnt(0)
    ds_read_b64_tr_b16 a[144:145], v124 offset:0
    ds_read_b64_tr_b16 a[146:147], v124 offset:256
    ds_read_b64_tr_b16 a[208:209], v124 offset:32
    ds_read_b64_tr_b16 a[210:211], v124 offset:288
    ds_read_b64_tr_b16 a[148:149], v124 offset:2048
    ds_read_b64_tr_b16 a[150:151], v124 offset:2304
    ds_read_b64_tr_b16 a[212:213], v124 offset:2080
    ds_read_b64_tr_b16 a[214:215], v124 offset:2336
    ds_read_b64_tr_b16 a[152:153], v124 offset:4096
    ds_read_b64_tr_b16 a[154:155], v124 offset:4352
    ds_read_b64_tr_b16 a[216:217], v124 offset:4128
    ds_read_b64_tr_b16 a[218:219], v124 offset:4384
    ds_read_b64_tr_b16 a[156:157], v124 offset:6144
    ds_read_b64_tr_b16 a[158:159], v124 offset:6400
    ds_read_b64_tr_b16 a[220:221], v124 offset:6176
    ds_read_b64_tr_b16 a[222:223], v124 offset:6432
    s_waitcnt lgkmcnt(0)
    s_add_u32 s25, s57, 0
    buffer_load_dwordx4 v[72:75], v6, s[72:75], s25 offen
    s_add_u32 s25, s57, 131072
    buffer_load_dwordx4 v[76:79], v6, s[72:75], s25 offen
    s_add_u32 s25, s57, 262144
    buffer_load_dwordx4 v[80:83], v6, s[72:75], s25 offen
    s_add_u32 s25, s57, 393216
    buffer_load_dwordx4 v[84:87], v6, s[72:75], s25 offen
    s_add_u32 s25, s57, 524288
    buffer_load_dwordx4 v[88:91], v6, s[72:75], s25 offen
    s_add_u32 s25, s57, 655360
    buffer_load_dwordx4 v[92:95], v6, s[72:75], s25 offen
    s_add_u32 s25, s57, 786432
    buffer_load_dwordx4 v[96:99], v6, s[72:75], s25 offen
    s_add_u32 s25, s57, 917504
    buffer_load_dwordx4 v[100:103], v6, s[72:75], s25 offen
    s_waitcnt vmcnt(16)
    ds_write_b128 v5, v[8:11] offset:0
    ds_write_b128 v5, v[12:15] offset:1024
    ds_write_b128 v5, v[16:19] offset:2048
    ds_write_b128 v5, v[20:23] offset:3072
    ds_write_b128 v5, v[24:27] offset:4096
    ds_write_b128 v5, v[28:31] offset:5120
    ds_write_b128 v5, v[32:35] offset:6144
    ds_write_b128 v5, v[36:39] offset:7168
    s_waitcnt lgkmcnt(0)
    ds_read_b64_tr_b16 a[160:161], v124 offset:0
    ds_read_b64_tr_b16 a[162:163], v124 offset:256
    ds_read_b64_tr_b16 a[224:225], v124 offset:32
    ds_read_b64_tr_b16 a[226:227], v124 offset:288
    ds_read_b64_tr_b16 a[164:165], v124 offset:2048
    ds_read_b64_tr_b16 a[166:167], v124 offset:2304
    ds_read_b64_tr_b16 a[228:229], v124 offset:2080
    ds_read_b64_tr_b16 a[230:231], v124 offset:2336
    ds_read_b64_tr_b16 a[168:169], v124 offset:4096
    ds_read_b64_tr_b16 a[170:171], v124 offset:4352
    ds_read_b64_tr_b16 a[232:233], v124 offset:4128
    ds_read_b64_tr_b16 a[234:235], v124 offset:4384
    ds_read_b64_tr_b16 a[172:173], v124 offset:6144
    ds_read_b64_tr_b16 a[174:175], v124 offset:6400
    ds_read_b64_tr_b16 a[236:237], v124 offset:6176
    ds_read_b64_tr_b16 a[238:239], v124 offset:6432
    s_waitcnt lgkmcnt(0)
    s_add_u32 s25, s57, 1048576
    buffer_load_dwordx4 v[8:11], v6, s[72:75], s25 offen
    s_add_u32 s25, s57, 1179648
    buffer_load_dwordx4 v[12:15], v6, s[72:75], s25 offen
    s_add_u32 s25, s57, 1310720
    buffer_load_dwordx4 v[16:19], v6, s[72:75], s25 offen
    s_add_u32 s25, s57, 1441792
    buffer_load_dwordx4 v[20:23], v6, s[72:75], s25 offen
    s_add_u32 s25, s57, 1572864
    buffer_load_dwordx4 v[24:27], v6, s[72:75], s25 offen
    s_add_u32 s25, s57, 1703936
    buffer_load_dwordx4 v[28:31], v6, s[72:75], s25 offen
    s_add_u32 s25, s57, 1835008
    buffer_load_dwordx4 v[32:35], v6, s[72:75], s25 offen
    s_add_u32 s25, s57, 1966080
    buffer_load_dwordx4 v[36:39], v6, s[72:75], s25 offen
    s_waitcnt vmcnt(16)
    ds_write_b128 v5, v[40:43] offset:0
    ds_write_b128 v5, v[44:47] offset:1024
    ds_write_b128 v5, v[48:51] offset:2048
    ds_write_b128 v5, v[52:55] offset:3072
    ds_write_b128 v5, v[56:59] offset:4096
    ds_write_b128 v5, v[60:63] offset:5120
    ds_write_b128 v5, v[64:67] offset:6144
    ds_write_b128 v5, v[68:71] offset:7168
    s_waitcnt lgkmcnt(0)
    ds_read_b64_tr_b16 a[176:177], v124 offset:0
    ds_read_b64_tr_b16 a[178:179], v124 offset:256
    ds_read_b64_tr_b16 a[240:241], v124 offset:32
    ds_read_b64_tr_b16 a[242:243], v124 offset:288
    ds_read_b64_tr_b16 a[180:181], v124 offset:2048
    ds_read_b64_tr_b16 a[182:183], v124 offset:2304
    ds_read_b64_tr_b16 a[244:245], v124 offset:2080
    ds_read_b64_tr_b16 a[246:247], v124 offset:2336
    ds_read_b64_tr_b16 a[184:185], v124 offset:4096
    ds_read_b64_tr_b16 a[186:187], v124 offset:4352
    ds_read_b64_tr_b16 a[248:249], v124 offset:4128
    ds_read_b64_tr_b16 a[250:251], v124 offset:4384
    ds_read_b64_tr_b16 a[188:189], v124 offset:6144
    ds_read_b64_tr_b16 a[190:191], v124 offset:6400
    ds_read_b64_tr_b16 a[252:253], v124 offset:6176
    ds_read_b64_tr_b16 a[254:255], v124 offset:6432
    s_waitcnt lgkmcnt(0)
    s_add_u32 s25, s57, 2097152
    buffer_load_dwordx4 v[40:43], v6, s[72:75], s25 offen
    s_add_u32 s25, s57, 2228224
    buffer_load_dwordx4 v[44:47], v6, s[72:75], s25 offen
    s_add_u32 s25, s57, 2359296
    buffer_load_dwordx4 v[48:51], v6, s[72:75], s25 offen
    s_add_u32 s25, s57, 2490368
    buffer_load_dwordx4 v[52:55], v6, s[72:75], s25 offen
    s_add_u32 s25, s57, 2621440
    buffer_load_dwordx4 v[56:59], v6, s[72:75], s25 offen
    s_add_u32 s25, s57, 2752512
    buffer_load_dwordx4 v[60:63], v6, s[72:75], s25 offen
    s_add_u32 s25, s57, 2883584
    buffer_load_dwordx4 v[64:67], v6, s[72:75], s25 offen
    s_add_u32 s25, s57, 3014656
    buffer_load_dwordx4 v[68:71], v6, s[72:75], s25 offen
    s_waitcnt vmcnt(16)
    ds_write_b128 v5, v[72:75] offset:0
    ds_write_b128 v5, v[76:79] offset:1024
    ds_write_b128 v5, v[80:83] offset:2048
    ds_write_b128 v5, v[84:87] offset:3072
    ds_write_b128 v5, v[88:91] offset:4096
    ds_write_b128 v5, v[92:95] offset:5120
    ds_write_b128 v5, v[96:99] offset:6144
    ds_write_b128 v5, v[100:103] offset:7168
    s_waitcnt lgkmcnt(0)
    ds_read_b64_tr_b16 v[72:73], v124 offset:0
    ds_read_b64_tr_b16 v[74:75], v124 offset:256
    ds_read_b64_tr_b16 v[76:77], v124 offset:32
    ds_read_b64_tr_b16 v[78:79], v124 offset:288
    ds_read_b64_tr_b16 v[80:81], v124 offset:2048
    ds_read_b64_tr_b16 v[82:83], v124 offset:2304
    ds_read_b64_tr_b16 v[84:85], v124 offset:2080
    ds_read_b64_tr_b16 v[86:87], v124 offset:2336
    ds_read_b64_tr_b16 v[88:89], v124 offset:4096
    ds_read_b64_tr_b16 v[90:91], v124 offset:4352
    ds_read_b64_tr_b16 v[92:93], v124 offset:4128
    ds_read_b64_tr_b16 v[94:95], v124 offset:4384
    ds_read_b64_tr_b16 v[96:97], v124 offset:6144
    ds_read_b64_tr_b16 v[98:99], v124 offset:6400
    ds_read_b64_tr_b16 v[100:101], v124 offset:6176
    ds_read_b64_tr_b16 v[102:103], v124 offset:6432
    s_waitcnt lgkmcnt(0)
    ds_write_b128 v126, v[72:75] offset:0
    ds_write_b128 v126, v[76:79] offset:16384
    ds_write_b128 v126, v[80:83] offset:1024
    ds_write_b128 v126, v[84:87] offset:17408
    ds_write_b128 v126, v[88:91] offset:2048
    ds_write_b128 v126, v[92:95] offset:18432
    ds_write_b128 v126, v[96:99] offset:3072
    ds_write_b128 v126, v[100:103] offset:19456
    s_waitcnt lgkmcnt(0)
    s_add_u32 s25, s57, 3145728
    buffer_load_dwordx4 v[72:75], v6, s[72:75], s25 offen
    s_add_u32 s25, s57, 3276800
    buffer_load_dwordx4 v[76:79], v6, s[72:75], s25 offen
    s_add_u32 s25, s57, 3407872
    buffer_load_dwordx4 v[80:83], v6, s[72:75], s25 offen
    s_add_u32 s25, s57, 3538944
    buffer_load_dwordx4 v[84:87], v6, s[72:75], s25 offen
    s_add_u32 s25, s57, 3670016
    buffer_load_dwordx4 v[88:91], v6, s[72:75], s25 offen
    s_add_u32 s25, s57, 3801088
    buffer_load_dwordx4 v[92:95], v6, s[72:75], s25 offen
    s_add_u32 s25, s57, 3932160
    buffer_load_dwordx4 v[96:99], v6, s[72:75], s25 offen
    s_add_u32 s25, s57, 4063232
    buffer_load_dwordx4 v[100:103], v6, s[72:75], s25 offen
    s_waitcnt vmcnt(16)
    ds_write_b128 v5, v[8:11] offset:0
    ds_write_b128 v5, v[12:15] offset:1024
    ds_write_b128 v5, v[16:19] offset:2048
    ds_write_b128 v5, v[20:23] offset:3072
    ds_write_b128 v5, v[24:27] offset:4096
    ds_write_b128 v5, v[28:31] offset:5120
    ds_write_b128 v5, v[32:35] offset:6144
    ds_write_b128 v5, v[36:39] offset:7168
    s_waitcnt lgkmcnt(0)
    ds_read_b64_tr_b16 v[8:9], v124 offset:0
    ds_read_b64_tr_b16 v[10:11], v124 offset:256
    ds_read_b64_tr_b16 v[12:13], v124 offset:32
    ds_read_b64_tr_b16 v[14:15], v124 offset:288
    ds_read_b64_tr_b16 v[16:17], v124 offset:2048
    ds_read_b64_tr_b16 v[18:19], v124 offset:2304
    ds_read_b64_tr_b16 v[20:21], v124 offset:2080
    ds_read_b64_tr_b16 v[22:23], v124 offset:2336
    ds_read_b64_tr_b16 v[24:25], v124 offset:4096
    ds_read_b64_tr_b16 v[26:27], v124 offset:4352
    ds_read_b64_tr_b16 v[28:29], v124 offset:4128
    ds_read_b64_tr_b16 v[30:31], v124 offset:4384
    ds_read_b64_tr_b16 v[32:33], v124 offset:6144
    ds_read_b64_tr_b16 v[34:35], v124 offset:6400
    ds_read_b64_tr_b16 v[36:37], v124 offset:6176
    ds_read_b64_tr_b16 v[38:39], v124 offset:6432
    s_waitcnt lgkmcnt(0)
    ds_write_b128 v126, v[8:11] offset:4096
    ds_write_b128 v126, v[12:15] offset:20480
    ds_write_b128 v126, v[16:19] offset:5120
    ds_write_b128 v126, v[20:23] offset:21504
    ds_write_b128 v126, v[24:27] offset:6144
    ds_write_b128 v126, v[28:31] offset:22528
    ds_write_b128 v126, v[32:35] offset:7168
    ds_write_b128 v126, v[36:39] offset:23552
    s_waitcnt lgkmcnt(0)
    s_add_u32 s25, s58, 0
    buffer_load_dwordx4 v[8:11], v122, s[76:79], s25 offen
    s_add_u32 s25, s58, 4096
    buffer_load_dwordx4 v[12:15], v122, s[76:79], s25 offen
    s_add_u32 s25, s58, 8192
    buffer_load_dwordx4 v[16:19], v122, s[76:79], s25 offen
    s_add_u32 s25, s58, 12288
    buffer_load_dwordx4 v[20:23], v122, s[76:79], s25 offen
    s_add_u32 s25, s58, 16384
    buffer_load_dwordx4 v[24:27], v122, s[76:79], s25 offen
    s_add_u32 s25, s58, 20480
    buffer_load_dwordx4 v[28:31], v122, s[76:79], s25 offen
    s_add_u32 s25, s58, 24576
    buffer_load_dwordx4 v[32:35], v122, s[76:79], s25 offen
    s_add_u32 s25, s58, 28672
    buffer_load_dwordx4 v[36:39], v122, s[76:79], s25 offen
    s_waitcnt vmcnt(16)
    ds_write_b128 v5, v[40:43] offset:0
    ds_write_b128 v5, v[44:47] offset:1024
    ds_write_b128 v5, v[48:51] offset:2048
    ds_write_b128 v5, v[52:55] offset:3072
    ds_write_b128 v5, v[56:59] offset:4096
    ds_write_b128 v5, v[60:63] offset:5120
    ds_write_b128 v5, v[64:67] offset:6144
    ds_write_b128 v5, v[68:71] offset:7168
    s_waitcnt lgkmcnt(0)
    ds_read_b64_tr_b16 v[40:41], v124 offset:0
    ds_read_b64_tr_b16 v[42:43], v124 offset:256
    ds_read_b64_tr_b16 v[44:45], v124 offset:32
    ds_read_b64_tr_b16 v[46:47], v124 offset:288
    ds_read_b64_tr_b16 v[48:49], v124 offset:2048
    ds_read_b64_tr_b16 v[50:51], v124 offset:2304
    ds_read_b64_tr_b16 v[52:53], v124 offset:2080
    ds_read_b64_tr_b16 v[54:55], v124 offset:2336
    ds_read_b64_tr_b16 v[56:57], v124 offset:4096
    ds_read_b64_tr_b16 v[58:59], v124 offset:4352
    ds_read_b64_tr_b16 v[60:61], v124 offset:4128
    ds_read_b64_tr_b16 v[62:63], v124 offset:4384
    ds_read_b64_tr_b16 v[64:65], v124 offset:6144
    ds_read_b64_tr_b16 v[66:67], v124 offset:6400
    ds_read_b64_tr_b16 v[68:69], v124 offset:6176
    ds_read_b64_tr_b16 v[70:71], v124 offset:6432
    s_waitcnt lgkmcnt(0)
    ds_write_b128 v126, v[40:43] offset:8192
    ds_write_b128 v126, v[44:47] offset:24576
    ds_write_b128 v126, v[48:51] offset:9216
    ds_write_b128 v126, v[52:55] offset:25600
    ds_write_b128 v126, v[56:59] offset:10240
    ds_write_b128 v126, v[60:63] offset:26624
    ds_write_b128 v126, v[64:67] offset:11264
    ds_write_b128 v126, v[68:71] offset:27648
    s_waitcnt lgkmcnt(0)
    s_add_u32 s25, s58, 32768
    buffer_load_dwordx4 v[40:43], v122, s[76:79], s25 offen
    s_add_u32 s25, s58, 36864
    buffer_load_dwordx4 v[44:47], v122, s[76:79], s25 offen
    s_add_u32 s25, s58, 40960
    buffer_load_dwordx4 v[48:51], v122, s[76:79], s25 offen
    s_add_u32 s25, s58, 45056
    buffer_load_dwordx4 v[52:55], v122, s[76:79], s25 offen
    s_add_u32 s25, s58, 49152
    buffer_load_dwordx4 v[56:59], v122, s[76:79], s25 offen
    s_add_u32 s25, s58, 53248
    buffer_load_dwordx4 v[60:63], v122, s[76:79], s25 offen
    s_add_u32 s25, s58, 57344
    buffer_load_dwordx4 v[64:67], v122, s[76:79], s25 offen
    s_add_u32 s25, s58, 61440
    buffer_load_dwordx4 v[68:71], v122, s[76:79], s25 offen
    s_waitcnt vmcnt(16)
    ds_write_b128 v5, v[72:75] offset:0
    ds_write_b128 v5, v[76:79] offset:1024
    ds_write_b128 v5, v[80:83] offset:2048
    ds_write_b128 v5, v[84:87] offset:3072
    ds_write_b128 v5, v[88:91] offset:4096
    ds_write_b128 v5, v[92:95] offset:5120
    ds_write_b128 v5, v[96:99] offset:6144
    ds_write_b128 v5, v[100:103] offset:7168
    s_waitcnt lgkmcnt(0)
    ds_read_b64_tr_b16 v[72:73], v124 offset:0
    ds_read_b64_tr_b16 v[74:75], v124 offset:256
    ds_read_b64_tr_b16 v[76:77], v124 offset:32
    ds_read_b64_tr_b16 v[78:79], v124 offset:288
    ds_read_b64_tr_b16 v[80:81], v124 offset:2048
    ds_read_b64_tr_b16 v[82:83], v124 offset:2304
    ds_read_b64_tr_b16 v[84:85], v124 offset:2080
    ds_read_b64_tr_b16 v[86:87], v124 offset:2336
    ds_read_b64_tr_b16 v[88:89], v124 offset:4096
    ds_read_b64_tr_b16 v[90:91], v124 offset:4352
    ds_read_b64_tr_b16 v[92:93], v124 offset:4128
    ds_read_b64_tr_b16 v[94:95], v124 offset:4384
    ds_read_b64_tr_b16 v[96:97], v124 offset:6144
    ds_read_b64_tr_b16 v[98:99], v124 offset:6400
    ds_read_b64_tr_b16 v[100:101], v124 offset:6176
    ds_read_b64_tr_b16 v[102:103], v124 offset:6432
    s_waitcnt lgkmcnt(0)
    ds_write_b128 v126, v[72:75] offset:12288
    ds_write_b128 v126, v[76:79] offset:28672
    ds_write_b128 v126, v[80:83] offset:13312
    ds_write_b128 v126, v[84:87] offset:29696
    ds_write_b128 v126, v[88:91] offset:14336
    ds_write_b128 v126, v[92:95] offset:30720
    ds_write_b128 v126, v[96:99] offset:15360
    ds_write_b128 v126, v[100:103] offset:31744
    s_waitcnt lgkmcnt(0)
    s_add_u32 s25, s58, 65536
    buffer_load_dwordx4 v[72:75], v122, s[76:79], s25 offen
    s_add_u32 s25, s58, 69632
    buffer_load_dwordx4 v[76:79], v122, s[76:79], s25 offen
    s_add_u32 s25, s58, 73728
    buffer_load_dwordx4 v[80:83], v122, s[76:79], s25 offen
    s_add_u32 s25, s58, 77824
    buffer_load_dwordx4 v[84:87], v122, s[76:79], s25 offen
    s_add_u32 s25, s58, 81920
    buffer_load_dwordx4 v[88:91], v122, s[76:79], s25 offen
    s_add_u32 s25, s58, 86016
    buffer_load_dwordx4 v[92:95], v122, s[76:79], s25 offen
    s_add_u32 s25, s58, 90112
    buffer_load_dwordx4 v[96:99], v122, s[76:79], s25 offen
    s_add_u32 s25, s58, 94208
    buffer_load_dwordx4 v[100:103], v122, s[76:79], s25 offen
    s_waitcnt vmcnt(16)
    ds_write_b128 v5, v[8:11] offset:0
    ds_write_b128 v5, v[12:15] offset:1024
    ds_write_b128 v5, v[16:19] offset:2048
    ds_write_b128 v5, v[20:23] offset:3072
    ds_write_b128 v5, v[24:27] offset:4096
    ds_write_b128 v5, v[28:31] offset:5120
    ds_write_b128 v5, v[32:35] offset:6144
    ds_write_b128 v5, v[36:39] offset:7168
    s_waitcnt lgkmcnt(0)
    ds_read_b64_tr_b16 v[128:129], v125 offset:0
    ds_read_b64_tr_b16 v[130:131], v125 offset:4096
    ds_read_b64_tr_b16 v[144:145], v125 offset:32
    ds_read_b64_tr_b16 v[146:147], v125 offset:4128
    ds_read_b64_tr_b16 v[160:161], v125 offset:64
    ds_read_b64_tr_b16 v[162:163], v125 offset:4160
    ds_read_b64_tr_b16 v[176:177], v125 offset:96
    ds_read_b64_tr_b16 v[178:179], v125 offset:4192
    ds_read_b64_tr_b16 v[192:193], v125 offset:128
    ds_read_b64_tr_b16 v[194:195], v125 offset:4224
    ds_read_b64_tr_b16 v[208:209], v125 offset:160
    ds_read_b64_tr_b16 v[210:211], v125 offset:4256
    ds_read_b64_tr_b16 v[224:225], v125 offset:192
    ds_read_b64_tr_b16 v[226:227], v125 offset:4288
    ds_read_b64_tr_b16 v[240:241], v125 offset:224
    ds_read_b64_tr_b16 v[242:243], v125 offset:4320
    s_waitcnt lgkmcnt(0)
    s_add_u32 s25, s58, 98304
    buffer_load_dwordx4 v[8:11], v122, s[76:79], s25 offen
    s_add_u32 s25, s58, 102400
    buffer_load_dwordx4 v[12:15], v122, s[76:79], s25 offen
    s_add_u32 s25, s58, 106496
    buffer_load_dwordx4 v[16:19], v122, s[76:79], s25 offen
    s_add_u32 s25, s58, 110592
    buffer_load_dwordx4 v[20:23], v122, s[76:79], s25 offen
    s_add_u32 s25, s58, 114688
    buffer_load_dwordx4 v[24:27], v122, s[76:79], s25 offen
    s_add_u32 s25, s58, 118784
    buffer_load_dwordx4 v[28:31], v122, s[76:79], s25 offen
    s_add_u32 s25, s58, 122880
    buffer_load_dwordx4 v[32:35], v122, s[76:79], s25 offen
    s_add_u32 s25, s58, 126976
    buffer_load_dwordx4 v[36:39], v122, s[76:79], s25 offen
    s_waitcnt vmcnt(16)
    ds_write_b128 v5, v[40:43] offset:0
    ds_write_b128 v5, v[44:47] offset:1024
    ds_write_b128 v5, v[48:51] offset:2048
    ds_write_b128 v5, v[52:55] offset:3072
    ds_write_b128 v5, v[56:59] offset:4096
    ds_write_b128 v5, v[60:63] offset:5120
    ds_write_b128 v5, v[64:67] offset:6144
    ds_write_b128 v5, v[68:71] offset:7168
    s_waitcnt lgkmcnt(0)
    ds_read_b64_tr_b16 v[132:133], v125 offset:0
    ds_read_b64_tr_b16 v[134:135], v125 offset:4096
    ds_read_b64_tr_b16 v[148:149], v125 offset:32
    ds_read_b64_tr_b16 v[150:151], v125 offset:4128
    ds_read_b64_tr_b16 v[164:165], v125 offset:64
    ds_read_b64_tr_b16 v[166:167], v125 offset:4160
    ds_read_b64_tr_b16 v[180:181], v125 offset:96
    ds_read_b64_tr_b16 v[182:183], v125 offset:4192
    ds_read_b64_tr_b16 v[196:197], v125 offset:128
    ds_read_b64_tr_b16 v[198:199], v125 offset:4224
    ds_read_b64_tr_b16 v[212:213], v125 offset:160
    ds_read_b64_tr_b16 v[214:215], v125 offset:4256
    ds_read_b64_tr_b16 v[228:229], v125 offset:192
    ds_read_b64_tr_b16 v[230:231], v125 offset:4288
    ds_read_b64_tr_b16 v[244:245], v125 offset:224
    ds_read_b64_tr_b16 v[246:247], v125 offset:4320
    s_waitcnt lgkmcnt(0)
    s_waitcnt vmcnt(8)
    ds_write_b128 v5, v[72:75] offset:0
    ds_write_b128 v5, v[76:79] offset:1024
    ds_write_b128 v5, v[80:83] offset:2048
    ds_write_b128 v5, v[84:87] offset:3072
    ds_write_b128 v5, v[88:91] offset:4096
    ds_write_b128 v5, v[92:95] offset:5120
    ds_write_b128 v5, v[96:99] offset:6144
    ds_write_b128 v5, v[100:103] offset:7168
    s_waitcnt lgkmcnt(0)
    ds_read_b64_tr_b16 v[136:137], v125 offset:0
    ds_read_b64_tr_b16 v[138:139], v125 offset:4096
    ds_read_b64_tr_b16 v[152:153], v125 offset:32
    ds_read_b64_tr_b16 v[154:155], v125 offset:4128
    ds_read_b64_tr_b16 v[168:169], v125 offset:64
    ds_read_b64_tr_b16 v[170:171], v125 offset:4160
    ds_read_b64_tr_b16 v[184:185], v125 offset:96
    ds_read_b64_tr_b16 v[186:187], v125 offset:4192
    ds_read_b64_tr_b16 v[200:201], v125 offset:128
    ds_read_b64_tr_b16 v[202:203], v125 offset:4224
    ds_read_b64_tr_b16 v[216:217], v125 offset:160
    ds_read_b64_tr_b16 v[218:219], v125 offset:4256
    ds_read_b64_tr_b16 v[232:233], v125 offset:192
    ds_read_b64_tr_b16 v[234:235], v125 offset:4288
    ds_read_b64_tr_b16 v[248:249], v125 offset:224
    ds_read_b64_tr_b16 v[250:251], v125 offset:4320
    s_waitcnt lgkmcnt(0)
    s_waitcnt vmcnt(0)
    ds_write_b128 v5, v[8:11] offset:0
    ds_write_b128 v5, v[12:15] offset:1024
    ds_write_b128 v5, v[16:19] offset:2048
    ds_write_b128 v5, v[20:23] offset:3072
    ds_write_b128 v5, v[24:27] offset:4096
    ds_write_b128 v5, v[28:31] offset:5120
    ds_write_b128 v5, v[32:35] offset:6144
    ds_write_b128 v5, v[36:39] offset:7168
    s_waitcnt lgkmcnt(0)
    ds_read_b64_tr_b16 v[140:141], v125 offset:0
    ds_read_b64_tr_b16 v[142:143], v125 offset:4096
    ds_read_b64_tr_b16 v[156:157], v125 offset:32
    ds_read_b64_tr_b16 v[158:159], v125 offset:4128
    ds_read_b64_tr_b16 v[172:173], v125 offset:64
    ds_read_b64_tr_b16 v[174:175], v125 offset:4160
    ds_read_b64_tr_b16 v[188:189], v125 offset:96
    ds_read_b64_tr_b16 v[190:191], v125 offset:4192
    ds_read_b64_tr_b16 v[204:205], v125 offset:128
    ds_read_b64_tr_b16 v[206:207], v125 offset:4224
    ds_read_b64_tr_b16 v[220:221], v125 offset:160
    ds_read_b64_tr_b16 v[222:223], v125 offset:4256
    ds_read_b64_tr_b16 v[236:237], v125 offset:192
    ds_read_b64_tr_b16 v[238:239], v125 offset:4288
    ds_read_b64_tr_b16 v[252:253], v125 offset:224
    ds_read_b64_tr_b16 v[254:255], v125 offset:4320
    s_waitcnt lgkmcnt(0)
    s_mov_b32 s27, 0
    v_lshlrev_b32 v6, 2, v1
    v_and_b32 v6, 127, v6
L_modepoll_8:
    buffer_load_dword v7, v6, s[12:15], 0 offen offset:64 sc1
    s_waitcnt vmcnt(0)
    s_add_u32 s27, s27, 1
    s_cmp_gt_u32 s27, 4194304
    s_cbranch_scc1 L_fused_done_1
    v_cmp_eq_u32 vcc, 0, v7
    s_cbranch_vccnz L_modepoll_8
    v_cmp_eq_u32 vcc, 2, v7
    s_cmp_lg_u64 vcc, 0
    s_cselect_b32 s28, 1, 0
    v_and_b32 v8, 7, v2
    v_lshrrev_b32 v9, 3, v2
    v_and_b32 v10, 1, v3
    v_lshrrev_b32 v11, 1, v3
    v_cmp_gt_u32 s[44:45], 2, v3
    v_cmp_gt_u32 vcc, 8, v2
    v_mov_b32 v126, 0xeeee
    v_mov_b32 v12, 0x4444
    v_cndmask_b32 v126, v126, v12, vcc
    v_lshlrev_b32 v13, 10, v8
    v_lshl_add_u32 v13, v3, 5, v13
    v_lshl_add_u32 v13, v9, 2, v13
    s_and_b32 s25, s20, 1
    s_lshl_b32 s25, s25, 1
    v_add_u32 v14, s25, v11
    v_lshl_add_u32 v14, v14, 4, v8
    v_lshlrev_b32 v14, 4, v14
    v_lshl_add_u32 v14, v10, 3, v14
    s_lshr_b32 s25, s20, 1
    s_lshl_b32 s25, s25, 10
    s_add_u32 s25, s25, 20480
    v_add_u32 v14, s25, v14
    v_add_u32 v15, 26624, v4
    v_cndmask_b32 v127, v15, v14, vcc
    v_lshlrev_b32 v7, 4, v2
    v_lshl_add_u32 v7, v10, 3, v7
    v_lshl_add_u32 v7, v11, 13, v7
    s_lshl_b32 s25, s24, 8
    v_add_u32 v7, s25, v7
    v_lshl_add_u32 v6, v11, 4, v2
    v_lshlrev_b32 v6, 4, v6
    v_lshl_add_u32 v6, v10, 3, v6
    s_lshl_b32 s25, s20, 10
    s_add_u32 s25, s25, 22528
    v_add_u32 v6, s25, v6
    v_lshrrev_b32 v16, 2, v2
    v_lshl_add_u32 v16, v3, 2, v16
    v_lshlrev_b32 v16, 4, v16
    v_and_b32 v17, 3, v1
    v_lshl_add_u32 v16, v17, 3, v16
    v_add_u32 v0, s25, v16
    v_lshrrev_b32 v16, 3, v1
    v_lshlrev_b32 v124, 10, v16
    v_and_b32 v16, 1, v1
    v_bfe_u32 v17, v1, 1, 1
    v_bfe_u32 v18, v1, 2, 1
    v_lshl_add_u32 v19, v18, 1, v16
    v_lshl_add_u32 v124, v19, 4, v124
    v_lshl_add_u32 v124, v17, 3, v124
    s_lshl_b32 s25, s24, 13
    s_lshl_b32 s26, s20, 6
    s_add_u32 s25, s25, s26
    v_add_u32 v124, s25, v124
    v_lshlrev_b32 v19, 2, v17
    v_lshl_add_u32 v19, v18, 3, v19
    v_lshlrev_b32 v125, 4, v19
    s_lshr_b32 s25, s24, 2
    s_lshl_b32 s25, s25, 10
    s_and_b32 s26, s24, 3
    s_lshl_b32 s26, s26, 8
    s_add_u32 s25, s25, s26
    s_lshl_b32 s26, s20, 2
    s_add_u32 s25, s25, s26
    v_add_u32 v125, s25, v125
    v_lshlrev_b32 v19, 1, v10
    v_add_u32 v19, v19, v11
    v_lshl_add_u32 v125, v19, 4, v125
    s_mov_b32 s46, 0x00550055
    s_mov_b32 s47, 0x00550055
    s_lshl_b32 s25, s20, 11
    v_add_u32 v5, s25, v4
    v_lshl_add_u32 v16, v3, 4, v8
    v_lshlrev_b32 v16, 4, v16
    v_lshl_add_u32 v3, v9, 3, v16
    v_add_u32 v9, 1, v9
    v_lshl_add_u32 v2, v9, 10, v16
    s_lshl_b32 s25, s20, 15
    s_add_u32 s25, s25, 32768
    v_add_u32 v1, s25, v4
    s_lshl_b32 s30, s24, 2
    s_add_u32 s30, s30, s20
    s_lshl_b32 s31, s30, 10
    s_lshl_b32 s30, s30, 11
    s_mul_i32 s43, s20, 3072
    s_mov_b32 s29, 0
    v_mov_b32 v100, v13
    buffer_load_dword v8, v100, s[16:19], 0 offen offset:0
    buffer_load_dword v9, v100, s[16:19], 0 offen offset:8
    buffer_load_dword v10, v100, s[16:19], 0 offen offset:16
    buffer_load_dword v11, v100, s[16:19], 0 offen offset:24
    buffer_load_dword v12, v100, s[16:19], 0 offen offset:128
    buffer_load_dword v13, v100, s[16:19], 0 offen offset:136
    buffer_load_dword v14, v100, s[16:19], 0 offen offset:144
    buffer_load_dword v15, v100, s[16:19], 0 offen offset:152
    buffer_load_dword v16, v100, s[16:19], 0 offen offset:256
    buffer_load_dword v17, v100, s[16:19], 0 offen offset:264
    buffer_load_dword v18, v100, s[16:19], 0 offen offset:272
    buffer_load_dword v19, v100, s[16:19], 0 offen offset:280
    buffer_load_dword v20, v100, s[16:19], 0 offen offset:384
    buffer_load_dword v21, v100, s[16:19], 0 offen offset:392
    buffer_load_dword v22, v100, s[16:19], 0 offen offset:400
    buffer_load_dword v23, v100, s[16:19], 0 offen offset:408
    buffer_load_dword v24, v100, s[16:19], 0 offen offset:512
    buffer_load_dword v25, v100, s[16:19], 0 offen offset:520
    buffer_load_dword v26, v100, s[16:19], 0 offen offset:528
    buffer_load_dword v27, v100, s[16:19], 0 offen offset:536
    buffer_load_dword v28, v100, s[16:19], 0 offen offset:640
    buffer_load_dword v29, v100, s[16:19], 0 offen offset:648
    buffer_load_dword v30, v100, s[16:19], 0 offen offset:656
    buffer_load_dword v31, v100, s[16:19], 0 offen offset:664
    buffer_load_dword v32, v100, s[16:19], 0 offen offset:768
    buffer_load_dword v33, v100, s[16:19], 0 offen offset:776
    buffer_load_dword v34, v100, s[16:19], 0 offen offset:784
    buffer_load_dword v35, v100, s[16:19], 0 offen offset:792
    buffer_load_dword v36, v100, s[16:19], 0 offen offset:896
    buffer_load_dword v37, v100, s[16:19], 0 offen offset:904
    buffer_load_dword v38, v100, s[16:19], 0 offen offset:912
    buffer_load_dword v39, v100, s[16:19], 0 offen offset:920
    v_mov_b32 v120, 0
L_prepwait_9:
    buffer_load_dword v121, v120, s[12:15], 0 offen offset:252 sc1
    s_add_u32 s27, s27, 1
    s_cmp_gt_u32 s27, 4194304
    s_cbranch_scc1 L_fused_done_1
    s_waitcnt vmcnt(0)
    v_readfirstlane_b32 s26, v121
    s_cmp_lt_u32 s26, 1
    s_cbranch_scc1 L_prepwait_9
    s_lshr_b32 s25, s29, 2
    s_lshl_b32 s25, s25, 7
    s_add_u32 s25, s25, 122736640
    v_mov_b32 v120, 0
L_kvwait_10:
    buffer_load_dword v121, v120, s[8:11], s25 offen sc1
    s_mov_b32 s26, 122738688
    buffer_load_dword v122, v120, s[8:11], s26 offen sc1
    s_add_u32 s27, s27, 1
    s_cmp_gt_u32 s27, 4194304
    s_cbranch_scc1 L_fused_done_1
    s_waitcnt vmcnt(0)
    v_readfirstlane_b32 s26, v121
    v_readfirstlane_b32 s93, v122
    s_cmp_lt_u32 s26, 64
    s_cbranch_scc1 L_kvwait_10
    s_lshl_b32 s25, s29, 18
    s_add_u32 s25, s25, s30
    s_add_u32 s26, s25, 41943040
    buffer_load_dwordx4 v[96:99], v4, s[8:11], s26 offen
    buffer_load_dwordx4 v[100:103], v4, s[8:11], s26 offen offset:1024
    s_add_u32 s26, s25, 58720256
    buffer_load_dwordx4 v[104:107], v4, s[8:11], s26 offen
    buffer_load_dwordx4 v[108:111], v4, s[8:11], s26 offen offset:1024
    v_mov_b64 v[40:41], 0
    v_mov_b64 v[42:43], 0
    v_mov_b64 v[44:45], 0
    v_mov_b64 v[46:47], 0
    v_mov_b64 v[48:49], 0
    v_mov_b64 v[50:51], 0
    v_mov_b64 v[52:53], 0
    v_mov_b64 v[54:55], 0
    v_mov_b64 v[56:57], 0
    v_mov_b64 v[58:59], 0
    v_mov_b64 v[60:61], 0
    v_mov_b64 v[62:63], 0
    s_waitcnt vmcnt(0) lgkmcnt(0)
    s_barrier
    s_cmp_lg_u32 s28, 0
    s_cbranch_scc1 L_slowloop_12
    s_and_b32 s25, s29, 1
    s_lshl_b32 s25, s25, 18
    s_add_u32 s33, s25, 121634816
    s_lshl_b32 s25, s20, 16
    s_add_u32 s34, s33, s25
    s_add_u32 s26, s29, 1
    s_mul_i32 s25, s26, 21846
    s_lshr_b32 s25, s25, 16
    s_mul_i32 s25, s25, 3
    s_sub_u32 s25, s26, s25
    s_lshl_b32 s35, s25, 13
    s_add_u32 s35, s35, 122159104
    s_add_u32 s25, s25, 2
    s_cmp_ge_u32 s25, 3
    s_cselect_b32 s26, 3, 0
    s_sub_u32 s25, s25, s26
    s_lshl_b32 s36, s25, 13
    s_add_u32 s36, s36, 122159104
    s_lshl_b32 s25, s29, 17
    s_add_u32 s25, s25, s31
    s_add_u32 s37, s25, 75497472
    s_add_u32 s38, s25, 83886080
    s_add_u32 s52, s34, 0
    s_add_u32 s53, s34, 16384
    s_add_u32 s54, s34, 32768
    s_add_u32 s55, s34, 49152
    s_branch L_qkv_13
L_step_14:
    buffer_load_dwordx4 v[8:11], v5, s[8:11], s32 offen sc1
    buffer_load_dwordx4 v[12:15], v5, s[8:11], s32 offen offset:1024 sc1
    v_mov_b64 v[40:41], 0
    v_mov_b64 v[42:43], 0
    v_mov_b64 v[44:45], 0
    v_mov_b64 v[46:47], 0
    v_mov_b64 v[48:49], 0
    v_mov_b64 v[50:51], 0
    v_mov_b64 v[52:53], 0
    v_mov_b64 v[54:55], 0
    v_mov_b64 v[56:57], 0
    v_mov_b64 v[58:59], 0
    v_mov_b64 v[60:61], 0
    v_mov_b64 v[62:63], 0
    s_and_b32 s25, s29, 1
    s_lshl_b32 s25, s25, 18
    s_add_u32 s33, s25, 121634816
    s_lshl_b32 s25, s20, 16
    s_add_u32 s34, s33, s25
    s_add_u32 s26, s29, 1
    s_mul_i32 s25, s26, 21846
    s_lshr_b32 s25, s25, 16
    s_mul_i32 s25, s25, 3
    s_sub_u32 s25, s26, s25
    s_lshl_b32 s35, s25, 13
    s_add_u32 s35, s35, 122159104
    s_add_u32 s25, s25, 2
    s_cmp_ge_u32 s25, 3
    s_cselect_b32 s26, 3, 0
    s_sub_u32 s25, s25, s26
    s_lshl_b32 s36, s25, 13
    s_add_u32 s36, s36, 122159104
    s_lshl_b32 s25, s29, 17
    s_add_u32 s25, s25, s31
    s_add_u32 s37, s25, 75497472
    s_add_u32 s38, s25, 83886080
    s_add_u32 s52, s34, 0
    s_add_u32 s53, s34, 16384
    s_add_u32 s54, s34, 32768
    s_add_u32 s55, s34, 49152
    s_waitcnt vmcnt(0)
    v_max3_u32 v16, v8, v9, v10
    v_max3_u32 v17, v11, v12, v13
    v_max3_u32 v16, v16, v14, v15
    v_max_u32 v16, v16, v17
    v_cmp_eq_u32 vcc, -1, v16
    s_cbranch_vccz L_memok_16
L_mempoll_15:
    buffer_load_dwordx4 v[8:11], v5, s[8:11], s32 offen sc1
    buffer_load_dwordx4 v[12:15], v5, s[8:11], s32 offen offset:1024 sc1
    s_add_u32 s27, s27, 1
    s_cmp_gt_u32 s27, 4194304
    s_cbranch_scc1 L_fused_done_1
    s_waitcnt vmcnt(0)
    v_max3_u32 v16, v8, v9, v10
    v_max3_u32 v17, v11, v12, v13
    v_max3_u32 v16, v16, v14, v15
    v_max_u32 v16, v16, v17
    v_cmp_eq_u32 vcc, -1, v16
    s_cbranch_vccnz L_mempoll_15
L_memok_16:
    ds_write_b128 v5, v[8:11]
    ds_write_b128 v5, v[12:15] offset:1024
    v_mov_b32 v120, -1
    v_mov_b32 v121, -1
    buffer_store_dwordx2 v[120:121], v124, s[8:11], s39 offen offset:0
    buffer_store_dwordx2 v[120:121], v124, s[8:11], s39 offen offset:256
    buffer_store_dwordx2 v[120:121], v124, s[8:11], s39 offen offset:512
    buffer_store_dwordx2 v[120:121], v124, s[8:11], s39 offen offset:768
    s_mov_b64 exec, s[46:47]
    buffer_store_dword v120, v125, s[8:11], s49 offen
    s_mov_b64 exec, -1
    s_waitcnt lgkmcnt(0)
    s_barrier
    ds_read_b128 v[8:11], v4 offset:0
    ds_read_b128 v[12:15], v4 offset:1024
    ds_read_b128 v[16:19], v4 offset:2048
    ds_read_b128 v[20:23], v4 offset:3072
    ds_read_b128 v[24:27], v4 offset:4096
    ds_read_b128 v[28:31], v4 offset:5120
    ds_read_b128 v[32:35], v4 offset:6144
    ds_read_b128 v[36:39], v4 offset:7168
L_qkv_13:
    ds_read_b128 v[64:67], v1 offset:0
    ds_read_b128 v[68:71], v1 offset:1024
    ds_read_b128 v[72:75], v1 offset:16384
    ds_read_b128 v[76:79], v1 offset:17408
    ds_read_b128 v[80:83], v1 offset:2048
    ds_read_b128 v[84:87], v1 offset:3072
    ds_read_b128 v[88:91], v1 offset:18432
    ds_read_b128 v[92:95], v1 offset:19456
    s_waitcnt lgkmcnt(15)
    v_smfmac_f32_16x16x64_bf16 v[40:43], v[8:11], a[0:7], v126
    v_smfmac_f32_16x16x64_bf16 v[48:51], v[8:11], a[128:135], v126
    v_smfmac_f32_16x16x64_bf16 v[44:47], v[8:11], a[64:71], v126
    v_smfmac_f32_16x16x64_bf16 v[52:55], v[8:11], a[192:199], v126
    s_waitcnt lgkmcnt(14)
    v_smfmac_f32_16x16x64_bf16 v[40:43], v[12:15], a[8:15], v126
    v_smfmac_f32_16x16x64_bf16 v[48:51], v[12:15], a[136:143], v126
    v_smfmac_f32_16x16x64_bf16 v[44:47], v[12:15], a[72:79], v126
    v_smfmac_f32_16x16x64_bf16 v[52:55], v[12:15], a[200:207], v126
    s_waitcnt lgkmcnt(13)
    v_smfmac_f32_16x16x64_bf16 v[40:43], v[16:19], a[16:23], v126
    v_smfmac_f32_16x16x64_bf16 v[48:51], v[16:19], a[144:151], v126
    v_smfmac_f32_16x16x64_bf16 v[44:47], v[16:19], a[80:87], v126
    v_smfmac_f32_16x16x64_bf16 v[52:55], v[16:19], a[208:215], v126
    s_cmp_eq_u32 s29, 0
    s_cbranch_scc1 L_noflag_17
    s_lshl_b32 s25, s29, 9
    s_lshr_b32 s26, s31, 8
    s_add_u32 s25, s25, s26
    s_add_u32 s25, s25, 122748416
    v_mov_b32 v120, 0
    v_mov_b32 v121, 1
    s_mov_b64 exec, 1
    buffer_store_dword v121, v120, s[8:11], s25 offen sc1
    s_mov_b64 exec, -1
L_noflag_17:
    s_waitcnt lgkmcnt(12)
    v_smfmac_f32_16x16x64_bf16 v[40:43], v[20:23], a[24:31], v126
    v_smfmac_f32_16x16x64_bf16 v[48:51], v[20:23], a[152:159], v126
    v_smfmac_f32_16x16x64_bf16 v[44:47], v[20:23], a[88:95], v126
    v_smfmac_f32_16x16x64_bf16 v[52:55], v[20:23], a[216:223], v126
    s_waitcnt lgkmcnt(11)
    v_smfmac_f32_16x16x64_bf16 v[40:43], v[24:27], a[32:39], v126
    v_smfmac_f32_16x16x64_bf16 v[48:51], v[24:27], a[160:167], v126
    v_smfmac_f32_16x16x64_bf16 v[44:47], v[24:27], a[96:103], v126
    v_smfmac_f32_16x16x64_bf16 v[52:55], v[24:27], a[224:231], v126
    s_cmp_ge_u32 s93, 1024
    s_cbranch_scc1 L_kvok_18
    s_add_u32 s92, s29, 2
    s_and_b32 s25, s92, 3
    s_cmp_lg_u32 s25, 0
    s_cbranch_scc1 L_kvpf_19
    s_cmp_ge_u32 s92, 64
    s_cbranch_scc1 L_kvok_18
    v_mov_b32 v122, 29696
    ds_read_b64 v[120:121], v122
    s_waitcnt lgkmcnt(0)
    v_readfirstlane_b32 s26, v120
    v_readfirstlane_b32 s93, v121
    s_cmp_ge_u32 s26, 64
    s_cbranch_scc1 L_kvok_18
    s_lshr_b32 s25, s92, 2
    s_lshl_b32 s25, s25, 7
    s_add_u32 s25, s25, 122736640
    v_mov_b32 v120, 0
L_kvwait_21:
    buffer_load_dword v121, v120, s[8:11], s25 offen sc1
    s_mov_b32 s26, 122738688
    buffer_load_dword v122, v120, s[8:11], s26 offen sc1
    s_add_u32 s27, s27, 1
    s_cmp_gt_u32 s27, 4194304
    s_cbranch_scc1 L_fused_done_1
    s_waitcnt vmcnt(0)
    v_readfirstlane_b32 s26, v121
    v_readfirstlane_b32 s93, v122
    s_cmp_lt_u32 s26, 64
    s_cbranch_scc1 L_kvwait_21
    s_branch L_kvok_18
L_kvpf_19:
    s_cmp_lg_u32 s25, 3
    s_cbranch_scc1 L_kvok_18
    s_add_u32 s25, s92, 1
    s_lshr_b32 s25, s25, 2
    s_lshl_b32 s25, s25, 7
    s_add_u32 s25, s25, 122736640
    v_mov_b32 v120, 122738688
    s_mov_b64 exec, 1
    v_mov_b32 v120, s25
    s_mov_b64 exec, 3
    s_mov_b32 m0, 29696
    s_nop 0
    buffer_load_dword v120, s[8:11], 0 offen sc1 lds
    s_mov_b64 exec, -1
L_kvok_18:
    v_and_b32 v120, 0xf0, v4
    v_lshlrev_b32 v120, 3, v120
    v_bfe_u32 v121, v4, 8, 1
    v_lshl_add_u32 v120, v121, 24, v120
    s_add_u32 s25, s29, 2
    s_lshl_b32 s25, s25, 18
    s_add_u32 s25, s25, s30
    s_add_u32 s25, s25, 41943040
    s_mov_b32 m0, 28672
    s_nop 0
    buffer_load_dword v120, s[8:11], s25 offen lds
    s_waitcnt lgkmcnt(10)
    v_smfmac_f32_16x16x64_bf16 v[40:43], v[28:31], a[40:47], v126
    v_smfmac_f32_16x16x64_bf16 v[48:51], v[28:31], a[168:175], v126
    v_smfmac_f32_16x16x64_bf16 v[44:47], v[28:31], a[104:111], v126
    v_smfmac_f32_16x16x64_bf16 v[52:55], v[28:31], a[232:239], v126
    s_waitcnt lgkmcnt(9)
    v_smfmac_f32_16x16x64_bf16 v[40:43], v[32:35], a[48:55], v126
    v_smfmac_f32_16x16x64_bf16 v[48:51], v[32:35], a[176:183], v126
    v_smfmac_f32_16x16x64_bf16 v[44:47], v[32:35], a[112:119], v126
    v_smfmac_f32_16x16x64_bf16 v[52:55], v[32:35], a[240:247], v126
    s_waitcnt lgkmcnt(8)
    v_smfmac_f32_16x16x64_bf16 v[40:43], v[36:39], a[56:63], v126
    v_smfmac_f32_16x16x64_bf16 v[48:51], v[36:39], a[184:191], v126
    v_smfmac_f32_16x16x64_bf16 v[44:47], v[36:39], a[120:127], v126
    v_smfmac_f32_16x16x64_bf16 v[52:55], v[36:39], a[248:255], v126
    v_add_u32 v123, s43, v4
    s_waitcnt lgkmcnt(6)
    v_smfmac_f32_16x16x64_bf16 v[56:59], v[8:11], v[64:71], v126
    ds_read_b128 v[64:67], v1 offset:4096
    ds_read_b128 v[68:71], v1 offset:5120
    s_waitcnt lgkmcnt(6)
    v_smfmac_f32_16x16x64_bf16 v[60:63], v[8:11], v[72:79], v126
    ds_read_b128 v[72:75], v1 offset:20480
    ds_read_b128 v[76:79], v1 offset:21504
    s_waitcnt lgkmcnt(6)
    v_smfmac_f32_16x16x64_bf16 v[56:59], v[12:15], v[80:87], v126
    ds_read_b128 v[80:83], v1 offset:6144
    ds_read_b128 v[84:87], v1 offset:7168
    s_waitcnt lgkmcnt(6)
    v_smfmac_f32_16x16x64_bf16 v[60:63], v[12:15], v[88:95], v126
    ds_read_b128 v[88:91], v1 offset:22528
    ds_read_b128 v[92:95], v1 offset:23552
    v_permlane32_swap_b32 v40, v44
    v_permlane32_swap_b32 v48, v52
    s_waitcnt lgkmcnt(6)
    v_smfmac_f32_16x16x64_bf16 v[56:59], v[16:19], v[64:71], v126
    ds_read_b128 v[64:67], v1 offset:8192
    ds_read_b128 v[68:71], v1 offset:9216
    v_permlane32_swap_b32 v41, v45
    v_permlane32_swap_b32 v49, v53
    s_waitcnt lgkmcnt(6)
    v_smfmac_f32_16x16x64_bf16 v[60:63], v[16:19], v[72:79], v126
    ds_read_b128 v[72:75], v1 offset:24576
    ds_read_b128 v[76:79], v1 offset:25600
    v_permlane32_swap_b32 v42, v46
    v_permlane32_swap_b32 v50, v54
    s_waitcnt lgkmcnt(6)
    v_smfmac_f32_16x16x64_bf16 v[56:59], v[20:23], v[80:87], v126
    ds_read_b128 v[80:83], v1 offset:10240
    ds_read_b128 v[84:87], v1 offset:11264
    v_permlane32_swap_b32 v43, v47
    v_permlane32_swap_b32 v51, v55
    s_waitcnt lgkmcnt(6)
    v_smfmac_f32_16x16x64_bf16 v[60:63], v[20:23], v[88:95], v126
    ds_read_b128 v[88:91], v1 offset:26624
    ds_read_b128 v[92:95], v1 offset:27648
    v_pk_add_f32 v[40:41], v[40:41], v[44:45]
    v_pk_add_f32 v[42:43], v[42:43], v[46:47]
    v_pk_add_f32 v[48:49], v[48:49], v[52:53]
    v_pk_add_f32 v[50:51], v[50:51], v[54:55]
    v_cvt_pk_bf16_f32 v44, v40, v41
    v_cvt_pk_bf16_f32 v45, v42, v43
    v_cvt_pk_bf16_f32 v52, v48, v49
    v_cvt_pk_bf16_f32 v53, v50, v51
    ds_write_b64 v6, v[44:45]
    ds_write_b64 v6, v[52:53] offset:512
    s_waitcnt lgkmcnt(8)
    v_smfmac_f32_16x16x64_bf16 v[56:59], v[24:27], v[64:71], v126
    ds_read_b128 v[64:67], v1 offset:12288
    ds_read_b128 v[68:71], v1 offset:13312
    s_waitcnt lgkmcnt(8)
    v_smfmac_f32_16x16x64_bf16 v[60:63], v[24:27], v[72:79], v126
    ds_read_b128 v[72:75], v1 offset:28672
    ds_read_b128 v[76:79], v1 offset:29696
    s_waitcnt lgkmcnt(4)
    ds_read_b64_tr_b16 v[40:41], v0
    ds_read_b64_tr_b16 v[42:43], v0 offset:256
    ds_read_b64_tr_b16 v[48:49], v0 offset:512
    ds_read_b64_tr_b16 v[50:51], v0 offset:768
    v_smfmac_f32_16x16x64_bf16 v[56:59], v[28:31], v[80:87], v126
    ds_read_b128 v[80:83], v1 offset:14336
    ds_read_b128 v[84:87], v1 offset:15360
    v_smfmac_f32_16x16x64_bf16 v[60:63], v[28:31], v[88:95], v126
    ds_read_b128 v[88:91], v1 offset:30720
    ds_read_b128 v[92:95], v1 offset:31744
    s_waitcnt lgkmcnt(4)
    v_mfma_f32_16x16x32_bf16 v[112:115], v[48:51], v[40:43], 0
    v_mfma_f32_16x16x32_bf16 v[116:119], v[96:99], v[40:43], 0
    v_mov_b32 v44, v123
    v_mfma_f32_16x16x32_bf16 v[120:123], v[100:103], v[40:43], 0
    buffer_store_dwordx4 v[48:51], v4, s[8:11], s37 offen sc1
    v_smfmac_f32_16x16x64_bf16 v[56:59], v[32:35], v[64:71], v126
    v_smfmac_f32_16x16x64_bf16 v[60:63], v[32:35], v[72:79], v126
    s_waitcnt lgkmcnt(2)
    v_smfmac_f32_16x16x64_bf16 v[56:59], v[36:39], v[80:87], v126
    s_waitcnt lgkmcnt(0)
    v_smfmac_f32_16x16x64_bf16 v[60:63], v[36:39], v[88:95], v126
    s_nop 3
    ds_write_b128 v44, v[112:115] offset:8192
    ds_write_b128 v44, v[116:119] offset:9216
    ds_write_b128 v44, v[120:123] offset:10240
    s_waitcnt lgkmcnt(0)
    s_barrier
    ds_read_b128 v[8:11], v2 offset:8192
    ds_read_b64 v[12:13], v3 offset:8192
    ds_read_b128 v[14:17], v2 offset:11264
    ds_read_b64 v[18:19], v3 offset:11264
    ds_read_b128 v[20:23], v2 offset:14336
    ds_read_b64 v[24:25], v3 offset:14336
    ds_read_b128 v[26:29], v2 offset:17408
    ds_read_b64 v[30:31], v3 offset:17408
    v_permlane32_swap_b32 v56, v60
    v_permlane32_swap_b32 v57, v61
    v_permlane32_swap_b32 v58, v62
    v_permlane32_swap_b32 v59, v63
    v_pk_add_f32 v[56:57], v[56:57], v[60:61]
    v_pk_add_f32 v[58:59], v[58:59], v[62:63]
    v_cvt_pk_bf16_f32 v56, v56, v57
    v_cvt_pk_bf16_f32 v57, v58, v59
    v_mov_b32 v60, v56
    v_mov_b32 v61, v57
    v_mov_b64 v[58:59], 0
    v_mov_b64 v[62:63], 0
    v_permlane32_swap_b32 v56, v60
    v_permlane32_swap_b32 v57, v61
    v_lshrrev_b32 v46, 1, v4
    buffer_store_dwordx2 v[56:57], v46, s[8:11], s38 offen sc1
    buffer_store_dwordx2 v[60:61], v46, s[8:11], s38 offen offset:512 sc1
    s_cmp_eq_u32 s29, 63
    s_cbranch_scc1 L_chain_last_11
    s_waitcnt lgkmcnt(0)
    v_pk_add_f32 v[8:9], v[8:9], v[14:15]
    v_pk_add_f32 v[20:21], v[20:21], v[26:27]
    v_pk_add_f32 v[10:11], v[10:11], v[16:17]
    v_pk_add_f32 v[22:23], v[22:23], v[28:29]
    v_pk_add_f32 v[12:13], v[12:13], v[18:19]
    v_pk_add_f32 v[24:25], v[24:25], v[30:31]
    v_pk_add_f32 v[112:113], v[8:9], v[20:21]
    v_pk_add_f32 v[114:115], v[10:11], v[22:23]
    v_pk_add_f32 v[116:117], v[12:13], v[24:25]
    v_mov_b32 v40, 0xff800000
    v_cndmask_b32 v116, v40, v116, s[44:45]
    v_cndmask_b32 v117, v40, v117, s[44:45]
    v_max3_f32 v40, v112, v113, v114
    v_max3_f32 v41, v115, v116, v117
    v_max_f32 v40, v40, v41
    v_mov_b32 v42, 0x3e0293ee
    v_mov_b32 v43, 0x3e0293ee
    v_max_f32_dpp v40, v40, v40 row_ror:8 row_mask:0xf bank_mask:0xf
    v_mov_b32 v41, v40
    v_mov_b64 v[64:65], 0
    v_mov_b64 v[66:67], 0
    v_permlane16_swap_b32 v40, v41
    v_max_f32 v40, v40, v41
    v_mov_b32 v41, v40
    v_mov_b64 v[68:69], 0
    v_mov_b64 v[70:71], 0
    v_permlane32_swap_b32 v40, v41
    v_max_f32 v40, v40, v41
    v_mul_f32 v40, 0xbe0293ee, v40
    v_mov_b32 v41, v40
    v_pk_fma_f32 v[112:113], v[112:113], v[42:43], v[40:41]
    v_pk_fma_f32 v[114:115], v[114:115], v[42:43], v[40:41]
    v_pk_fma_f32 v[116:117], v[116:117], v[42:43], v[40:41]
    v_exp_f32 v112, v112
    v_exp_f32 v113, v113
    v_exp_f32 v114, v114
    v_exp_f32 v115, v115
    v_exp_f32 v116, v116
    v_exp_f32 v117, v117
    v_mov_b64 v[54:55], 0
    v_cvt_pk_bf16_f32 v48, v112, v113
    v_cvt_pk_bf16_f32 v49, v114, v115
    v_cvt_pk_bf16_f32 v52, v116, v117
    v_pk_add_f32 v[40:41], v[112:113], v[114:115]
    v_mov_b32_dpp v50, v48 row_ror:8 row_mask:0xf bank_mask:0xf
    v_mov_b32_dpp v51, v49 row_ror:8 row_mask:0xf bank_mask:0xf
    v_mov_b32_dpp v53, v52 row_ror:8 row_mask:0xf bank_mask:0xf
    v_pk_add_f32 v[40:41], v[40:41], v[116:117]
    v_add_f32 v40, v40, v41
    v_mfma_f32_16x16x32_bf16 v[112:115], v[104:107], v[48:51], 0
    v_mov_b64 v[72:73], 0
    v_mfma_f32_16x16x32_bf16 v[116:119], v[108:111], v[48:51], 0
    v_mov_b64 v[74:75], 0
    v_mfma_f32_16x16x32_bf16 v[112:115], v[56:59], v[52:55], v[112:115]
    v_mov_b64 v[76:77], 0
    v_mfma_f32_16x16x32_bf16 v[116:119], v[60:63], v[52:55], v[116:119]
    v_add_f32_dpp v40, v40, v40 row_ror:8 row_mask:0xf bank_mask:0xf
    v_mov_b32 v41, v40
    v_mov_b64 v[78:79], 0
    v_mov_b64 v[80:81], 0
    v_permlane16_swap_b32 v40, v41
    v_add_f32 v40, v40, v41
    v_mov_b32 v41, v40
    v_mov_b64 v[82:83], 0
    v_mov_b64 v[84:85], 0
    v_permlane32_swap_b32 v40, v41
    v_add_f32 v40, v40, v41
    v_rcp_f32 v40, v40
    s_add_u32 s29, s29, 1
    v_mov_b32 v41, v40
    v_pk_mul_f32 v[112:113], v[112:113], v[40:41]
    v_pk_mul_f32 v[114:115], v[114:115], v[40:41]
    v_pk_mul_f32 v[116:117], v[116:117], v[40:41]
    v_pk_mul_f32 v[118:119], v[118:119], v[40:41]
    v_cvt_pk_bf16_f32 v120, v112, v113
    v_cvt_pk_bf16_f32 v121, v116, v117
    v_cvt_pk_bf16_f32 v122, v114, v115
    v_cvt_pk_bf16_f32 v123, v118, v119
    ds_write_b64 v127, v[120:121]
    ds_write_b64 v127, v[122:123] offset:128
    s_waitcnt lgkmcnt(0)
    s_barrier
    ds_read_b128 v[40:43], v4 offset:20480
    ds_read_b128 v[44:47], v4 offset:21504
    v_mov_b64 v[86:87], 0
    v_mov_b64 v[88:89], 0
    v_mov_b64 v[90:91], 0
    v_mov_b64 v[92:93], 0
    v_mov_b64 v[94:95], 0
    s_lshl_b32 s25, s29, 18
    s_add_u32 s25, s25, s30
    s_add_u32 s26, s25, 41943040
    buffer_load_dwordx4 v[96:99], v4, s[8:11], s26 offen
    buffer_load_dwordx4 v[100:103], v4, s[8:11], s26 offen offset:1024
    s_add_u32 s26, s25, 58720256
    buffer_load_dwordx4 v[104:107], v4, s[8:11], s26 offen
    buffer_load_dwordx4 v[108:111], v4, s[8:11], s26 offen offset:1024
    s_waitcnt lgkmcnt(0)
    v_smfmac_f32_16x16x64_bf16 v[64:67], v[40:43], v[128:135], v126
    v_smfmac_f32_16x16x64_bf16 v[64:67], v[44:47], v[136:143], v126
    v_smfmac_f32_16x16x64_bf16 v[68:71], v[40:43], v[144:151], v126
    v_smfmac_f32_16x16x64_bf16 v[68:71], v[44:47], v[152:159], v126
    v_smfmac_f32_16x16x64_bf16 v[72:75], v[40:43], v[160:167], v126
    v_smfmac_f32_16x16x64_bf16 v[72:75], v[44:47], v[168:175], v126
    v_smfmac_f32_16x16x64_bf16 v[76:79], v[40:43], v[176:183], v126
    v_smfmac_f32_16x16x64_bf16 v[76:79], v[44:47], v[184:191], v126
    v_smfmac_f32_16x16x64_bf16 v[80:83], v[40:43], v[192:199], v126
    v_smfmac_f32_16x16x64_bf16 v[80:83], v[44:47], v[200:207], v126
    v_smfmac_f32_16x16x64_bf16 v[84:87], v[40:43], v[208:215], v126
    v_smfmac_f32_16x16x64_bf16 v[84:87], v[44:47], v[216:223], v126
    v_permlane32_swap_b32 v64, v68
    v_permlane32_swap_b32 v65, v69
    v_smfmac_f32_16x16x64_bf16 v[88:91], v[40:43], v[224:231], v126
    v_smfmac_f32_16x16x64_bf16 v[88:91], v[44:47], v[232:239], v126
    v_permlane32_swap_b32 v66, v70
    v_permlane32_swap_b32 v67, v71
    v_smfmac_f32_16x16x64_bf16 v[92:95], v[40:43], v[240:247], v126
    v_smfmac_f32_16x16x64_bf16 v[92:95], v[44:47], v[248:255], v126
    v_pk_add_f32 v[64:65], v[64:65], v[68:69]
    v_pk_add_f32 v[66:67], v[66:67], v[70:71]
    v_cvt_pk_bf16_f32 v64, v64, v65
    v_cvt_pk_bf16_f32 v65, v66, v67
    v_min_u32 v64, 0xfffffffe, v64
    v_min_u32 v65, 0xfffffffe, v65
    buffer_store_dwordx2 v[64:65], v7, s[8:11], s52 offen
    v_permlane32_swap_b32 v72, v76
    v_permlane32_swap_b32 v73, v77
    v_permlane32_swap_b32 v74, v78
    v_permlane32_swap_b32 v75, v79
    v_pk_add_f32 v[72:73], v[72:73], v[76:77]
    v_pk_add_f32 v[74:75], v[74:75], v[78:79]
    v_cvt_pk_bf16_f32 v72, v72, v73
    v_cvt_pk_bf16_f32 v73, v74, v75
    v_min_u32 v72, 0xfffffffe, v72
    v_min_u32 v73, 0xfffffffe, v73
    buffer_store_dwordx2 v[72:73], v7, s[8:11], s53 offen
    v_permlane32_swap_b32 v80, v84
    v_permlane32_swap_b32 v81, v85
    v_permlane32_swap_b32 v82, v86
    v_permlane32_swap_b32 v83, v87
    v_pk_add_f32 v[80:81], v[80:81], v[84:85]
    v_pk_add_f32 v[82:83], v[82:83], v[86:87]
    v_cvt_pk_bf16_f32 v80, v80, v81
    v_cvt_pk_bf16_f32 v81, v82, v83
    v_min_u32 v80, 0xfffffffe, v80
    v_min_u32 v81, 0xfffffffe, v81
    buffer_store_dwordx2 v[80:81], v7, s[8:11], s54 offen
    v_permlane32_swap_b32 v88, v92
    v_permlane32_swap_b32 v89, v93
    v_permlane32_swap_b32 v90, v94
    v_permlane32_swap_b32 v91, v95
    v_pk_add_f32 v[88:89], v[88:89], v[92:93]
    v_pk_add_f32 v[90:91], v[90:91], v[94:95]
    v_cvt_pk_bf16_f32 v88, v88, v89
    v_cvt_pk_bf16_f32 v89, v90, v91
    v_min_u32 v88, 0xfffffffe, v88
    v_min_u32 v89, 0xfffffffe, v89
    buffer_store_dwordx2 v[88:89], v7, s[8:11], s55 offen
    buffer_load_dwordx2 v[8:9], v124, s[8:11], s33 offen offset:0 sc1
    buffer_load_dwordx2 v[10:11], v124, s[8:11], s33 offen offset:256 sc1
    buffer_load_dwordx2 v[12:13], v124, s[8:11], s33 offen offset:512 sc1
    buffer_load_dwordx2 v[14:15], v124, s[8:11], s33 offen offset:768 sc1
    s_waitcnt vmcnt(0)
    v_max3_u32 v16, v8, v9, v10
    v_max3_u32 v17, v11, v12, v13
    v_max3_u32 v16, v16, v14, v15
    v_max_u32 v16, v16, v17
    v_cmp_eq_u32 vcc, -1, v16
    s_cbranch_vccz L_partok_23
L_partpoll_22:
    buffer_load_dwordx2 v[8:9], v124, s[8:11], s33 offen offset:0 sc1
    buffer_load_dwordx2 v[10:11], v124, s[8:11], s33 offen offset:256 sc1
    buffer_load_dwordx2 v[12:13], v124, s[8:11], s33 offen offset:512 sc1
    buffer_load_dwordx2 v[14:15], v124, s[8:11], s33 offen offset:768 sc1
    s_add_u32 s27, s27, 1
    s_cmp_gt_u32 s27, 4194304
    s_cbranch_scc1 L_fused_done_1
    s_waitcnt vmcnt(0)
    v_max3_u32 v16, v8, v9, v10
    v_max3_u32 v17, v11, v12, v13
    v_max3_u32 v16, v16, v14, v15
    v_max_u32 v16, v16, v17
    v_cmp_eq_u32 vcc, -1, v16
    s_cbranch_vccnz L_partpoll_22
L_partok_23:
    v_lshlrev_b32 v20, 16, v8
    v_and_b32 v21, 0xffff0000, v8
    v_lshlrev_b32 v22, 16, v9
    v_and_b32 v23, 0xffff0000, v9
    v_lshlrev_b32 v24, 16, v10
    v_and_b32 v25, 0xffff0000, v10
    v_lshlrev_b32 v26, 16, v11
    v_and_b32 v27, 0xffff0000, v11
    v_lshlrev_b32 v28, 16, v12
    v_and_b32 v29, 0xffff0000, v12
    v_lshlrev_b32 v30, 16, v13
    v_and_b32 v31, 0xffff0000, v13
    v_lshlrev_b32 v32, 16, v14
    v_and_b32 v33, 0xffff0000, v14
    v_lshlrev_b32 v34, 16, v15
    v_and_b32 v35, 0xffff0000, v15
    v_pk_add_f32 v[20:21], v[20:21], v[24:25]
    v_pk_add_f32 v[28:29], v[28:29], v[32:33]
    v_pk_add_f32 v[22:23], v[22:23], v[26:27]
    v_pk_add_f32 v[30:31], v[30:31], v[34:35]
    v_pk_add_f32 v[20:21], v[20:21], v[28:29]
    v_pk_add_f32 v[22:23], v[22:23], v[30:31]
    s_nop 0
    v_permlane32_swap_b32 v20, v21
    v_permlane32_swap_b32 v22, v23
    v_add_f32 v20, v20, v21
    v_add_f32 v22, v22, v23
    s_mov_b32 s39, s33
    s_mov_b32 s49, s36
    v_permlane16_swap_b32 v20, v22
    v_add_f32 v20, v20, v22
    s_nop 1
    v_add_f32_dpp v20, v20, v20 row_ror:8 row_mask:0xf bank_mask:0xf
    s_nop 1
    v_mov_b32_dpp v21, v20 quad_perm:[1,0,3,2] row_mask:0xf bank_mask:0xf
    v_cvt_pk_bf16_f32 v20, v20, v21
    v_min_u32 v20, 0xfffffffe, v20
    s_mov_b64 exec, s[46:47]
    buffer_store_dword v20, v125, s[8:11], s35 offen
    s_mov_b64 exec, -1
    s_mov_b32 s32, s35
    s_branch L_step_14
L_slowloop_12:
    s_and_b32 s25, s29, 1
    s_lshl_b32 s25, s25, 18
    s_add_u32 s33, s25, 121634816
    s_lshl_b32 s25, s20, 16
    s_add_u32 s34, s33, s25
    s_add_u32 s26, s29, 1
    s_mul_i32 s25, s26, 21846
    s_lshr_b32 s25, s25, 16
    s_mul_i32 s25, s25, 3
    s_sub_u32 s25, s26, s25
    s_lshl_b32 s35, s25, 13
    s_add_u32 s35, s35, 122159104
    s_add_u32 s25, s25, 2
    s_cmp_ge_u32 s25, 3
    s_cselect_b32 s26, 3, 0
    s_sub_u32 s25, s25, s26
    s_lshl_b32 s36, s25, 13
    s_add_u32 s36, s36, 122159104
    s_lshl_b32 s25, s29, 17
    s_add_u32 s25, s25, s31
    s_add_u32 s37, s25, 75497472
    s_add_u32 s38, s25, 83886080
    s_add_u32 s52, s34, 0
    s_add_u32 s53, s34, 16384
    s_add_u32 s54, s34, 32768
    s_add_u32 s55, s34, 49152
    s_branch L_qkv_24
L_step_25:
    buffer_load_dwordx4 v[8:11], v5, s[8:11], s32 offen sc1
    buffer_load_dwordx4 v[12:15], v5, s[8:11], s32 offen offset:1024 sc1
    v_mov_b64 v[40:41], 0
    v_mov_b64 v[42:43], 0
    v_mov_b64 v[44:45], 0
    v_mov_b64 v[46:47], 0
    v_mov_b64 v[48:49], 0
    v_mov_b64 v[50:51], 0
    v_mov_b64 v[52:53], 0
    v_mov_b64 v[54:55], 0
    v_mov_b64 v[56:57], 0
    v_mov_b64 v[58:59], 0
    v_mov_b64 v[60:61], 0
    v_mov_b64 v[62:63], 0
    s_and_b32 s25, s29, 1
    s_lshl_b32 s25, s25, 18
    s_add_u32 s33, s25, 121634816
    s_lshl_b32 s25, s20, 16
    s_add_u32 s34, s33, s25
    s_add_u32 s26, s29, 1
    s_mul_i32 s25, s26, 21846
    s_lshr_b32 s25, s25, 16
    s_mul_i32 s25, s25, 3
    s_sub_u32 s25, s26, s25
    s_lshl_b32 s35, s25, 13
    s_add_u32 s35, s35, 122159104
    s_add_u32 s25, s25, 2
    s_cmp_ge_u32 s25, 3
    s_cselect_b32 s26, 3, 0
    s_sub_u32 s25, s25, s26
    s_lshl_b32 s36, s25, 13
    s_add_u32 s36, s36, 122159104
    s_lshl_b32 s25, s29, 17
    s_add_u32 s25, s25, s31
    s_add_u32 s37, s25, 75497472
    s_add_u32 s38, s25, 83886080
    s_add_u32 s52, s34, 0
    s_add_u32 s53, s34, 16384
    s_add_u32 s54, s34, 32768
    s_add_u32 s55, s34, 49152
    s_waitcnt vmcnt(0)
    v_max3_u32 v16, v8, v9, v10
    v_max3_u32 v17, v11, v12, v13
    v_max3_u32 v16, v16, v14, v15
    v_max_u32 v16, v16, v17
    v_cmp_eq_u32 vcc, -1, v16
    s_cbranch_vccz L_memok_27
L_mempoll_26:
    buffer_load_dwordx4 v[8:11], v5, s[8:11], s32 offen sc1
    buffer_load_dwordx4 v[12:15], v5, s[8:11], s32 offen offset:1024 sc1
    s_add_u32 s27, s27, 1
    s_cmp_gt_u32 s27, 4194304
    s_cbranch_scc1 L_fused_done_1
    s_waitcnt vmcnt(0)
    v_max3_u32 v16, v8, v9, v10
    v_max3_u32 v17, v11, v12, v13
    v_max3_u32 v16, v16, v14, v15
    v_max_u32 v16, v16, v17
    v_cmp_eq_u32 vcc, -1, v16
    s_cbranch_vccnz L_mempoll_26
L_memok_27:
    ds_write_b128 v5, v[8:11]
    ds_write_b128 v5, v[12:15] offset:1024
    v_mov_b32 v120, -1
    v_mov_b32 v121, -1
    buffer_store_dwordx2 v[120:121], v124, s[8:11], s39 offen offset:0 sc1
    buffer_store_dwordx2 v[120:121], v124, s[8:11], s39 offen offset:256 sc1
    buffer_store_dwordx2 v[120:121], v124, s[8:11], s39 offen offset:512 sc1
    buffer_store_dwordx2 v[120:121], v124, s[8:11], s39 offen offset:768 sc1
    s_mov_b64 exec, s[46:47]
    buffer_store_dword v120, v125, s[8:11], s49 offen sc1
    s_mov_b64 exec, -1
    s_waitcnt lgkmcnt(0)
    s_barrier
    ds_read_b128 v[8:11], v4 offset:0
    ds_read_b128 v[12:15], v4 offset:1024
    ds_read_b128 v[16:19], v4 offset:2048
    ds_read_b128 v[20:23], v4 offset:3072
    ds_read_b128 v[24:27], v4 offset:4096
    ds_read_b128 v[28:31], v4 offset:5120
    ds_read_b128 v[32:35], v4 offset:6144
    ds_read_b128 v[36:39], v4 offset:7168
L_qkv_24:
    ds_read_b128 v[64:67], v1 offset:0
    ds_read_b128 v[68:71], v1 offset:1024
    ds_read_b128 v[72:75], v1 offset:16384
    ds_read_b128 v[76:79], v1 offset:17408
    ds_read_b128 v[80:83], v1 offset:2048
    ds_read_b128 v[84:87], v1 offset:3072
    ds_read_b128 v[88:91], v1 offset:18432
    ds_read_b128 v[92:95], v1 offset:19456
    s_waitcnt lgkmcnt(15)
    v_smfmac_f32_16x16x64_bf16 v[40:43], v[8:11], a[0:7], v126
    v_smfmac_f32_16x16x64_bf16 v[48:51], v[8:11], a[128:135], v126
    v_smfmac_f32_16x16x64_bf16 v[44:47], v[8:11], a[64:71], v126
    v_smfmac_f32_16x16x64_bf16 v[52:55], v[8:11], a[192:199], v126
    s_waitcnt lgkmcnt(14)
    v_smfmac_f32_16x16x64_bf16 v[40:43], v[12:15], a[8:15], v126
    v_smfmac_f32_16x16x64_bf16 v[48:51], v[12:15], a[136:143], v126
    v_smfmac_f32_16x16x64_bf16 v[44:47], v[12:15], a[72:79], v126
    v_smfmac_f32_16x16x64_bf16 v[52:55], v[12:15], a[200:207], v126
    s_waitcnt lgkmcnt(13)
    v_smfmac_f32_16x16x64_bf16 v[40:43], v[16:19], a[16:23], v126
    v_smfmac_f32_16x16x64_bf16 v[48:51], v[16:19], a[144:151], v126
    v_smfmac_f32_16x16x64_bf16 v[44:47], v[16:19], a[80:87], v126
    v_smfmac_f32_16x16x64_bf16 v[52:55], v[16:19], a[208:215], v126
    s_cmp_eq_u32 s29, 0
    s_cbranch_scc1 L_noflag_28
    s_lshl_b32 s25, s29, 9
    s_lshr_b32 s26, s31, 8
    s_add_u32 s25, s25, s26
    s_add_u32 s25, s25, 122748416
    v_mov_b32 v120, 0
    v_mov_b32 v121, 1
    s_mov_b64 exec, 1
    buffer_store_dword v121, v120, s[8:11], s25 offen sc1
    s_mov_b64 exec, -1
L_noflag_28:
    s_waitcnt lgkmcnt(12)
    v_smfmac_f32_16x16x64_bf16 v[40:43], v[20:23], a[24:31], v126
    v_smfmac_f32_16x16x64_bf16 v[48:51], v[20:23], a[152:159], v126
    v_smfmac_f32_16x16x64_bf16 v[44:47], v[20:23], a[88:95], v126
    v_smfmac_f32_16x16x64_bf16 v[52:55], v[20:23], a[216:223], v126
    s_waitcnt lgkmcnt(11)
    v_smfmac_f32_16x16x64_bf16 v[40:43], v[24:27], a[32:39], v126
    v_smfmac_f32_16x16x64_bf16 v[48:51], v[24:27], a[160:167], v126
    v_smfmac_f32_16x16x64_bf16 v[44:47], v[24:27], a[96:103], v126
    v_smfmac_f32_16x16x64_bf16 v[52:55], v[24:27], a[224:231], v126
    s_cmp_ge_u32 s93, 1024
    s_cbranch_scc1 L_kvok_29
    s_add_u32 s92, s29, 2
    s_and_b32 s25, s92, 3
    s_cmp_lg_u32 s25, 0
    s_cbranch_scc1 L_kvpf_30
    s_cmp_ge_u32 s92, 64
    s_cbranch_scc1 L_kvok_29
    v_mov_b32 v122, 29696
    ds_read_b64 v[120:121], v122
    s_waitcnt lgkmcnt(0)
    v_readfirstlane_b32 s26, v120
    v_readfirstlane_b32 s93, v121
    s_cmp_ge_u32 s26, 64
    s_cbranch_scc1 L_kvok_29
    s_lshr_b32 s25, s92, 2
    s_lshl_b32 s25, s25, 7
    s_add_u32 s25, s25, 122736640
    v_mov_b32 v120, 0
L_kvwait_32:
    buffer_load_dword v121, v120, s[8:11], s25 offen sc1
    s_mov_b32 s26, 122738688
    buffer_load_dword v122, v120, s[8:11], s26 offen sc1
    s_add_u32 s27, s27, 1
    s_cmp_gt_u32 s27, 4194304
    s_cbranch_scc1 L_fused_done_1
    s_waitcnt vmcnt(0)
    v_readfirstlane_b32 s26, v121
    v_readfirstlane_b32 s93, v122
    s_cmp_lt_u32 s26, 64
    s_cbranch_scc1 L_kvwait_32
    s_branch L_kvok_29
L_kvpf_30:
    s_cmp_lg_u32 s25, 3
    s_cbranch_scc1 L_kvok_29
    s_add_u32 s25, s92, 1
    s_lshr_b32 s25, s25, 2
    s_lshl_b32 s25, s25, 7
    s_add_u32 s25, s25, 122736640
    v_mov_b32 v120, 122738688
    s_mov_b64 exec, 1
    v_mov_b32 v120, s25
    s_mov_b64 exec, 3
    s_mov_b32 m0, 29696
    s_nop 0
    buffer_load_dword v120, s[8:11], 0 offen sc1 lds
    s_mov_b64 exec, -1
L_kvok_29:
    v_and_b32 v120, 0xf0, v4
    v_lshlrev_b32 v120, 3, v120
    v_bfe_u32 v121, v4, 8, 1
    v_lshl_add_u32 v120, v121, 24, v120
    s_add_u32 s25, s29, 2
    s_lshl_b32 s25, s25, 18
    s_add_u32 s25, s25, s30
    s_add_u32 s25, s25, 41943040
    s_mov_b32 m0, 28672
    s_nop 0
    buffer_load_dword v120, s[8:11], s25 offen lds
    s_waitcnt lgkmcnt(10)
    v_smfmac_f32_16x16x64_bf16 v[40:43], v[28:31], a[40:47], v126
    v_smfmac_f32_16x16x64_bf16 v[48:51], v[28:31], a[168:175], v126
    v_smfmac_f32_16x16x64_bf16 v[44:47], v[28:31], a[104:111], v126
    v_smfmac_f32_16x16x64_bf16 v[52:55], v[28:31], a[232:239], v126
    s_waitcnt lgkmcnt(9)
    v_smfmac_f32_16x16x64_bf16 v[40:43], v[32:35], a[48:55], v126
    v_smfmac_f32_16x16x64_bf16 v[48:51], v[32:35], a[176:183], v126
    v_smfmac_f32_16x16x64_bf16 v[44:47], v[32:35], a[112:119], v126
    v_smfmac_f32_16x16x64_bf16 v[52:55], v[32:35], a[240:247], v126
    s_waitcnt lgkmcnt(8)
    v_smfmac_f32_16x16x64_bf16 v[40:43], v[36:39], a[56:63], v126
    v_smfmac_f32_16x16x64_bf16 v[48:51], v[36:39], a[184:191], v126
    v_smfmac_f32_16x16x64_bf16 v[44:47], v[36:39], a[120:127], v126
    v_smfmac_f32_16x16x64_bf16 v[52:55], v[36:39], a[248:255], v126
    v_add_u32 v123, s43, v4
    s_waitcnt lgkmcnt(6)
    v_smfmac_f32_16x16x64_bf16 v[56:59], v[8:11], v[64:71], v126
    ds_read_b128 v[64:67], v1 offset:4096
    ds_read_b128 v[68:71], v1 offset:5120
    s_waitcnt lgkmcnt(6)
    v_smfmac_f32_16x16x64_bf16 v[60:63], v[8:11], v[72:79], v126
    ds_read_b128 v[72:75], v1 offset:20480
    ds_read_b128 v[76:79], v1 offset:21504
    s_waitcnt lgkmcnt(6)
    v_smfmac_f32_16x16x64_bf16 v[56:59], v[12:15], v[80:87], v126
    ds_read_b128 v[80:83], v1 offset:6144
    ds_read_b128 v[84:87], v1 offset:7168
    s_waitcnt lgkmcnt(6)
    v_smfmac_f32_16x16x64_bf16 v[60:63], v[12:15], v[88:95], v126
    ds_read_b128 v[88:91], v1 offset:22528
    ds_read_b128 v[92:95], v1 offset:23552
    v_permlane32_swap_b32 v40, v44
    v_permlane32_swap_b32 v48, v52
    s_waitcnt lgkmcnt(6)
    v_smfmac_f32_16x16x64_bf16 v[56:59], v[16:19], v[64:71], v126
    ds_read_b128 v[64:67], v1 offset:8192
    ds_read_b128 v[68:71], v1 offset:9216
    v_permlane32_swap_b32 v41, v45
    v_permlane32_swap_b32 v49, v53
    s_waitcnt lgkmcnt(6)
    v_smfmac_f32_16x16x64_bf16 v[60:63], v[16:19], v[72:79], v126
    ds_read_b128 v[72:75], v1 offset:24576
    ds_read_b128 v[76:79], v1 offset:25600
    v_permlane32_swap_b32 v42, v46
    v_permlane32_swap_b32 v50, v54
    s_waitcnt lgkmcnt(6)
    v_smfmac_f32_16x16x64_bf16 v[56:59], v[20:23], v[80:87], v126
    ds_read_b128 v[80:83], v1 offset:10240
    ds_read_b128 v[84:87], v1 offset:11264
    v_permlane32_swap_b32 v43, v47
    v_permlane32_swap_b32 v51, v55
    s_waitcnt lgkmcnt(6)
    v_smfmac_f32_16x16x64_bf16 v[60:63], v[20:23], v[88:95], v126
    ds_read_b128 v[88:91], v1 offset:26624
    ds_read_b128 v[92:95], v1 offset:27648
    v_pk_add_f32 v[40:41], v[40:41], v[44:45]
    v_pk_add_f32 v[42:43], v[42:43], v[46:47]
    v_pk_add_f32 v[48:49], v[48:49], v[52:53]
    v_pk_add_f32 v[50:51], v[50:51], v[54:55]
    v_cvt_pk_bf16_f32 v44, v40, v41
    v_cvt_pk_bf16_f32 v45, v42, v43
    v_cvt_pk_bf16_f32 v52, v48, v49
    v_cvt_pk_bf16_f32 v53, v50, v51
    ds_write_b64 v6, v[44:45]
    ds_write_b64 v6, v[52:53] offset:512
    s_waitcnt lgkmcnt(8)
    v_smfmac_f32_16x16x64_bf16 v[56:59], v[24:27], v[64:71], v126
    ds_read_b128 v[64:67], v1 offset:12288
    ds_read_b128 v[68:71], v1 offset:13312
    s_waitcnt lgkmcnt(8)
    v_smfmac_f32_16x16x64_bf16 v[60:63], v[24:27], v[72:79], v126
    ds_read_b128 v[72:75], v1 offset:28672
    ds_read_b128 v[76:79], v1 offset:29696
    s_waitcnt lgkmcnt(4)
    ds_read_b64_tr_b16 v[40:41], v0
    ds_read_b64_tr_b16 v[42:43], v0 offset:256
    ds_read_b64_tr_b16 v[48:49], v0 offset:512
    ds_read_b64_tr_b16 v[50:51], v0 offset:768
    v_smfmac_f32_16x16x64_bf16 v[56:59], v[28:31], v[80:87], v126
    ds_read_b128 v[80:83], v1 offset:14336
    ds_read_b128 v[84:87], v1 offset:15360
    v_smfmac_f32_16x16x64_bf16 v[60:63], v[28:31], v[88:95], v126
    ds_read_b128 v[88:91], v1 offset:30720
    ds_read_b128 v[92:95], v1 offset:31744
    s_waitcnt lgkmcnt(4)
    v_mfma_f32_16x16x32_bf16 v[112:115], v[48:51], v[40:43], 0
    v_mfma_f32_16x16x32_bf16 v[116:119], v[96:99], v[40:43], 0
    v_mov_b32 v44, v123
    v_mfma_f32_16x16x32_bf16 v[120:123], v[100:103], v[40:43], 0
    buffer_store_dwordx4 v[48:51], v4, s[8:11], s37 offen sc1
    v_smfmac_f32_16x16x64_bf16 v[56:59], v[32:35], v[64:71], v126
    v_smfmac_f32_16x16x64_bf16 v[60:63], v[32:35], v[72:79], v126
    s_waitcnt lgkmcnt(2)
    v_smfmac_f32_16x16x64_bf16 v[56:59], v[36:39], v[80:87], v126
    s_waitcnt lgkmcnt(0)
    v_smfmac_f32_16x16x64_bf16 v[60:63], v[36:39], v[88:95], v126
    s_nop 3
    ds_write_b128 v44, v[112:115] offset:8192
    ds_write_b128 v44, v[116:119] offset:9216
    ds_write_b128 v44, v[120:123] offset:10240
    s_waitcnt lgkmcnt(0)
    s_barrier
    ds_read_b128 v[8:11], v2 offset:8192
    ds_read_b64 v[12:13], v3 offset:8192
    ds_read_b128 v[14:17], v2 offset:11264
    ds_read_b64 v[18:19], v3 offset:11264
    ds_read_b128 v[20:23], v2 offset:14336
    ds_read_b64 v[24:25], v3 offset:14336
    ds_read_b128 v[26:29], v2 offset:17408
    ds_read_b64 v[30:31], v3 offset:17408
    v_permlane32_swap_b32 v56, v60
    v_permlane32_swap_b32 v57, v61
    v_permlane32_swap_b32 v58, v62
    v_permlane32_swap_b32 v59, v63
    v_pk_add_f32 v[56:57], v[56:57], v[60:61]
    v_pk_add_f32 v[58:59], v[58:59], v[62:63]
    v_cvt_pk_bf16_f32 v56, v56, v57
    v_cvt_pk_bf16_f32 v57, v58, v59
    v_mov_b32 v60, v56
    v_mov_b32 v61, v57
    v_mov_b64 v[58:59], 0
    v_mov_b64 v[62:63], 0
    v_permlane32_swap_b32 v56, v60
    v_permlane32_swap_b32 v57, v61
    v_lshrrev_b32 v46, 1, v4
    buffer_store_dwordx2 v[56:57], v46, s[8:11], s38 offen sc1
    buffer_store_dwordx2 v[60:61], v46, s[8:11], s38 offen offset:512 sc1
    s_cmp_eq_u32 s29, 63
    s_cbranch_scc1 L_chain_last_11
    s_waitcnt lgkmcnt(0)
    v_pk_add_f32 v[8:9], v[8:9], v[14:15]
    v_pk_add_f32 v[20:21], v[20:21], v[26:27]
    v_pk_add_f32 v[10:11], v[10:11], v[16:17]
    v_pk_add_f32 v[22:23], v[22:23], v[28:29]
    v_pk_add_f32 v[12:13], v[12:13], v[18:19]
    v_pk_add_f32 v[24:25], v[24:25], v[30:31]
    v_pk_add_f32 v[112:113], v[8:9], v[20:21]
    v_pk_add_f32 v[114:115], v[10:11], v[22:23]
    v_pk_add_f32 v[116:117], v[12:13], v[24:25]
    v_mov_b32 v40, 0xff800000
    v_cndmask_b32 v116, v40, v116, s[44:45]
    v_cndmask_b32 v117, v40, v117, s[44:45]
    v_max3_f32 v40, v112, v113, v114
    v_max3_f32 v41, v115, v116, v117
    v_max_f32 v40, v40, v41
    v_mov_b32 v42, 0x3e0293ee
    v_mov_b32 v43, 0x3e0293ee
    v_max_f32_dpp v40, v40, v40 row_ror:8 row_mask:0xf bank_mask:0xf
    v_mov_b32 v41, v40
    v_mov_b64 v[64:65], 0
    v_mov_b64 v[66:67], 0
    v_permlane16_swap_b32 v40, v41
    v_max_f32 v40, v40, v41
    v_mov_b32 v41, v40
    v_mov_b64 v[68:69], 0
    v_mov_b64 v[70:71], 0
    v_permlane32_swap_b32 v40, v41
    v_max_f32 v40, v40, v41
    v_mul_f32 v40, 0xbe0293ee, v40
    v_mov_b32 v41, v40
    v_pk_fma_f32 v[112:113], v[112:113], v[42:43], v[40:41]
    v_pk_fma_f32 v[114:115], v[114:115], v[42:43], v[40:41]
    v_pk_fma_f32 v[116:117], v[116:117], v[42:43], v[40:41]
    v_exp_f32 v112, v112
    v_exp_f32 v113, v113
    v_exp_f32 v114, v114
    v_exp_f32 v115, v115
    v_exp_f32 v116, v116
    v_exp_f32 v117, v117
    v_mov_b64 v[54:55], 0
    v_cvt_pk_bf16_f32 v48, v112, v113
    v_cvt_pk_bf16_f32 v49, v114, v115
    v_cvt_pk_bf16_f32 v52, v116, v117
    v_pk_add_f32 v[40:41], v[112:113], v[114:115]
    v_mov_b32_dpp v50, v48 row_ror:8 row_mask:0xf bank_mask:0xf
    v_mov_b32_dpp v51, v49 row_ror:8 row_mask:0xf bank_mask:0xf
    v_mov_b32_dpp v53, v52 row_ror:8 row_mask:0xf bank_mask:0xf
    v_pk_add_f32 v[40:41], v[40:41], v[116:117]
    v_add_f32 v40, v40, v41
    v_mfma_f32_16x16x32_bf16 v[112:115], v[104:107], v[48:51], 0
    v_mov_b64 v[72:73], 0
    v_mfma_f32_16x16x32_bf16 v[116:119], v[108:111], v[48:51], 0
    v_mov_b64 v[74:75], 0
    v_mfma_f32_16x16x32_bf16 v[112:115], v[56:59], v[52:55], v[112:115]
    v_mov_b64 v[76:77], 0
    v_mfma_f32_16x16x32_bf16 v[116:119], v[60:63], v[52:55], v[116:119]
    v_add_f32_dpp v40, v40, v40 row_ror:8 row_mask:0xf bank_mask:0xf
    v_mov_b32 v41, v40
    v_mov_b64 v[78:79], 0
    v_mov_b64 v[80:81], 0
    v_permlane16_swap_b32 v40, v41
    v_add_f32 v40, v40, v41
    v_mov_b32 v41, v40
    v_mov_b64 v[82:83], 0
    v_mov_b64 v[84:85], 0
    v_permlane32_swap_b32 v40, v41
    v_add_f32 v40, v40, v41
    v_rcp_f32 v40, v40
    s_add_u32 s29, s29, 1
    v_mov_b32 v41, v40
    v_pk_mul_f32 v[112:113], v[112:113], v[40:41]
    v_pk_mul_f32 v[114:115], v[114:115], v[40:41]
    v_pk_mul_f32 v[116:117], v[116:117], v[40:41]
    v_pk_mul_f32 v[118:119], v[118:119], v[40:41]
    v_cvt_pk_bf16_f32 v120, v112, v113
    v_cvt_pk_bf16_f32 v121, v116, v117
    v_cvt_pk_bf16_f32 v122, v114, v115
    v_cvt_pk_bf16_f32 v123, v118, v119
    ds_write_b64 v127, v[120:121]
    ds_write_b64 v127, v[122:123] offset:128
    s_waitcnt lgkmcnt(0)
    s_barrier
    ds_read_b128 v[40:43], v4 offset:20480
    ds_read_b128 v[44:47], v4 offset:21504
    v_mov_b64 v[86:87], 0
    v_mov_b64 v[88:89], 0
    v_mov_b64 v[90:91], 0
    v_mov_b64 v[92:93], 0
    v_mov_b64 v[94:95], 0
    s_lshl_b32 s25, s29, 18
    s_add_u32 s25, s25, s30
    s_add_u32 s26, s25, 41943040
    buffer_load_dwordx4 v[96:99], v4, s[8:11], s26 offen
    buffer_load_dwordx4 v[100:103], v4, s[8:11], s26 offen offset:1024
    s_add_u32 s26, s25, 58720256
    buffer_load_dwordx4 v[104:107], v4, s[8:11], s26 offen
    buffer_load_dwordx4 v[108:111], v4, s[8:11], s26 offen offset:1024
    s_waitcnt lgkmcnt(0)
    v_smfmac_f32_16x16x64_bf16 v[64:67], v[40:43], v[128:135], v126
    v_smfmac_f32_16x16x64_bf16 v[64:67], v[44:47], v[136:143], v126
    v_smfmac_f32_16x16x64_bf16 v[68:71], v[40:43], v[144:151], v126
    v_smfmac_f32_16x16x64_bf16 v[68:71], v[44:47], v[152:159], v126
    v_smfmac_f32_16x16x64_bf16 v[72:75], v[40:43], v[160:167], v126
    v_smfmac_f32_16x16x64_bf16 v[72:75], v[44:47], v[168:175], v126
    v_smfmac_f32_16x16x64_bf16 v[76:79], v[40:43], v[176:183], v126
    v_smfmac_f32_16x16x64_bf16 v[76:79], v[44:47], v[184:191], v126
    v_smfmac_f32_16x16x64_bf16 v[80:83], v[40:43], v[192:199], v126
    v_smfmac_f32_16x16x64_bf16 v[80:83], v[44:47], v[200:207], v126
    v_smfmac_f32_16x16x64_bf16 v[84:87], v[40:43], v[208:215], v126
    v_smfmac_f32_16x16x64_bf16 v[84:87], v[44:47], v[216:223], v126
    v_permlane32_swap_b32 v64, v68
    v_permlane32_swap_b32 v65, v69
    v_smfmac_f32_16x16x64_bf16 v[88:91], v[40:43], v[224:231], v126
    v_smfmac_f32_16x16x64_bf16 v[88:91], v[44:47], v[232:239], v126
    v_permlane32_swap_b32 v66, v70
    v_permlane32_swap_b32 v67, v71
    v_smfmac_f32_16x16x64_bf16 v[92:95], v[40:43], v[240:247], v126
    v_smfmac_f32_16x16x64_bf16 v[92:95], v[44:47], v[248:255], v126
    v_pk_add_f32 v[64:65], v[64:65], v[68:69]
    v_pk_add_f32 v[66:67], v[66:67], v[70:71]
    v_cvt_pk_bf16_f32 v64, v64, v65
    v_cvt_pk_bf16_f32 v65, v66, v67
    v_min_u32 v64, 0xfffffffe, v64
    v_min_u32 v65, 0xfffffffe, v65
    buffer_store_dwordx2 v[64:65], v7, s[8:11], s52 offen sc1
    v_permlane32_swap_b32 v72, v76
    v_permlane32_swap_b32 v73, v77
    v_permlane32_swap_b32 v74, v78
    v_permlane32_swap_b32 v75, v79
    v_pk_add_f32 v[72:73], v[72:73], v[76:77]
    v_pk_add_f32 v[74:75], v[74:75], v[78:79]
    v_cvt_pk_bf16_f32 v72, v72, v73
    v_cvt_pk_bf16_f32 v73, v74, v75
    v_min_u32 v72, 0xfffffffe, v72
    v_min_u32 v73, 0xfffffffe, v73
    buffer_store_dwordx2 v[72:73], v7, s[8:11], s53 offen sc1
    v_permlane32_swap_b32 v80, v84
    v_permlane32_swap_b32 v81, v85
    v_permlane32_swap_b32 v82, v86
    v_permlane32_swap_b32 v83, v87
    v_pk_add_f32 v[80:81], v[80:81], v[84:85]
    v_pk_add_f32 v[82:83], v[82:83], v[86:87]
    v_cvt_pk_bf16_f32 v80, v80, v81
    v_cvt_pk_bf16_f32 v81, v82, v83
    v_min_u32 v80, 0xfffffffe, v80
    v_min_u32 v81, 0xfffffffe, v81
    buffer_store_dwordx2 v[80:81], v7, s[8:11], s54 offen sc1
    v_permlane32_swap_b32 v88, v92
    v_permlane32_swap_b32 v89, v93
    v_permlane32_swap_b32 v90, v94
    v_permlane32_swap_b32 v91, v95
    v_pk_add_f32 v[88:89], v[88:89], v[92:93]
    v_pk_add_f32 v[90:91], v[90:91], v[94:95]
    v_cvt_pk_bf16_f32 v88, v88, v89
    v_cvt_pk_bf16_f32 v89, v90, v91
    v_min_u32 v88, 0xfffffffe, v88
    v_min_u32 v89, 0xfffffffe, v89
    buffer_store_dwordx2 v[88:89], v7, s[8:11], s55 offen sc1
    buffer_load_dwordx2 v[8:9], v124, s[8:11], s33 offen offset:0 sc1
    buffer_load_dwordx2 v[10:11], v124, s[8:11], s33 offen offset:256 sc1
    buffer_load_dwordx2 v[12:13], v124, s[8:11], s33 offen offset:512 sc1
    buffer_load_dwordx2 v[14:15], v124, s[8:11], s33 offen offset:768 sc1
    s_waitcnt vmcnt(0)
    v_max3_u32 v16, v8, v9, v10
    v_max3_u32 v17, v11, v12, v13
    v_max3_u32 v16, v16, v14, v15
    v_max_u32 v16, v16, v17
    v_cmp_eq_u32 vcc, -1, v16
    s_cbranch_vccz L_partok_34
L_partpoll_33:
    buffer_load_dwordx2 v[8:9], v124, s[8:11], s33 offen offset:0 sc1
    buffer_load_dwordx2 v[10:11], v124, s[8:11], s33 offen offset:256 sc1
    buffer_load_dwordx2 v[12:13], v124, s[8:11], s33 offen offset:512 sc1
    buffer_load_dwordx2 v[14:15], v124, s[8:11], s33 offen offset:768 sc1
    s_add_u32 s27, s27, 1
    s_cmp_gt_u32 s27, 4194304
    s_cbranch_scc1 L_fused_done_1
    s_waitcnt vmcnt(0)
    v_max3_u32 v16, v8, v9, v10
    v_max3_u32 v17, v11, v12, v13
    v_max3_u32 v16, v16, v14, v15
    v_max_u32 v16, v16, v17
    v_cmp_eq_u32 vcc, -1, v16
    s_cbranch_vccnz L_partpoll_33
L_partok_34:
    v_lshlrev_b32 v20, 16, v8
    v_and_b32 v21, 0xffff0000, v8
    v_lshlrev_b32 v22, 16, v9
    v_and_b32 v23, 0xffff0000, v9
    v_lshlrev_b32 v24, 16, v10
    v_and_b32 v25, 0xffff0000, v10
    v_lshlrev_b32 v26, 16, v11
    v_and_b32 v27, 0xffff0000, v11
    v_lshlrev_b32 v28, 16, v12
    v_and_b32 v29, 0xffff0000, v12
    v_lshlrev_b32 v30, 16, v13
    v_and_b32 v31, 0xffff0000, v13
    v_lshlrev_b32 v32, 16, v14
    v_and_b32 v33, 0xffff0000, v14
    v_lshlrev_b32 v34, 16, v15
    v_and_b32 v35, 0xffff0000, v15
    v_pk_add_f32 v[20:21], v[20:21], v[24:25]
    v_pk_add_f32 v[28:29], v[28:29], v[32:33]
    v_pk_add_f32 v[22:23], v[22:23], v[26:27]
    v_pk_add_f32 v[30:31], v[30:31], v[34:35]
    v_pk_add_f32 v[20:21], v[20:21], v[28:29]
    v_pk_add_f32 v[22:23], v[22:23], v[30:31]
    s_nop 0
    v_permlane32_swap_b32 v20, v21
    v_permlane32_swap_b32 v22, v23
    v_add_f32 v20, v20, v21
    v_add_f32 v22, v22, v23
    s_mov_b32 s39, s33
    s_mov_b32 s49, s36
    v_permlane16_swap_b32 v20, v22
    v_add_f32 v20, v20, v22
    s_nop 1
    v_add_f32_dpp v20, v20, v20 row_ror:8 row_mask:0xf bank_mask:0xf
    s_nop 1
    v_mov_b32_dpp v21, v20 quad_perm:[1,0,3,2] row_mask:0xf bank_mask:0xf
    v_cvt_pk_bf16_f32 v20, v20, v21
    v_min_u32 v20, 0xfffffffe, v20
    s_mov_b64 exec, s[46:47]
    buffer_store_dword v20, v125, s[8:11], s35 offen sc1
    s_mov_b64 exec, -1
    s_mov_b32 s32, s35
    s_branch L_step_25
L_chain_last_11:
    s_waitcnt vmcnt(0)
    s_mov_b32 s92, 64
    s_lshl_b32 s25, s92, 9
    s_lshr_b32 s26, s31, 8
    s_add_u32 s25, s25, s26
    s_add_u32 s25, s25, 122748416
    v_mov_b32 v20, 0
    v_mov_b32 v21, 1
    s_mov_b64 exec, 1
    buffer_store_dword v21, v20, s[8:11], s25 offen sc1
    s_mov_b64 exec, -1
    s_branch L_fused_done_1
L_worker_6:
    v_and_b32 v1, 63, v0
    v_and_b32 v2, 15, v1
    v_lshrrev_b32 v3, 4, v1
    v_lshlrev_b32 v4, 4, v1
    s_sub_u32 s90, s24, 32
    s_mov_b32 s100, s90
    s_lshl_b32 s3, s90, 2
    s_add_u32 s3, s3, s20
    s_mov_b32 s95, s90
    s_load_dwordx16 s[36:51], s[0:1], 0
    s_load_dwordx8 s[52:59], s[0:1], 64
    s_load_dwordx2 s[76:77], s[0:1], 0
    s_waitcnt lgkmcnt(0)
    s_and_b32 s77, s77, 0xffff
    s_mov_b32 s78, 2097152
    s_mov_b32 s79, 0x00020000
    s_cmp_ge_u32 s3, 536
    s_cbranch_scc1 L_noinit_35
    v_mov_b32 v16, -1
    v_mov_b32 v17, -1
    v_mov_b32 v18, -1
    v_mov_b32 v19, -1
    s_lshl_b32 s4, s3, 10
    s_add_u32 s4, s4, 121634816
    buffer_store_dwordx4 v[16:19], v4, s[8:11], s4 offen sc1
L_noinit_35:
    s_sub_u32 s4, s3, 536
    s_cmp_ge_u32 s4, 96
    s_cbranch_scc1 L_nocnt_36
    v_mov_b32 v16, 0
    v_mov_b32 v17, 0
    v_mov_b32 v18, 0
    v_mov_b32 v19, 0
    s_lshl_b32 s4, s4, 10
    s_add_u32 s4, s4, 122683392
    buffer_store_dwordx4 v[16:19], v4, s[8:11], s4 offen sc1
L_nocnt_36:
    v_lshrrev_b32 v5, 2, v1
    v_lshlrev_b32 v5, 10, v5
    v_and_b32 v6, 3, v1
    v_lshl_add_u32 v140, v6, 8, v5
    s_add_u32 s92, s3, 0
    s_lshl_b32 s60, s92, 10
    buffer_load_dwordx4 v[112:115], v4, s[76:79], s60 offen
    s_add_u32 s93, s3, 896
    s_lshl_b32 s60, s93, 10
    buffer_load_dwordx4 v[116:119], v4, s[76:79], s60 offen
    s_add_u32 s94, s3, 1792
    s_lshl_b32 s60, s94, 10
    buffer_load_dwordx4 v[120:123], v4, s[76:79], s60 offen
    s_add_u32 s98, s3, 0
    s_mul_i32 s21, s20, 4608
    v_lshrrev_b32 v8, 3, v1
    v_and_b32 v9, 7, v1
    v_mul_u32_u24 v10, 144, v8
    v_lshl_add_u32 v10, v9, 4, v10
    v_add_u32 v10, s21, v10
    v_lshrrev_b32 v11, 2, v2
    v_and_b32 v12, 3, v1
    s_mov_b32 s62, -1
    s_cmp_ge_u32 s98, 3072
    s_cbranch_scc1 L_rl_store_37
    s_mov_b32 s27, 0x00020000
    s_mov_b32 s35, 0x7fffffff
    s_cmp_ge_u32 s98, 3072
    s_cbranch_scc1 L_cB_40
    s_lshr_b32 s33, s98, 10
    s_cmp_eq_u32 s33, 1
    s_cselect_b32 s24, s42, s40
    s_cselect_b32 s25, s43, s41
    s_cmp_eq_u32 s33, 2
    s_cselect_b32 s24, s44, s24
    s_cselect_b32 s25, s45, s25
    s_mov_b32 s26, 4194304
    s_mov_b32 s28, 8192
    s_and_b32 s29, s98, 15
    s_lshr_b32 s30, s98, 4
    s_and_b32 s30, s30, 63
    s_mov_b32 s31, 0
    s_mov_b32 s34, 16384
    s_lshl_b32 s32, s33, 22
    s_add_u32 s32, s32, 2097152
    s_branch L_rl_common_39
L_cB_40:
    s_cmp_ge_u32 s98, 4096
    s_cbranch_scc1 L_cC_41
    s_sub_u32 s33, s98, 3072
    s_mov_b32 s24, s46
    s_mov_b32 s25, s47
    s_mov_b32 s26, 4194304
    s_mov_b32 s28, 1024
    s_and_b32 s29, s33, 127
    s_lshr_b32 s30, s33, 7
    s_mov_b32 s31, 1
    s_mov_b32 s34, 131072
    s_mov_b32 s32, 14680064
    s_branch L_rl_common_39
L_cC_41:
    s_cmp_ge_u32 s98, 4800
    s_cbranch_scc1 L_cD_42
    s_sub_u32 s33, s98, 4096
    s_cmp_ge_u32 s33, 352
    s_cselect_b32 s24, s54, s52
    s_cselect_b32 s25, s55, s53
    s_mov_b32 s32, 18874368
    s_cselect_b32 s32, 20971520, s32
    s_cselect_b32 s34, 352, 0
    s_sub_u32 s33, s33, s34
    s_mov_b32 s26, 1409024
    s_mov_b32 s28, 2752
    s_and_b32 s29, s33, 15
    s_lshr_b32 s30, s33, 4
    s_mov_b32 s31, 0
    s_mov_b32 s34, 16384
    s_mov_b32 s35, 1376
    s_branch L_rl_common_39
L_cD_42:
    s_sub_u32 s33, s98, 4800
    s_mov_b32 s24, s56
    s_mov_b32 s25, s57
    s_mul_i32 s30, s33, 1490
    s_lshr_b32 s30, s30, 16
    s_mul_i32 s34, s30, 44
    s_sub_u32 s29, s33, s34
    s_cmp_lt_u32 s29, 43
    s_cselect_b32 s26, 1409024, 0
    s_mov_b32 s28, 1024
    s_mov_b32 s31, 1
    s_mov_b32 s34, 45056
    s_mov_b32 s32, 23068672
L_rl_common_39:
    s_and_b32 s25, s25, 0xffff
    s_lshl_b32 s33, s30, 2
    s_mul_i32 s33, s33, s34
    s_add_u32 s32, s32, s33
    s_lshl_b32 s33, s29, 10
    s_add_u32 s62, s32, s33
    s_mov_b32 s63, s34
    s_mov_b32 s64, s31
    s_lshl_b32 s33, s29, 5
    v_add_u32 v6, s33, v8
    v_mul_lo_u32 v6, v6, s28
    s_lshl_b32 s33, s30, 6
    v_lshl_add_u32 v7, v9, 3, s33
    v_lshl_add_u32 v6, v7, 1, v6
    v_cmp_gt_u32 vcc, s35, v7
    v_mov_b32 v7, 0x7ffffff0
    s_lshl_b32 s33, s28, 3
    v_cndmask_b32 v6, v7, v6, vcc
    s_lshl_b32 s60, s33, 1
    s_add_u32 s61, s60, s33
    buffer_load_dwordx4 v[16:19], v6, s[24:27], 0 offen
    buffer_load_dwordx4 v[20:23], v6, s[24:27], s33 offen
    buffer_load_dwordx4 v[24:27], v6, s[24:27], s60 offen
    buffer_load_dwordx4 v[28:31], v6, s[24:27], s61 offen
    s_add_u32 s98, s98, 896
    s_mov_b32 s65, -1
    s_cmp_ge_u32 s98, 3072
    s_cbranch_scc1 L_rl_store_37
    s_mov_b32 s27, 0x00020000
    s_mov_b32 s35, 0x7fffffff
    s_cmp_ge_u32 s98, 3072
    s_cbranch_scc1 L_cB_44
    s_lshr_b32 s33, s98, 10
    s_cmp_eq_u32 s33, 1
    s_cselect_b32 s24, s42, s40
    s_cselect_b32 s25, s43, s41
    s_cmp_eq_u32 s33, 2
    s_cselect_b32 s24, s44, s24
    s_cselect_b32 s25, s45, s25
    s_mov_b32 s26, 4194304
    s_mov_b32 s28, 8192
    s_and_b32 s29, s98, 15
    s_lshr_b32 s30, s98, 4
    s_and_b32 s30, s30, 63
    s_mov_b32 s31, 0
    s_mov_b32 s34, 16384
    s_lshl_b32 s32, s33, 22
    s_add_u32 s32, s32, 2097152
    s_branch L_rl_common_43
L_cB_44:
    s_cmp_ge_u32 s98, 4096
    s_cbranch_scc1 L_cC_45
    s_sub_u32 s33, s98, 3072
    s_mov_b32 s24, s46
    s_mov_b32 s25, s47
    s_mov_b32 s26, 4194304
    s_mov_b32 s28, 1024
    s_and_b32 s29, s33, 127
    s_lshr_b32 s30, s33, 7
    s_mov_b32 s31, 1
    s_mov_b32 s34, 131072
    s_mov_b32 s32, 14680064
    s_branch L_rl_common_43
L_cC_45:
    s_cmp_ge_u32 s98, 4800
    s_cbranch_scc1 L_cD_46
    s_sub_u32 s33, s98, 4096
    s_cmp_ge_u32 s33, 352
    s_cselect_b32 s24, s54, s52
    s_cselect_b32 s25, s55, s53
    s_mov_b32 s32, 18874368
    s_cselect_b32 s32, 20971520, s32
    s_cselect_b32 s34, 352, 0
    s_sub_u32 s33, s33, s34
    s_mov_b32 s26, 1409024
    s_mov_b32 s28, 2752
    s_and_b32 s29, s33, 15
    s_lshr_b32 s30, s33, 4
    s_mov_b32 s31, 0
    s_mov_b32 s34, 16384
    s_mov_b32 s35, 1376
    s_branch L_rl_common_43
L_cD_46:
    s_sub_u32 s33, s98, 4800
    s_mov_b32 s24, s56
    s_mov_b32 s25, s57
    s_mul_i32 s30, s33, 1490
    s_lshr_b32 s30, s30, 16
    s_mul_i32 s34, s30, 44
    s_sub_u32 s29, s33, s34
    s_cmp_lt_u32 s29, 43
    s_cselect_b32 s26, 1409024, 0
    s_mov_b32 s28, 1024
    s_mov_b32 s31, 1
    s_mov_b32 s34, 45056
    s_mov_b32 s32, 23068672
L_rl_common_43:
    s_and_b32 s25, s25, 0xffff
    s_lshl_b32 s33, s30, 2
    s_mul_i32 s33, s33, s34
    s_add_u32 s32, s32, s33
    s_lshl_b32 s33, s29, 10
    s_add_u32 s65, s32, s33
    s_mov_b32 s66, s34
    s_mov_b32 s67, s31
    s_lshl_b32 s33, s29, 5
    v_add_u32 v6, s33, v8
    v_mul_lo_u32 v6, v6, s28
    s_lshl_b32 s33, s30, 6
    v_lshl_add_u32 v7, v9, 3, s33
    v_lshl_add_u32 v6, v7, 1, v6
    v_cmp_gt_u32 vcc, s35, v7
    v_mov_b32 v7, 0x7ffffff0
    s_lshl_b32 s33, s28, 3
    v_cndmask_b32 v6, v7, v6, vcc
    s_lshl_b32 s60, s33, 1
    s_add_u32 s61, s60, s33
    buffer_load_dwordx4 v[32:35], v6, s[24:27], 0 offen
    buffer_load_dwordx4 v[36:39], v6, s[24:27], s33 offen
    buffer_load_dwordx4 v[40:43], v6, s[24:27], s60 offen
    buffer_load_dwordx4 v[44:47], v6, s[24:27], s61 offen
    s_add_u32 s98, s98, 896
    s_mov_b32 s68, -1
    s_cmp_ge_u32 s98, 3072
    s_cbranch_scc1 L_rl_store_37
    s_mov_b32 s27, 0x00020000
    s_mov_b32 s35, 0x7fffffff
    s_cmp_ge_u32 s98, 3072
    s_cbranch_scc1 L_cB_48
    s_lshr_b32 s33, s98, 10
    s_cmp_eq_u32 s33, 1
    s_cselect_b32 s24, s42, s40
    s_cselect_b32 s25, s43, s41
    s_cmp_eq_u32 s33, 2
    s_cselect_b32 s24, s44, s24
    s_cselect_b32 s25, s45, s25
    s_mov_b32 s26, 4194304
    s_mov_b32 s28, 8192
    s_and_b32 s29, s98, 15
    s_lshr_b32 s30, s98, 4
    s_and_b32 s30, s30, 63
    s_mov_b32 s31, 0
    s_mov_b32 s34, 16384
    s_lshl_b32 s32, s33, 22
    s_add_u32 s32, s32, 2097152
    s_branch L_rl_common_47
L_cB_48:
    s_cmp_ge_u32 s98, 4096
    s_cbranch_scc1 L_cC_49
    s_sub_u32 s33, s98, 3072
    s_mov_b32 s24, s46
    s_mov_b32 s25, s47
    s_mov_b32 s26, 4194304
    s_mov_b32 s28, 1024
    s_and_b32 s29, s33, 127
    s_lshr_b32 s30, s33, 7
    s_mov_b32 s31, 1
    s_mov_b32 s34, 131072
    s_mov_b32 s32, 14680064
    s_branch L_rl_common_47
L_cC_49:
    s_cmp_ge_u32 s98, 4800
    s_cbranch_scc1 L_cD_50
    s_sub_u32 s33, s98, 4096
    s_cmp_ge_u32 s33, 352
    s_cselect_b32 s24, s54, s52
    s_cselect_b32 s25, s55, s53
    s_mov_b32 s32, 18874368
    s_cselect_b32 s32, 20971520, s32
    s_cselect_b32 s34, 352, 0
    s_sub_u32 s33, s33, s34
    s_mov_b32 s26, 1409024
    s_mov_b32 s28, 2752
    s_and_b32 s29, s33, 15
    s_lshr_b32 s30, s33, 4
    s_mov_b32 s31, 0
    s_mov_b32 s34, 16384
    s_mov_b32 s35, 1376
    s_branch L_rl_common_47
L_cD_50:
    s_sub_u32 s33, s98, 4800
    s_mov_b32 s24, s56
    s_mov_b32 s25, s57
    s_mul_i32 s30, s33, 1490
    s_lshr_b32 s30, s30, 16
    s_mul_i32 s34, s30, 44
    s_sub_u32 s29, s33, s34
    s_cmp_lt_u32 s29, 43
    s_cselect_b32 s26, 1409024, 0
    s_mov_b32 s28, 1024
    s_mov_b32 s31, 1
    s_mov_b32 s34, 45056
    s_mov_b32 s32, 23068672
L_rl_common_47:
    s_and_b32 s25, s25, 0xffff
    s_lshl_b32 s33, s30, 2
    s_mul_i32 s33, s33, s34
    s_add_u32 s32, s32, s33
    s_lshl_b32 s33, s29, 10
    s_add_u32 s68, s32, s33
    s_mov_b32 s69, s34
    s_mov_b32 s70, s31
    s_lshl_b32 s33, s29, 5
    v_add_u32 v6, s33, v8
    v_mul_lo_u32 v6, v6, s28
    s_lshl_b32 s33, s30, 6
    v_lshl_add_u32 v7, v9, 3, s33
    v_lshl_add_u32 v6, v7, 1, v6
    v_cmp_gt_u32 vcc, s35, v7
    v_mov_b32 v7, 0x7ffffff0
    s_lshl_b32 s33, s28, 3
    v_cndmask_b32 v6, v7, v6, vcc
    s_lshl_b32 s60, s33, 1
    s_add_u32 s61, s60, s33
    buffer_load_dwordx4 v[48:51], v6, s[24:27], 0 offen
    buffer_load_dwordx4 v[52:55], v6, s[24:27], s33 offen
    buffer_load_dwordx4 v[56:59], v6, s[24:27], s60 offen
    buffer_load_dwordx4 v[60:63], v6, s[24:27], s61 offen
    s_add_u32 s98, s98, 896
    s_mov_b32 s71, -1
    s_cmp_ge_u32 s98, 3072
    s_cbranch_scc1 L_rl_store_37
    s_mov_b32 s27, 0x00020000
    s_mov_b32 s35, 0x7fffffff
    s_cmp_ge_u32 s98, 3072
    s_cbranch_scc1 L_cB_52
    s_lshr_b32 s33, s98, 10
    s_cmp_eq_u32 s33, 1
    s_cselect_b32 s24, s42, s40
    s_cselect_b32 s25, s43, s41
    s_cmp_eq_u32 s33, 2
    s_cselect_b32 s24, s44, s24
    s_cselect_b32 s25, s45, s25
    s_mov_b32 s26, 4194304
    s_mov_b32 s28, 8192
    s_and_b32 s29, s98, 15
    s_lshr_b32 s30, s98, 4
    s_and_b32 s30, s30, 63
    s_mov_b32 s31, 0
    s_mov_b32 s34, 16384
    s_lshl_b32 s32, s33, 22
    s_add_u32 s32, s32, 2097152
    s_branch L_rl_common_51
L_cB_52:
    s_cmp_ge_u32 s98, 4096
    s_cbranch_scc1 L_cC_53
    s_sub_u32 s33, s98, 3072
    s_mov_b32 s24, s46
    s_mov_b32 s25, s47
    s_mov_b32 s26, 4194304
    s_mov_b32 s28, 1024
    s_and_b32 s29, s33, 127
    s_lshr_b32 s30, s33, 7
    s_mov_b32 s31, 1
    s_mov_b32 s34, 131072
    s_mov_b32 s32, 14680064
    s_branch L_rl_common_51
L_cC_53:
    s_cmp_ge_u32 s98, 4800
    s_cbranch_scc1 L_cD_54
    s_sub_u32 s33, s98, 4096
    s_cmp_ge_u32 s33, 352
    s_cselect_b32 s24, s54, s52
    s_cselect_b32 s25, s55, s53
    s_mov_b32 s32, 18874368
    s_cselect_b32 s32, 20971520, s32
    s_cselect_b32 s34, 352, 0
    s_sub_u32 s33, s33, s34
    s_mov_b32 s26, 1409024
    s_mov_b32 s28, 2752
    s_and_b32 s29, s33, 15
    s_lshr_b32 s30, s33, 4
    s_mov_b32 s31, 0
    s_mov_b32 s34, 16384
    s_mov_b32 s35, 1376
    s_branch L_rl_common_51
L_cD_54:
    s_sub_u32 s33, s98, 4800
    s_mov_b32 s24, s56
    s_mov_b32 s25, s57
    s_mul_i32 s30, s33, 1490
    s_lshr_b32 s30, s30, 16
    s_mul_i32 s34, s30, 44
    s_sub_u32 s29, s33, s34
    s_cmp_lt_u32 s29, 43
    s_cselect_b32 s26, 1409024, 0
    s_mov_b32 s28, 1024
    s_mov_b32 s31, 1
    s_mov_b32 s34, 45056
    s_mov_b32 s32, 23068672
L_rl_common_51:
    s_and_b32 s25, s25, 0xffff
    s_lshl_b32 s33, s30, 2
    s_mul_i32 s33, s33, s34
    s_add_u32 s32, s32, s33
    s_lshl_b32 s33, s29, 10
    s_add_u32 s71, s32, s33
    s_mov_b32 s72, s34
    s_mov_b32 s73, s31
    s_lshl_b32 s33, s29, 5
    v_add_u32 v6, s33, v8
    v_mul_lo_u32 v6, v6, s28
    s_lshl_b32 s33, s30, 6
    v_lshl_add_u32 v7, v9, 3, s33
    v_lshl_add_u32 v6, v7, 1, v6
    v_cmp_gt_u32 vcc, s35, v7
    v_mov_b32 v7, 0x7ffffff0
    s_lshl_b32 s33, s28, 3
    v_cndmask_b32 v6, v7, v6, vcc
    s_lshl_b32 s60, s33, 1
    s_add_u32 s61, s60, s33
    buffer_load_dwordx4 v[64:67], v6, s[24:27], 0 offen
    buffer_load_dwordx4 v[68:71], v6, s[24:27], s33 offen
    buffer_load_dwordx4 v[72:75], v6, s[24:27], s60 offen
    buffer_load_dwordx4 v[76:79], v6, s[24:27], s61 offen
    s_add_u32 s98, s98, 896
L_rl_store_37:
    s_waitcnt vmcnt(0)
    s_cmp_ge_u32 s92, 2048
    s_cbranch_scc1 L_lnfin_55
    v_lshlrev_b32 v128, 16, v112
    v_and_b32 v129, 0xffff0000, v112
    v_lshlrev_b32 v130, 16, v113
    v_and_b32 v131, 0xffff0000, v113
    v_lshlrev_b32 v132, 16, v114
    v_and_b32 v133, 0xffff0000, v114
    v_lshlrev_b32 v134, 16, v115
    v_and_b32 v135, 0xffff0000, v115
    v_pk_add_f32 v[136:137], v[128:129], v[130:131]
    v_pk_add_f32 v[138:139], v[132:133], v[134:135]
    v_pk_add_f32 v[136:137], v[136:137], v[138:139]
    v_add_f32 v136, v136, v137
    s_nop 1
    v_add_f32_dpp v136, v136, v136 row_ror:1 row_mask:0xf bank_mask:0xf
    s_nop 1
    v_add_f32_dpp v136, v136, v136 row_ror:2 row_mask:0xf bank_mask:0xf
    s_nop 1
    v_add_f32_dpp v136, v136, v136 row_ror:4 row_mask:0xf bank_mask:0xf
    s_nop 1
    v_add_f32_dpp v136, v136, v136 row_ror:8 row_mask:0xf bank_mask:0xf
    s_nop 1
    v_mov_b32 v137, v136
    s_nop 1
    v_permlane16_swap_b32 v136, v137
    v_add_f32 v136, v136, v137
    v_mov_b32 v137, v136
    s_nop 1
    v_permlane32_swap_b32 v136, v137
    v_add_f32 v136, v136, v137
    v_mul_f32 v136, 0x3b000000, v136
    v_mov_b32 v138, 0
    v_sub_f32 v128, v128, v136
    v_fmac_f32 v138, v128, v128
    v_sub_f32 v129, v129, v136
    v_fmac_f32 v138, v129, v129
    v_sub_f32 v130, v130, v136
    v_fmac_f32 v138, v130, v130
    v_sub_f32 v131, v131, v136
    v_fmac_f32 v138, v131, v131
    v_sub_f32 v132, v132, v136
    v_fmac_f32 v138, v132, v132
    v_sub_f32 v133, v133, v136
    v_fmac_f32 v138, v133, v133
    v_sub_f32 v134, v134, v136
    v_fmac_f32 v138, v134, v134
    v_sub_f32 v135, v135, v136
    v_fmac_f32 v138, v135, v135
    s_nop 1
    v_add_f32_dpp v138, v138, v138 row_ror:1 row_mask:0xf bank_mask:0xf
    s_nop 1
    v_add_f32_dpp v138, v138, v138 row_ror:2 row_mask:0xf bank_mask:0xf
    s_nop 1
    v_add_f32_dpp v138, v138, v138 row_ror:4 row_mask:0xf bank_mask:0xf
    s_nop 1
    v_add_f32_dpp v138, v138, v138 row_ror:8 row_mask:0xf bank_mask:0xf
    s_nop 1
    v_mov_b32 v137, v138
    s_nop 1
    v_permlane16_swap_b32 v138, v137
    v_add_f32 v138, v138, v137
    v_mov_b32 v137, v138
    s_nop 1
    v_permlane32_swap_b32 v138, v137
    v_add_f32 v138, v138, v137
    v_mov_b32 v139, 0x3727c5ac
    v_fmac_f32 v139, 0x3b000000, v138
    v_rsq_f32 v139, v139
    s_nop 0
    v_mul_f32 v128, v128, v139
    v_mul_f32 v129, v129, v139
    v_mul_f32 v130, v130, v139
    v_mul_f32 v131, v131, v139
    v_mul_f32 v132, v132, v139
    v_mul_f32 v133, v133, v139
    v_mul_f32 v134, v134, v139
    v_mul_f32 v135, v135, v139
    v_cvt_pk_bf16_f32 v112, v128, v129
    v_cvt_pk_bf16_f32 v113, v130, v131
    v_cvt_pk_bf16_f32 v114, v132, v133
    v_cvt_pk_bf16_f32 v115, v134, v135
    s_lshr_b32 s60, s92, 4
    s_lshl_b32 s60, s60, 14
    s_and_b32 s61, s92, 15
    s_lshl_b32 s61, s61, 4
    s_add_u32 s60, s60, s61
    s_add_u32 s60, s60, 0
    buffer_store_dwordx4 v[112:115], v140, s[8:11], s60 offen sc1
    s_cmp_ge_u32 s93, 2048
    s_cbranch_scc1 L_lnfin_55
    v_lshlrev_b32 v128, 16, v116
    v_and_b32 v129, 0xffff0000, v116
    v_lshlrev_b32 v130, 16, v117
    v_and_b32 v131, 0xffff0000, v117
    v_lshlrev_b32 v132, 16, v118
    v_and_b32 v133, 0xffff0000, v118
    v_lshlrev_b32 v134, 16, v119
    v_and_b32 v135, 0xffff0000, v119
    v_pk_add_f32 v[136:137], v[128:129], v[130:131]
    v_pk_add_f32 v[138:139], v[132:133], v[134:135]
    v_pk_add_f32 v[136:137], v[136:137], v[138:139]
    v_add_f32 v136, v136, v137
    s_nop 1
    v_add_f32_dpp v136, v136, v136 row_ror:1 row_mask:0xf bank_mask:0xf
    s_nop 1
    v_add_f32_dpp v136, v136, v136 row_ror:2 row_mask:0xf bank_mask:0xf
    s_nop 1
    v_add_f32_dpp v136, v136, v136 row_ror:4 row_mask:0xf bank_mask:0xf
    s_nop 1
    v_add_f32_dpp v136, v136, v136 row_ror:8 row_mask:0xf bank_mask:0xf
    s_nop 1
    v_mov_b32 v137, v136
    s_nop 1
    v_permlane16_swap_b32 v136, v137
    v_add_f32 v136, v136, v137
    v_mov_b32 v137, v136
    s_nop 1
    v_permlane32_swap_b32 v136, v137
    v_add_f32 v136, v136, v137
    v_mul_f32 v136, 0x3b000000, v136
    v_mov_b32 v138, 0
    v_sub_f32 v128, v128, v136
    v_fmac_f32 v138, v128, v128
    v_sub_f32 v129, v129, v136
    v_fmac_f32 v138, v129, v129
    v_sub_f32 v130, v130, v136
    v_fmac_f32 v138, v130, v130
    v_sub_f32 v131, v131, v136
    v_fmac_f32 v138, v131, v131
    v_sub_f32 v132, v132, v136
    v_fmac_f32 v138, v132, v132
    v_sub_f32 v133, v133, v136
    v_fmac_f32 v138, v133, v133
    v_sub_f32 v134, v134, v136
    v_fmac_f32 v138, v134, v134
    v_sub_f32 v135, v135, v136
    v_fmac_f32 v138, v135, v135
    s_nop 1
    v_add_f32_dpp v138, v138, v138 row_ror:1 row_mask:0xf bank_mask:0xf
    s_nop 1
    v_add_f32_dpp v138, v138, v138 row_ror:2 row_mask:0xf bank_mask:0xf
    s_nop 1
    v_add_f32_dpp v138, v138, v138 row_ror:4 row_mask:0xf bank_mask:0xf
    s_nop 1
    v_add_f32_dpp v138, v138, v138 row_ror:8 row_mask:0xf bank_mask:0xf
    s_nop 1
    v_mov_b32 v137, v138
    s_nop 1
    v_permlane16_swap_b32 v138, v137
    v_add_f32 v138, v138, v137
    v_mov_b32 v137, v138
    s_nop 1
    v_permlane32_swap_b32 v138, v137
    v_add_f32 v138, v138, v137
    v_mov_b32 v139, 0x3727c5ac
    v_fmac_f32 v139, 0x3b000000, v138
    v_rsq_f32 v139, v139
    s_nop 0
    v_mul_f32 v128, v128, v139
    v_mul_f32 v129, v129, v139
    v_mul_f32 v130, v130, v139
    v_mul_f32 v131, v131, v139
    v_mul_f32 v132, v132, v139
    v_mul_f32 v133, v133, v139
    v_mul_f32 v134, v134, v139
    v_mul_f32 v135, v135, v139
    v_cvt_pk_bf16_f32 v116, v128, v129
    v_cvt_pk_bf16_f32 v117, v130, v131
    v_cvt_pk_bf16_f32 v118, v132, v133
    v_cvt_pk_bf16_f32 v119, v134, v135
    s_lshr_b32 s60, s93, 4
    s_lshl_b32 s60, s60, 14
    s_and_b32 s61, s93, 15
    s_lshl_b32 s61, s61, 4
    s_add_u32 s60, s60, s61
    s_add_u32 s60, s60, 0
    buffer_store_dwordx4 v[116:119], v140, s[8:11], s60 offen sc1
    s_cmp_ge_u32 s94, 2048
    s_cbranch_scc1 L_lnfin_55
    v_lshlrev_b32 v128, 16, v120
    v_and_b32 v129, 0xffff0000, v120
    v_lshlrev_b32 v130, 16, v121
    v_and_b32 v131, 0xffff0000, v121
    v_lshlrev_b32 v132, 16, v122
    v_and_b32 v133, 0xffff0000, v122
    v_lshlrev_b32 v134, 16, v123
    v_and_b32 v135, 0xffff0000, v123
    v_pk_add_f32 v[136:137], v[128:129], v[130:131]
    v_pk_add_f32 v[138:139], v[132:133], v[134:135]
    v_pk_add_f32 v[136:137], v[136:137], v[138:139]
    v_add_f32 v136, v136, v137
    s_nop 1
    v_add_f32_dpp v136, v136, v136 row_ror:1 row_mask:0xf bank_mask:0xf
    s_nop 1
    v_add_f32_dpp v136, v136, v136 row_ror:2 row_mask:0xf bank_mask:0xf
    s_nop 1
    v_add_f32_dpp v136, v136, v136 row_ror:4 row_mask:0xf bank_mask:0xf
    s_nop 1
    v_add_f32_dpp v136, v136, v136 row_ror:8 row_mask:0xf bank_mask:0xf
    s_nop 1
    v_mov_b32 v137, v136
    s_nop 1
    v_permlane16_swap_b32 v136, v137
    v_add_f32 v136, v136, v137
    v_mov_b32 v137, v136
    s_nop 1
    v_permlane32_swap_b32 v136, v137
    v_add_f32 v136, v136, v137
    v_mul_f32 v136, 0x3b000000, v136
    v_mov_b32 v138, 0
    v_sub_f32 v128, v128, v136
    v_fmac_f32 v138, v128, v128
    v_sub_f32 v129, v129, v136
    v_fmac_f32 v138, v129, v129
    v_sub_f32 v130, v130, v136
    v_fmac_f32 v138, v130, v130
    v_sub_f32 v131, v131, v136
    v_fmac_f32 v138, v131, v131
    v_sub_f32 v132, v132, v136
    v_fmac_f32 v138, v132, v132
    v_sub_f32 v133, v133, v136
    v_fmac_f32 v138, v133, v133
    v_sub_f32 v134, v134, v136
    v_fmac_f32 v138, v134, v134
    v_sub_f32 v135, v135, v136
    v_fmac_f32 v138, v135, v135
    s_nop 1
    v_add_f32_dpp v138, v138, v138 row_ror:1 row_mask:0xf bank_mask:0xf
    s_nop 1
    v_add_f32_dpp v138, v138, v138 row_ror:2 row_mask:0xf bank_mask:0xf
    s_nop 1
    v_add_f32_dpp v138, v138, v138 row_ror:4 row_mask:0xf bank_mask:0xf
    s_nop 1
    v_add_f32_dpp v138, v138, v138 row_ror:8 row_mask:0xf bank_mask:0xf
    s_nop 1
    v_mov_b32 v137, v138
    s_nop 1
    v_permlane16_swap_b32 v138, v137
    v_add_f32 v138, v138, v137
    v_mov_b32 v137, v138
    s_nop 1
    v_permlane32_swap_b32 v138, v137
    v_add_f32 v138, v138, v137
    v_mov_b32 v139, 0x3727c5ac
    v_fmac_f32 v139, 0x3b000000, v138
    v_rsq_f32 v139, v139
    s_nop 0
    v_mul_f32 v128, v128, v139
    v_mul_f32 v129, v129, v139
    v_mul_f32 v130, v130, v139
    v_mul_f32 v131, v131, v139
    v_mul_f32 v132, v132, v139
    v_mul_f32 v133, v133, v139
    v_mul_f32 v134, v134, v139
    v_mul_f32 v135, v135, v139
    v_cvt_pk_bf16_f32 v120, v128, v129
    v_cvt_pk_bf16_f32 v121, v130, v131
    v_cvt_pk_bf16_f32 v122, v132, v133
    v_cvt_pk_bf16_f32 v123, v134, v135
    s_lshr_b32 s60, s94, 4
    s_lshl_b32 s60, s60, 14
    s_and_b32 s61, s94, 15
    s_lshl_b32 s61, s61, 4
    s_add_u32 s60, s60, s61
    s_add_u32 s60, s60, 0
    buffer_store_dwordx4 v[120:123], v140, s[8:11], s60 offen sc1
L_lnfin_55:
    s_cmp_eq_u32 s62, -1
    s_cbranch_scc1 L_rl_fin_38
    s_sub_u32 s33, 3, s64
    v_lshlrev_b32 v13, s33, v3
    v_add_u32 v13, v13, v11
    v_mul_u32_u24 v13, 144, v13
    v_lshl_add_u32 v13, v12, 3, v13
    v_add_u32 v13, s21, v13
    s_mul_i32 s33, s64, 12
    s_add_u32 s33, s33, 4
    s_mul_i32 s33, s33, 144
    v_add_u32 v14, s33, v13
    ds_write_b128 v10, v[16:19] offset:0
    ds_write_b128 v10, v[20:23] offset:1152
    ds_write_b128 v10, v[24:27] offset:2304
    ds_write_b128 v10, v[28:31] offset:3456
    s_waitcnt lgkmcnt(0)
    ds_read_b64_tr_b16 v[16:17], v13 offset:0
    ds_read_b64_tr_b16 v[18:19], v14 offset:0
    ds_read_b64_tr_b16 v[20:21], v13 offset:32
    ds_read_b64_tr_b16 v[22:23], v14 offset:32
    ds_read_b64_tr_b16 v[24:25], v13 offset:64
    ds_read_b64_tr_b16 v[26:27], v14 offset:64
    ds_read_b64_tr_b16 v[28:29], v13 offset:96
    ds_read_b64_tr_b16 v[30:31], v14 offset:96
    s_waitcnt lgkmcnt(0)
    buffer_store_dwordx4 v[16:19], v4, s[8:11], s62 offen sc1
    s_add_u32 s62, s62, s63
    buffer_store_dwordx4 v[20:23], v4, s[8:11], s62 offen sc1
    s_add_u32 s62, s62, s63
    buffer_store_dwordx4 v[24:27], v4, s[8:11], s62 offen sc1
    s_add_u32 s62, s62, s63
    buffer_store_dwordx4 v[28:31], v4, s[8:11], s62 offen sc1
    s_add_u32 s62, s62, s63
    s_cmp_eq_u32 s65, -1
    s_cbranch_scc1 L_rl_fin_38
    s_sub_u32 s33, 3, s67
    v_lshlrev_b32 v13, s33, v3
    v_add_u32 v13, v13, v11
    v_mul_u32_u24 v13, 144, v13
    v_lshl_add_u32 v13, v12, 3, v13
    v_add_u32 v13, s21, v13
    s_mul_i32 s33, s67, 12
    s_add_u32 s33, s33, 4
    s_mul_i32 s33, s33, 144
    v_add_u32 v14, s33, v13
    ds_write_b128 v10, v[32:35] offset:0
    ds_write_b128 v10, v[36:39] offset:1152
    ds_write_b128 v10, v[40:43] offset:2304
    ds_write_b128 v10, v[44:47] offset:3456
    s_waitcnt lgkmcnt(0)
    ds_read_b64_tr_b16 v[32:33], v13 offset:0
    ds_read_b64_tr_b16 v[34:35], v14 offset:0
    ds_read_b64_tr_b16 v[36:37], v13 offset:32
    ds_read_b64_tr_b16 v[38:39], v14 offset:32
    ds_read_b64_tr_b16 v[40:41], v13 offset:64
    ds_read_b64_tr_b16 v[42:43], v14 offset:64
    ds_read_b64_tr_b16 v[44:45], v13 offset:96
    ds_read_b64_tr_b16 v[46:47], v14 offset:96
    s_waitcnt lgkmcnt(0)
    buffer_store_dwordx4 v[32:35], v4, s[8:11], s65 offen sc1
    s_add_u32 s65, s65, s66
    buffer_store_dwordx4 v[36:39], v4, s[8:11], s65 offen sc1
    s_add_u32 s65, s65, s66
    buffer_store_dwordx4 v[40:43], v4, s[8:11], s65 offen sc1
    s_add_u32 s65, s65, s66
    buffer_store_dwordx4 v[44:47], v4, s[8:11], s65 offen sc1
    s_add_u32 s65, s65, s66
    s_cmp_eq_u32 s68, -1
    s_cbranch_scc1 L_rl_fin_38
    s_sub_u32 s33, 3, s70
    v_lshlrev_b32 v13, s33, v3
    v_add_u32 v13, v13, v11
    v_mul_u32_u24 v13, 144, v13
    v_lshl_add_u32 v13, v12, 3, v13
    v_add_u32 v13, s21, v13
    s_mul_i32 s33, s70, 12
    s_add_u32 s33, s33, 4
    s_mul_i32 s33, s33, 144
    v_add_u32 v14, s33, v13
    ds_write_b128 v10, v[48:51] offset:0
    ds_write_b128 v10, v[52:55] offset:1152
    ds_write_b128 v10, v[56:59] offset:2304
    ds_write_b128 v10, v[60:63] offset:3456
    s_waitcnt lgkmcnt(0)
    ds_read_b64_tr_b16 v[48:49], v13 offset:0
    ds_read_b64_tr_b16 v[50:51], v14 offset:0
    ds_read_b64_tr_b16 v[52:53], v13 offset:32
    ds_read_b64_tr_b16 v[54:55], v14 offset:32
    ds_read_b64_tr_b16 v[56:57], v13 offset:64
    ds_read_b64_tr_b16 v[58:59], v14 offset:64
    ds_read_b64_tr_b16 v[60:61], v13 offset:96
    ds_read_b64_tr_b16 v[62:63], v14 offset:96
    s_waitcnt lgkmcnt(0)
    buffer_store_dwordx4 v[48:51], v4, s[8:11], s68 offen sc1
    s_add_u32 s68, s68, s69
    buffer_store_dwordx4 v[52:55], v4, s[8:11], s68 offen sc1
    s_add_u32 s68, s68, s69
    buffer_store_dwordx4 v[56:59], v4, s[8:11], s68 offen sc1
    s_add_u32 s68, s68, s69
    buffer_store_dwordx4 v[60:63], v4, s[8:11], s68 offen sc1
    s_add_u32 s68, s68, s69
    s_cmp_eq_u32 s71, -1
    s_cbranch_scc1 L_rl_fin_38
    s_sub_u32 s33, 3, s73
    v_lshlrev_b32 v13, s33, v3
    v_add_u32 v13, v13, v11
    v_mul_u32_u24 v13, 144, v13
    v_lshl_add_u32 v13, v12, 3, v13
    v_add_u32 v13, s21, v13
    s_mul_i32 s33, s73, 12
    s_add_u32 s33, s33, 4
    s_mul_i32 s33, s33, 144
    v_add_u32 v14, s33, v13
    ds_write_b128 v10, v[64:67] offset:0
    ds_write_b128 v10, v[68:71] offset:1152
    ds_write_b128 v10, v[72:75] offset:2304
    ds_write_b128 v10, v[76:79] offset:3456
    s_waitcnt lgkmcnt(0)
    ds_read_b64_tr_b16 v[64:65], v13 offset:0
    ds_read_b64_tr_b16 v[66:67], v14 offset:0
    ds_read_b64_tr_b16 v[68:69], v13 offset:32
    ds_read_b64_tr_b16 v[70:71], v14 offset:32
    ds_read_b64_tr_b16 v[72:73], v13 offset:64
    ds_read_b64_tr_b16 v[74:75], v14 offset:64
    ds_read_b64_tr_b16 v[76:77], v13 offset:96
    ds_read_b64_tr_b16 v[78:79], v14 offset:96
    s_waitcnt lgkmcnt(0)
    buffer_store_dwordx4 v[64:67], v4, s[8:11], s71 offen sc1
    s_add_u32 s71, s71, s72
    buffer_store_dwordx4 v[68:71], v4, s[8:11], s71 offen sc1
    s_add_u32 s71, s71, s72
    buffer_store_dwordx4 v[72:75], v4, s[8:11], s71 offen sc1
    s_add_u32 s71, s71, s72
    buffer_store_dwordx4 v[76:79], v4, s[8:11], s71 offen sc1
    s_add_u32 s71, s71, s72
L_rl_fin_38:
    s_waitcnt vmcnt(0)
    s_barrier
    s_cmp_lg_u32 s20, 0
    s_cbranch_scc1 L_prepok_57
    v_mov_b32 v7, 8
    v_mov_b32 v8, 1
    s_mov_b64 exec, 1
    buffer_atomic_add v8, v7, s[12:15], 0 offen sc0
    s_waitcnt vmcnt(0)
    v_readfirstlane_b32 s60, v8
    s_cmp_lg_u32 s60, 223
    s_cbranch_scc1 L_notlast_58
    v_mov_b32 v7, 252
    v_mov_b32 v8, 1
    buffer_store_dword v8, v7, s[12:15], 0 offen sc1
L_notlast_58:
    s_mov_b64 exec, -1
    s_mov_b32 s96, 0
    v_mov_b32 v7, 0
L_prepbar_56:
    buffer_load_dword v8, v7, s[12:15], 0 offen offset:252 sc1
    s_add_u32 s96, s96, 1
    s_cmp_gt_u32 s96, 4194304
    s_cbranch_scc1 L_prepok_57
    s_waitcnt vmcnt(0)
    v_readfirstlane_b32 s60, v8
    s_cmp_ge_u32 s60, 1
    s_cbranch_scc1 L_prepok_57
    s_sleep 6
    s_branch L_prepbar_56
L_prepok_57:
    s_barrier
L_task_59:
    s_cmp_ge_u32 s90, 1536
    s_cbranch_scc1 L_phase2_60
    s_cmp_ge_u32 s90, 1024
    s_cbranch_scc1 L_isq_61
    s_lshr_b32 s91, s90, 6
    s_and_b32 s70, s90, 63
    s_add_u32 s70, s70, 32
    s_branch L_go_62
L_isq_61:
    s_sub_u32 s70, s90, 1024
    s_lshr_b32 s91, s70, 5
    s_and_b32 s70, s70, 31
L_go_62:
    s_lshl_b32 s21, s91, 3
    s_lshl_b32 s22, s70, 3
    s_lshr_b32 s23, s20, 1
    s_and_b32 s24, s20, 1
    s_add_u32 s60, s21, s20
    s_add_u32 s60, s60, 0
    s_mul_i32 s60, s60, 16384
    s_add_u32 s28, s60, 0
    s_add_u32 s60, s21, s20
    s_add_u32 s60, s60, 4
    s_mul_i32 s60, s60, 16384
    s_add_u32 s29, s60, 0
    s_add_u32 s60, s22, s20
    s_add_u32 s60, s60, 0
    s_mul_i32 s60, s60, 16384
    s_add_u32 s30, s60, 2097152
    s_add_u32 s60, s22, s20
    s_add_u32 s60, s60, 4
    s_mul_i32 s60, s60, 16384
    s_add_u32 s31, s60, 2097152
    s_add_u32 s60, s20, 0
    s_mul_i32 s32, s60, 2048
    s_add_u32 s60, s20, 4
    s_mul_i32 s33, s60, 2048
    s_add_u32 s60, s20, 8
    s_mul_i32 s34, s60, 2048
    s_add_u32 s60, s20, 12
    s_mul_i32 s35, s60, 2048
    s_mul_i32 s60, s23, 8192
    v_add_u32 v5, s60, v4
    s_mul_i32 s60, s24, 8192
    s_add_u32 s60, s60, 16384
    v_add_u32 v6, s60, v4
    v_add_u32 v7, 0x10000, v5
    v_add_u32 v8, 0x10000, v6
    v_add_u32 v9, 0x20000, v5
    v_add_u32 v10, 0x20000, v6
    v_mov_b64 v[16:17], 0
    v_mov_b64 v[18:19], 0
    v_mov_b64 v[20:21], 0
    v_mov_b64 v[22:23], 0
    v_mov_b64 v[24:25], 0
    v_mov_b64 v[26:27], 0
    v_mov_b64 v[28:29], 0
    v_mov_b64 v[30:31], 0
    v_mov_b64 v[32:33], 0
    v_mov_b64 v[34:35], 0
    v_mov_b64 v[36:37], 0
    v_mov_b64 v[38:39], 0
    v_mov_b64 v[40:41], 0
    v_mov_b64 v[42:43], 0
    v_mov_b64 v[44:45], 0
    v_mov_b64 v[46:47], 0
    v_mov_b64 v[48:49], 0
    v_mov_b64 v[50:51], 0
    v_mov_b64 v[52:53], 0
    v_mov_b64 v[54:55], 0
    v_mov_b64 v[56:57], 0
    v_mov_b64 v[58:59], 0
    v_mov_b64 v[60:61], 0
    v_mov_b64 v[62:63], 0
    v_mov_b64 v[64:65], 0
    v_mov_b64 v[66:67], 0
    v_mov_b64 v[68:69], 0
    v_mov_b64 v[70:71], 0
    v_mov_b64 v[72:73], 0
    v_mov_b64 v[74:75], 0
    v_mov_b64 v[76:77], 0
    v_mov_b64 v[78:79], 0
    s_barrier
    s_add_u32 m0, 0, s32
    s_nop 0
    buffer_load_dwordx4 v4, s[8:11], s28 offen offset:0 lds
    buffer_load_dwordx4 v4, s[8:11], s28 offen offset:1024 lds
    s_add_u32 s28, s28, 2048
    s_add_u32 m0, 0, s33
    s_nop 0
    buffer_load_dwordx4 v4, s[8:11], s29 offen offset:0 lds
    buffer_load_dwordx4 v4, s[8:11], s29 offen offset:1024 lds
    s_add_u32 s29, s29, 2048
    s_add_u32 m0, 0, s34
    s_nop 0
    buffer_load_dwordx4 v4, s[8:11], s30 offen offset:0 lds
    buffer_load_dwordx4 v4, s[8:11], s30 offen offset:1024 lds
    s_add_u32 s30, s30, 2048
    s_add_u32 m0, 0, s35
    s_nop 0
    buffer_load_dwordx4 v4, s[8:11], s31 offen offset:0 lds
    buffer_load_dwordx4 v4, s[8:11], s31 offen offset:1024 lds
    s_add_u32 s31, s31, 2048
    s_add_u32 m0, 32768, s32
    s_nop 0
    buffer_load_dwordx4 v4, s[8:11], s28 offen offset:0 lds
    buffer_load_dwordx4 v4, s[8:11], s28 offen offset:1024 lds
    s_add_u32 s28, s28, 2048
    s_add_u32 m0, 32768, s33
    s_nop 0
    buffer_load_dwordx4 v4, s[8:11], s29 offen offset:0 lds
    buffer_load_dwordx4 v4, s[8:11], s29 offen offset:1024 lds
    s_add_u32 s29, s29, 2048
    s_add_u32 m0, 32768, s34
    s_nop 0
    buffer_load_dwordx4 v4, s[8:11], s30 offen offset:0 lds
    buffer_load_dwordx4 v4, s[8:11], s30 offen offset:1024 lds
    s_add_u32 s30, s30, 2048
    s_add_u32 m0, 32768, s35
    s_nop 0
    buffer_load_dwordx4 v4, s[8:11], s31 offen offset:0 lds
    buffer_load_dwordx4 v4, s[8:11], s31 offen offset:1024 lds
    s_add_u32 s31, s31, 2048
    s_add_u32 m0, 65536, s32
    s_nop 0
    buffer_load_dwordx4 v4, s[8:11], s28 offen offset:0 lds
    buffer_load_dwordx4 v4, s[8:11], s28 offen offset:1024 lds
    s_add_u32 s28, s28, 2048
    s_add_u32 m0, 65536, s33
    s_nop 0
    buffer_load_dwordx4 v4, s[8:11], s29 offen offset:0 lds
    buffer_load_dwordx4 v4, s[8:11], s29 offen offset:1024 lds
    s_add_u32 s29, s29, 2048
    s_add_u32 m0, 65536, s34
    s_nop 0
    buffer_load_dwordx4 v4, s[8:11], s30 offen offset:0 lds
    buffer_load_dwordx4 v4, s[8:11], s30 offen offset:1024 lds
    s_add_u32 s30, s30, 2048
    s_add_u32 m0, 65536, s35
    s_nop 0
    buffer_load_dwordx4 v4, s[8:11], s31 offen offset:0 lds
    buffer_load_dwordx4 v4, s[8:11], s31 offen offset:1024 lds
    s_add_u32 s31, s31, 2048
    s_add_u32 m0, 98304, s32
    s_nop 0
    buffer_load_dwordx4 v4, s[8:11], s28 offen offset:0 lds
    buffer_load_dwordx4 v4, s[8:11], s28 offen offset:1024 lds
    s_add_u32 s28, s28, 2048
    s_add_u32 m0, 98304, s33
    s_nop 0
    buffer_load_dwordx4 v4, s[8:11], s29 offen offset:0 lds
    buffer_load_dwordx4 v4, s[8:11], s29 offen offset:1024 lds
    s_add_u32 s29, s29, 2048
    s_add_u32 m0, 98304, s34
    s_nop 0
    buffer_load_dwordx4 v4, s[8:11], s30 offen offset:0 lds
    buffer_load_dwordx4 v4, s[8:11], s30 offen offset:1024 lds
    s_add_u32 s30, s30, 2048
    s_add_u32 m0, 98304, s35
    s_nop 0
    buffer_load_dwordx4 v4, s[8:11], s31 offen offset:0 lds
    buffer_load_dwordx4 v4, s[8:11], s31 offen offset:1024 lds
    s_add_u32 s31, s31, 2048
    s_cmp_ge_u32 s70, 64
    s_cbranch_scc1 L_qkv_v_64
    s_waitcnt vmcnt(24)
    s_barrier
    ds_read_b128 v[80:83], v5 offset:0
    ds_read_b128 v[84:87], v5 offset:2048
    ds_read_b128 v[88:91], v5 offset:4096
    ds_read_b128 v[92:95], v5 offset:6144
    ds_read_b128 v[96:99], v6 offset:0
    ds_read_b128 v[100:103], v6 offset:2048
    ds_read_b128 v[104:107], v6 offset:4096
    ds_read_b128 v[108:111], v6 offset:6144
    ds_read_b128 v[112:115], v5 offset:1024
    ds_read_b128 v[116:119], v5 offset:3072
    ds_read_b128 v[120:123], v5 offset:5120
    ds_read_b128 v[124:127], v5 offset:7168
    ds_read_b128 v[128:131], v6 offset:1024
    ds_read_b128 v[132:135], v6 offset:3072
    ds_read_b128 v[136:139], v6 offset:5120
    ds_read_b128 v[140:143], v6 offset:7168
    s_add_u32 m0, 131072, s32
    s_nop 0
    buffer_load_dwordx4 v4, s[8:11], s28 offen offset:0 lds
    buffer_load_dwordx4 v4, s[8:11], s28 offen offset:1024 lds
    s_add_u32 s28, s28, 2048
    s_add_u32 m0, 131072, s33
    s_nop 0
    buffer_load_dwordx4 v4, s[8:11], s29 offen offset:0 lds
    buffer_load_dwordx4 v4, s[8:11], s29 offen offset:1024 lds
    s_add_u32 s29, s29, 2048
    s_add_u32 m0, 131072, s34
    s_nop 0
    buffer_load_dwordx4 v4, s[8:11], s30 offen offset:0 lds
    buffer_load_dwordx4 v4, s[8:11], s30 offen offset:1024 lds
    s_add_u32 s30, s30, 2048
    s_add_u32 m0, 131072, s35
    s_nop 0
    buffer_load_dwordx4 v4, s[8:11], s31 offen offset:0 lds
    buffer_load_dwordx4 v4, s[8:11], s31 offen offset:1024 lds
    s_add_u32 s31, s31, 2048
    s_waitcnt lgkmcnt(8)
    v_mfma_f32_16x16x32_bf16 v[16:19], v[96:99], v[80:83], v[16:19]
    v_mfma_f32_16x16x32_bf16 v[20:23], v[100:103], v[80:83], v[20:23]
    v_mfma_f32_16x16x32_bf16 v[24:27], v[104:107], v[80:83], v[24:27]
    v_mfma_f32_16x16x32_bf16 v[28:31], v[108:111], v[80:83], v[28:31]
    v_mfma_f32_16x16x32_bf16 v[32:35], v[96:99], v[84:87], v[32:35]
    v_mfma_f32_16x16x32_bf16 v[36:39], v[100:103], v[84:87], v[36:39]
    v_mfma_f32_16x16x32_bf16 v[40:43], v[104:107], v[84:87], v[40:43]
    v_mfma_f32_16x16x32_bf16 v[44:47], v[108:111], v[84:87], v[44:47]
    v_mfma_f32_16x16x32_bf16 v[48:51], v[96:99], v[88:91], v[48:51]
    v_mfma_f32_16x16x32_bf16 v[52:55], v[100:103], v[88:91], v[52:55]
    v_mfma_f32_16x16x32_bf16 v[56:59], v[104:107], v[88:91], v[56:59]
    v_mfma_f32_16x16x32_bf16 v[60:63], v[108:111], v[88:91], v[60:63]
    v_mfma_f32_16x16x32_bf16 v[64:67], v[96:99], v[92:95], v[64:67]
    v_mfma_f32_16x16x32_bf16 v[68:71], v[100:103], v[92:95], v[68:71]
    v_mfma_f32_16x16x32_bf16 v[72:75], v[104:107], v[92:95], v[72:75]
    v_mfma_f32_16x16x32_bf16 v[76:79], v[108:111], v[92:95], v[76:79]
    s_waitcnt lgkmcnt(0)
    v_mfma_f32_16x16x32_bf16 v[16:19], v[128:131], v[112:115], v[16:19]
    v_mfma_f32_16x16x32_bf16 v[20:23], v[132:135], v[112:115], v[20:23]
    v_mfma_f32_16x16x32_bf16 v[24:27], v[136:139], v[112:115], v[24:27]
    v_mfma_f32_16x16x32_bf16 v[28:31], v[140:143], v[112:115], v[28:31]
    v_mfma_f32_16x16x32_bf16 v[32:35], v[128:131], v[116:119], v[32:35]
    v_mfma_f32_16x16x32_bf16 v[36:39], v[132:135], v[116:119], v[36:39]
    v_mfma_f32_16x16x32_bf16 v[40:43], v[136:139], v[116:119], v[40:43]
    v_mfma_f32_16x16x32_bf16 v[44:47], v[140:143], v[116:119], v[44:47]
    v_mfma_f32_16x16x32_bf16 v[48:51], v[128:131], v[120:123], v[48:51]
    v_mfma_f32_16x16x32_bf16 v[52:55], v[132:135], v[120:123], v[52:55]
    v_mfma_f32_16x16x32_bf16 v[56:59], v[136:139], v[120:123], v[56:59]
    v_mfma_f32_16x16x32_bf16 v[60:63], v[140:143], v[120:123], v[60:63]
    v_mfma_f32_16x16x32_bf16 v[64:67], v[128:131], v[124:127], v[64:67]
    v_mfma_f32_16x16x32_bf16 v[68:71], v[132:135], v[124:127], v[68:71]
    v_mfma_f32_16x16x32_bf16 v[72:75], v[136:139], v[124:127], v[72:75]
    v_mfma_f32_16x16x32_bf16 v[76:79], v[140:143], v[124:127], v[76:79]
    s_waitcnt vmcnt(24)
    s_barrier
    ds_read_b128 v[80:83], v5 offset:32768
    ds_read_b128 v[84:87], v5 offset:34816
    ds_read_b128 v[88:91], v5 offset:36864
    ds_read_b128 v[92:95], v5 offset:38912
    ds_read_b128 v[96:99], v6 offset:32768
    ds_read_b128 v[100:103], v6 offset:34816
    ds_read_b128 v[104:107], v6 offset:36864
    ds_read_b128 v[108:111], v6 offset:38912
    ds_read_b128 v[112:115], v5 offset:33792
    ds_read_b128 v[116:119], v5 offset:35840
    ds_read_b128 v[120:123], v5 offset:37888
    ds_read_b128 v[124:127], v5 offset:39936
    ds_read_b128 v[128:131], v6 offset:33792
    ds_read_b128 v[132:135], v6 offset:35840
    ds_read_b128 v[136:139], v6 offset:37888
    ds_read_b128 v[140:143], v6 offset:39936
    s_add_u32 m0, 0, s32
    s_nop 0
    buffer_load_dwordx4 v4, s[8:11], s28 offen offset:0 lds
    buffer_load_dwordx4 v4, s[8:11], s28 offen offset:1024 lds
    s_add_u32 s28, s28, 2048
    s_add_u32 m0, 0, s33
    s_nop 0
    buffer_load_dwordx4 v4, s[8:11], s29 offen offset:0 lds
    buffer_load_dwordx4 v4, s[8:11], s29 offen offset:1024 lds
    s_add_u32 s29, s29, 2048
    s_add_u32 m0, 0, s34
    s_nop 0
    buffer_load_dwordx4 v4, s[8:11], s30 offen offset:0 lds
    buffer_load_dwordx4 v4, s[8:11], s30 offen offset:1024 lds
    s_add_u32 s30, s30, 2048
    s_add_u32 m0, 0, s35
    s_nop 0
    buffer_load_dwordx4 v4, s[8:11], s31 offen offset:0 lds
    buffer_load_dwordx4 v4, s[8:11], s31 offen offset:1024 lds
    s_add_u32 s31, s31, 2048
    s_waitcnt lgkmcnt(8)
    v_mfma_f32_16x16x32_bf16 v[16:19], v[96:99], v[80:83], v[16:19]
    v_mfma_f32_16x16x32_bf16 v[20:23], v[100:103], v[80:83], v[20:23]
    v_mfma_f32_16x16x32_bf16 v[24:27], v[104:107], v[80:83], v[24:27]
    v_mfma_f32_16x16x32_bf16 v[28:31], v[108:111], v[80:83], v[28:31]
    v_mfma_f32_16x16x32_bf16 v[32:35], v[96:99], v[84:87], v[32:35]
    v_mfma_f32_16x16x32_bf16 v[36:39], v[100:103], v[84:87], v[36:39]
    v_mfma_f32_16x16x32_bf16 v[40:43], v[104:107], v[84:87], v[40:43]
    v_mfma_f32_16x16x32_bf16 v[44:47], v[108:111], v[84:87], v[44:47]
    v_mfma_f32_16x16x32_bf16 v[48:51], v[96:99], v[88:91], v[48:51]
    v_mfma_f32_16x16x32_bf16 v[52:55], v[100:103], v[88:91], v[52:55]
    v_mfma_f32_16x16x32_bf16 v[56:59], v[104:107], v[88:91], v[56:59]
    v_mfma_f32_16x16x32_bf16 v[60:63], v[108:111], v[88:91], v[60:63]
    v_mfma_f32_16x16x32_bf16 v[64:67], v[96:99], v[92:95], v[64:67]
    v_mfma_f32_16x16x32_bf16 v[68:71], v[100:103], v[92:95], v[68:71]
    v_mfma_f32_16x16x32_bf16 v[72:75], v[104:107], v[92:95], v[72:75]
    v_mfma_f32_16x16x32_bf16 v[76:79], v[108:111], v[92:95], v[76:79]
    s_waitcnt lgkmcnt(0)
    v_mfma_f32_16x16x32_bf16 v[16:19], v[128:131], v[112:115], v[16:19]
    v_mfma_f32_16x16x32_bf16 v[20:23], v[132:135], v[112:115], v[20:23]
    v_mfma_f32_16x16x32_bf16 v[24:27], v[136:139], v[112:115], v[24:27]
    v_mfma_f32_16x16x32_bf16 v[28:31], v[140:143], v[112:115], v[28:31]
    v_mfma_f32_16x16x32_bf16 v[32:35], v[128:131], v[116:119], v[32:35]
    v_mfma_f32_16x16x32_bf16 v[36:39], v[132:135], v[116:119], v[36:39]
    v_mfma_f32_16x16x32_bf16 v[40:43], v[136:139], v[116:119], v[40:43]
    v_mfma_f32_16x16x32_bf16 v[44:47], v[140:143], v[116:119], v[44:47]
    v_mfma_f32_16x16x32_bf16 v[48:51], v[128:131], v[120:123], v[48:51]
    v_mfma_f32_16x16x32_bf16 v[52:55], v[132:135], v[120:123], v[52:55]
    v_mfma_f32_16x16x32_bf16 v[56:59], v[136:139], v[120:123], v[56:59]
    v_mfma_f32_16x16x32_bf16 v[60:63], v[140:143], v[120:123], v[60:63]
    v_mfma_f32_16x16x32_bf16 v[64:67], v[128:131], v[124:127], v[64:67]
    v_mfma_f32_16x16x32_bf16 v[68:71], v[132:135], v[124:127], v[68:71]
    v_mfma_f32_16x16x32_bf16 v[72:75], v[136:139], v[124:127], v[72:75]
    v_mfma_f32_16x16x32_bf16 v[76:79], v[140:143], v[124:127], v[76:79]
    s_waitcnt vmcnt(24)
    s_barrier
    ds_read_b128 v[80:83], v7 offset:0
    ds_read_b128 v[84:87], v7 offset:2048
    ds_read_b128 v[88:91], v7 offset:4096
    ds_read_b128 v[92:95], v7 offset:6144
    ds_read_b128 v[96:99], v8 offset:0
    ds_read_b128 v[100:103], v8 offset:2048
    ds_read_b128 v[104:107], v8 offset:4096
    ds_read_b128 v[108:111], v8 offset:6144
    ds_read_b128 v[112:115], v7 offset:1024
    ds_read_b128 v[116:119], v7 offset:3072
    ds_read_b128 v[120:123], v7 offset:5120
    ds_read_b128 v[124:127], v7 offset:7168
    ds_read_b128 v[128:131], v8 offset:1024
    ds_read_b128 v[132:135], v8 offset:3072
    ds_read_b128 v[136:139], v8 offset:5120
    ds_read_b128 v[140:143], v8 offset:7168
    s_add_u32 m0, 32768, s32
    s_nop 0
    buffer_load_dwordx4 v4, s[8:11], s28 offen offset:0 lds
    buffer_load_dwordx4 v4, s[8:11], s28 offen offset:1024 lds
    s_add_u32 s28, s28, 2048
    s_add_u32 m0, 32768, s33
    s_nop 0
    buffer_load_dwordx4 v4, s[8:11], s29 offen offset:0 lds
    buffer_load_dwordx4 v4, s[8:11], s29 offen offset:1024 lds
    s_add_u32 s29, s29, 2048
    s_add_u32 m0, 32768, s34
    s_nop 0
    buffer_load_dwordx4 v4, s[8:11], s30 offen offset:0 lds
    buffer_load_dwordx4 v4, s[8:11], s30 offen offset:1024 lds
    s_add_u32 s30, s30, 2048
    s_add_u32 m0, 32768, s35
    s_nop 0
    buffer_load_dwordx4 v4, s[8:11], s31 offen offset:0 lds
    buffer_load_dwordx4 v4, s[8:11], s31 offen offset:1024 lds
    s_add_u32 s31, s31, 2048
    s_waitcnt lgkmcnt(8)
    v_mfma_f32_16x16x32_bf16 v[16:19], v[96:99], v[80:83], v[16:19]
    v_mfma_f32_16x16x32_bf16 v[20:23], v[100:103], v[80:83], v[20:23]
    v_mfma_f32_16x16x32_bf16 v[24:27], v[104:107], v[80:83], v[24:27]
    v_mfma_f32_16x16x32_bf16 v[28:31], v[108:111], v[80:83], v[28:31]
    v_mfma_f32_16x16x32_bf16 v[32:35], v[96:99], v[84:87], v[32:35]
    v_mfma_f32_16x16x32_bf16 v[36:39], v[100:103], v[84:87], v[36:39]
    v_mfma_f32_16x16x32_bf16 v[40:43], v[104:107], v[84:87], v[40:43]
    v_mfma_f32_16x16x32_bf16 v[44:47], v[108:111], v[84:87], v[44:47]
    v_mfma_f32_16x16x32_bf16 v[48:51], v[96:99], v[88:91], v[48:51]
    v_mfma_f32_16x16x32_bf16 v[52:55], v[100:103], v[88:91], v[52:55]
    v_mfma_f32_16x16x32_bf16 v[56:59], v[104:107], v[88:91], v[56:59]
    v_mfma_f32_16x16x32_bf16 v[60:63], v[108:111], v[88:91], v[60:63]
    v_mfma_f32_16x16x32_bf16 v[64:67], v[96:99], v[92:95], v[64:67]
    v_mfma_f32_16x16x32_bf16 v[68:71], v[100:103], v[92:95], v[68:71]
    v_mfma_f32_16x16x32_bf16 v[72:75], v[104:107], v[92:95], v[72:75]
    v_mfma_f32_16x16x32_bf16 v[76:79], v[108:111], v[92:95], v[76:79]
    s_waitcnt lgkmcnt(0)
    v_mfma_f32_16x16x32_bf16 v[16:19], v[128:131], v[112:115], v[16:19]
    v_mfma_f32_16x16x32_bf16 v[20:23], v[132:135], v[112:115], v[20:23]
    v_mfma_f32_16x16x32_bf16 v[24:27], v[136:139], v[112:115], v[24:27]
    v_mfma_f32_16x16x32_bf16 v[28:31], v[140:143], v[112:115], v[28:31]
    v_mfma_f32_16x16x32_bf16 v[32:35], v[128:131], v[116:119], v[32:35]
    v_mfma_f32_16x16x32_bf16 v[36:39], v[132:135], v[116:119], v[36:39]
    v_mfma_f32_16x16x32_bf16 v[40:43], v[136:139], v[116:119], v[40:43]
    v_mfma_f32_16x16x32_bf16 v[44:47], v[140:143], v[116:119], v[44:47]
    v_mfma_f32_16x16x32_bf16 v[48:51], v[128:131], v[120:123], v[48:51]
    v_mfma_f32_16x16x32_bf16 v[52:55], v[132:135], v[120:123], v[52:55]
    v_mfma_f32_16x16x32_bf16 v[56:59], v[136:139], v[120:123], v[56:59]
    v_mfma_f32_16x16x32_bf16 v[60:63], v[140:143], v[120:123], v[60:63]
    v_mfma_f32_16x16x32_bf16 v[64:67], v[128:131], v[124:127], v[64:67]
    v_mfma_f32_16x16x32_bf16 v[68:71], v[132:135], v[124:127], v[68:71]
    v_mfma_f32_16x16x32_bf16 v[72:75], v[136:139], v[124:127], v[72:75]
    v_mfma_f32_16x16x32_bf16 v[76:79], v[140:143], v[124:127], v[76:79]
    s_waitcnt vmcnt(24)
    s_barrier
    ds_read_b128 v[80:83], v7 offset:32768
    ds_read_b128 v[84:87], v7 offset:34816
    ds_read_b128 v[88:91], v7 offset:36864
    ds_read_b128 v[92:95], v7 offset:38912
    ds_read_b128 v[96:99], v8 offset:32768
    ds_read_b128 v[100:103], v8 offset:34816
    ds_read_b128 v[104:107], v8 offset:36864
    ds_read_b128 v[108:111], v8 offset:38912
    ds_read_b128 v[112:115], v7 offset:33792
    ds_read_b128 v[116:119], v7 offset:35840
    ds_read_b128 v[120:123], v7 offset:37888
    ds_read_b128 v[124:127], v7 offset:39936
    ds_read_b128 v[128:131], v8 offset:33792
    ds_read_b128 v[132:135], v8 offset:35840
    ds_read_b128 v[136:139], v8 offset:37888
    ds_read_b128 v[140:143], v8 offset:39936
    s_add_u32 m0, 65536, s32
    s_nop 0
    buffer_load_dwordx4 v4, s[8:11], s28 offen offset:0 lds
    buffer_load_dwordx4 v4, s[8:11], s28 offen offset:1024 lds
    s_add_u32 s28, s28, 2048
    s_add_u32 m0, 65536, s33
    s_nop 0
    buffer_load_dwordx4 v4, s[8:11], s29 offen offset:0 lds
    buffer_load_dwordx4 v4, s[8:11], s29 offen offset:1024 lds
    s_add_u32 s29, s29, 2048
    s_add_u32 m0, 65536, s34
    s_nop 0
    buffer_load_dwordx4 v4, s[8:11], s30 offen offset:0 lds
    buffer_load_dwordx4 v4, s[8:11], s30 offen offset:1024 lds
    s_add_u32 s30, s30, 2048
    s_add_u32 m0, 65536, s35
    s_nop 0
    buffer_load_dwordx4 v4, s[8:11], s31 offen offset:0 lds
    buffer_load_dwordx4 v4, s[8:11], s31 offen offset:1024 lds
    s_add_u32 s31, s31, 2048
    s_waitcnt lgkmcnt(8)
    v_mfma_f32_16x16x32_bf16 v[16:19], v[96:99], v[80:83], v[16:19]
    v_mfma_f32_16x16x32_bf16 v[20:23], v[100:103], v[80:83], v[20:23]
    v_mfma_f32_16x16x32_bf16 v[24:27], v[104:107], v[80:83], v[24:27]
    v_mfma_f32_16x16x32_bf16 v[28:31], v[108:111], v[80:83], v[28:31]
    v_mfma_f32_16x16x32_bf16 v[32:35], v[96:99], v[84:87], v[32:35]
    v_mfma_f32_16x16x32_bf16 v[36:39], v[100:103], v[84:87], v[36:39]
    v_mfma_f32_16x16x32_bf16 v[40:43], v[104:107], v[84:87], v[40:43]
    v_mfma_f32_16x16x32_bf16 v[44:47], v[108:111], v[84:87], v[44:47]
    v_mfma_f32_16x16x32_bf16 v[48:51], v[96:99], v[88:91], v[48:51]
    v_mfma_f32_16x16x32_bf16 v[52:55], v[100:103], v[88:91], v[52:55]
    v_mfma_f32_16x16x32_bf16 v[56:59], v[104:107], v[88:91], v[56:59]
    v_mfma_f32_16x16x32_bf16 v[60:63], v[108:111], v[88:91], v[60:63]
    v_mfma_f32_16x16x32_bf16 v[64:67], v[96:99], v[92:95], v[64:67]
    v_mfma_f32_16x16x32_bf16 v[68:71], v[100:103], v[92:95], v[68:71]
    v_mfma_f32_16x16x32_bf16 v[72:75], v[104:107], v[92:95], v[72:75]
    v_mfma_f32_16x16x32_bf16 v[76:79], v[108:111], v[92:95], v[76:79]
    s_waitcnt lgkmcnt(0)
    v_mfma_f32_16x16x32_bf16 v[16:19], v[128:131], v[112:115], v[16:19]
    v_mfma_f32_16x16x32_bf16 v[20:23], v[132:135], v[112:115], v[20:23]
    v_mfma_f32_16x16x32_bf16 v[24:27], v[136:139], v[112:115], v[24:27]
    v_mfma_f32_16x16x32_bf16 v[28:31], v[140:143], v[112:115], v[28:31]
    v_mfma_f32_16x16x32_bf16 v[32:35], v[128:131], v[116:119], v[32:35]
    v_mfma_f32_16x16x32_bf16 v[36:39], v[132:135], v[116:119], v[36:39]
    v_mfma_f32_16x16x32_bf16 v[40:43], v[136:139], v[116:119], v[40:43]
    v_mfma_f32_16x16x32_bf16 v[44:47], v[140:143], v[116:119], v[44:47]
    v_mfma_f32_16x16x32_bf16 v[48:51], v[128:131], v[120:123], v[48:51]
    v_mfma_f32_16x16x32_bf16 v[52:55], v[132:135], v[120:123], v[52:55]
    v_mfma_f32_16x16x32_bf16 v[56:59], v[136:139], v[120:123], v[56:59]
    v_mfma_f32_16x16x32_bf16 v[60:63], v[140:143], v[120:123], v[60:63]
    v_mfma_f32_16x16x32_bf16 v[64:67], v[128:131], v[124:127], v[64:67]
    v_mfma_f32_16x16x32_bf16 v[68:71], v[132:135], v[124:127], v[68:71]
    v_mfma_f32_16x16x32_bf16 v[72:75], v[136:139], v[124:127], v[72:75]
    v_mfma_f32_16x16x32_bf16 v[76:79], v[140:143], v[124:127], v[76:79]
    s_waitcnt vmcnt(24)
    s_barrier
    ds_read_b128 v[80:83], v9 offset:0
    ds_read_b128 v[84:87], v9 offset:2048
    ds_read_b128 v[88:91], v9 offset:4096
    ds_read_b128 v[92:95], v9 offset:6144
    ds_read_b128 v[96:99], v10 offset:0
    ds_read_b128 v[100:103], v10 offset:2048
    ds_read_b128 v[104:107], v10 offset:4096
    ds_read_b128 v[108:111], v10 offset:6144
    ds_read_b128 v[112:115], v9 offset:1024
    ds_read_b128 v[116:119], v9 offset:3072
    ds_read_b128 v[120:123], v9 offset:5120
    ds_read_b128 v[124:127], v9 offset:7168
    ds_read_b128 v[128:131], v10 offset:1024
    ds_read_b128 v[132:135], v10 offset:3072
    ds_read_b128 v[136:139], v10 offset:5120
    ds_read_b128 v[140:143], v10 offset:7168
    s_waitcnt lgkmcnt(8)
    v_mfma_f32_16x16x32_bf16 v[16:19], v[96:99], v[80:83], v[16:19]
    v_mfma_f32_16x16x32_bf16 v[20:23], v[100:103], v[80:83], v[20:23]
    v_mfma_f32_16x16x32_bf16 v[24:27], v[104:107], v[80:83], v[24:27]
    v_mfma_f32_16x16x32_bf16 v[28:31], v[108:111], v[80:83], v[28:31]
    v_mfma_f32_16x16x32_bf16 v[32:35], v[96:99], v[84:87], v[32:35]
    v_mfma_f32_16x16x32_bf16 v[36:39], v[100:103], v[84:87], v[36:39]
    v_mfma_f32_16x16x32_bf16 v[40:43], v[104:107], v[84:87], v[40:43]
    v_mfma_f32_16x16x32_bf16 v[44:47], v[108:111], v[84:87], v[44:47]
    v_mfma_f32_16x16x32_bf16 v[48:51], v[96:99], v[88:91], v[48:51]
    v_mfma_f32_16x16x32_bf16 v[52:55], v[100:103], v[88:91], v[52:55]
    v_mfma_f32_16x16x32_bf16 v[56:59], v[104:107], v[88:91], v[56:59]
    v_mfma_f32_16x16x32_bf16 v[60:63], v[108:111], v[88:91], v[60:63]
    v_mfma_f32_16x16x32_bf16 v[64:67], v[96:99], v[92:95], v[64:67]
    v_mfma_f32_16x16x32_bf16 v[68:71], v[100:103], v[92:95], v[68:71]
    v_mfma_f32_16x16x32_bf16 v[72:75], v[104:107], v[92:95], v[72:75]
    v_mfma_f32_16x16x32_bf16 v[76:79], v[108:111], v[92:95], v[76:79]
    s_waitcnt lgkmcnt(0)
    v_mfma_f32_16x16x32_bf16 v[16:19], v[128:131], v[112:115], v[16:19]
    v_mfma_f32_16x16x32_bf16 v[20:23], v[132:135], v[112:115], v[20:23]
    v_mfma_f32_16x16x32_bf16 v[24:27], v[136:139], v[112:115], v[24:27]
    v_mfma_f32_16x16x32_bf16 v[28:31], v[140:143], v[112:115], v[28:31]
    v_mfma_f32_16x16x32_bf16 v[32:35], v[128:131], v[116:119], v[32:35]
    v_mfma_f32_16x16x32_bf16 v[36:39], v[132:135], v[116:119], v[36:39]
    v_mfma_f32_16x16x32_bf16 v[40:43], v[136:139], v[116:119], v[40:43]
    v_mfma_f32_16x16x32_bf16 v[44:47], v[140:143], v[116:119], v[44:47]
    v_mfma_f32_16x16x32_bf16 v[48:51], v[128:131], v[120:123], v[48:51]
    v_mfma_f32_16x16x32_bf16 v[52:55], v[132:135], v[120:123], v[52:55]
    v_mfma_f32_16x16x32_bf16 v[56:59], v[136:139], v[120:123], v[56:59]
    v_mfma_f32_16x16x32_bf16 v[60:63], v[140:143], v[120:123], v[60:63]
    v_mfma_f32_16x16x32_bf16 v[64:67], v[128:131], v[124:127], v[64:67]
    v_mfma_f32_16x16x32_bf16 v[68:71], v[132:135], v[124:127], v[68:71]
    v_mfma_f32_16x16x32_bf16 v[72:75], v[136:139], v[124:127], v[72:75]
    v_mfma_f32_16x16x32_bf16 v[76:79], v[140:143], v[124:127], v[76:79]
    s_waitcnt vmcnt(16)
    s_barrier
    ds_read_b128 v[80:83], v5 offset:0
    ds_read_b128 v[84:87], v5 offset:2048
    ds_read_b128 v[88:91], v5 offset:4096
    ds_read_b128 v[92:95], v5 offset:6144
    ds_read_b128 v[96:99], v6 offset:0
    ds_read_b128 v[100:103], v6 offset:2048
    ds_read_b128 v[104:107], v6 offset:4096
    ds_read_b128 v[108:111], v6 offset:6144
    ds_read_b128 v[112:115], v5 offset:1024
    ds_read_b128 v[116:119], v5 offset:3072
    ds_read_b128 v[120:123], v5 offset:5120
    ds_read_b128 v[124:127], v5 offset:7168
    ds_read_b128 v[128:131], v6 offset:1024
    ds_read_b128 v[132:135], v6 offset:3072
    ds_read_b128 v[136:139], v6 offset:5120
    ds_read_b128 v[140:143], v6 offset:7168
    s_waitcnt lgkmcnt(8)
    v_mfma_f32_16x16x32_bf16 v[16:19], v[96:99], v[80:83], v[16:19]
    v_mfma_f32_16x16x32_bf16 v[20:23], v[100:103], v[80:83], v[20:23]
    v_mfma_f32_16x16x32_bf16 v[24:27], v[104:107], v[80:83], v[24:27]
    v_mfma_f32_16x16x32_bf16 v[28:31], v[108:111], v[80:83], v[28:31]
    v_mfma_f32_16x16x32_bf16 v[32:35], v[96:99], v[84:87], v[32:35]
    v_mfma_f32_16x16x32_bf16 v[36:39], v[100:103], v[84:87], v[36:39]
    v_mfma_f32_16x16x32_bf16 v[40:43], v[104:107], v[84:87], v[40:43]
    v_mfma_f32_16x16x32_bf16 v[44:47], v[108:111], v[84:87], v[44:47]
    v_mfma_f32_16x16x32_bf16 v[48:51], v[96:99], v[88:91], v[48:51]
    v_mfma_f32_16x16x32_bf16 v[52:55], v[100:103], v[88:91], v[52:55]
    v_mfma_f32_16x16x32_bf16 v[56:59], v[104:107], v[88:91], v[56:59]
    v_mfma_f32_16x16x32_bf16 v[60:63], v[108:111], v[88:91], v[60:63]
    v_mfma_f32_16x16x32_bf16 v[64:67], v[96:99], v[92:95], v[64:67]
    v_mfma_f32_16x16x32_bf16 v[68:71], v[100:103], v[92:95], v[68:71]
    v_mfma_f32_16x16x32_bf16 v[72:75], v[104:107], v[92:95], v[72:75]
    v_mfma_f32_16x16x32_bf16 v[76:79], v[108:111], v[92:95], v[76:79]
    s_waitcnt lgkmcnt(0)
    v_mfma_f32_16x16x32_bf16 v[16:19], v[128:131], v[112:115], v[16:19]
    v_mfma_f32_16x16x32_bf16 v[20:23], v[132:135], v[112:115], v[20:23]
    v_mfma_f32_16x16x32_bf16 v[24:27], v[136:139], v[112:115], v[24:27]
    v_mfma_f32_16x16x32_bf16 v[28:31], v[140:143], v[112:115], v[28:31]
    v_mfma_f32_16x16x32_bf16 v[32:35], v[128:131], v[116:119], v[32:35]
    v_mfma_f32_16x16x32_bf16 v[36:39], v[132:135], v[116:119], v[36:39]
    v_mfma_f32_16x16x32_bf16 v[40:43], v[136:139], v[116:119], v[40:43]
    v_mfma_f32_16x16x32_bf16 v[44:47], v[140:143], v[116:119], v[44:47]
    v_mfma_f32_16x16x32_bf16 v[48:51], v[128:131], v[120:123], v[48:51]
    v_mfma_f32_16x16x32_bf16 v[52:55], v[132:135], v[120:123], v[52:55]
    v_mfma_f32_16x16x32_bf16 v[56:59], v[136:139], v[120:123], v[56:59]
    v_mfma_f32_16x16x32_bf16 v[60:63], v[140:143], v[120:123], v[60:63]
    v_mfma_f32_16x16x32_bf16 v[64:67], v[128:131], v[124:127], v[64:67]
    v_mfma_f32_16x16x32_bf16 v[68:71], v[132:135], v[124:127], v[68:71]
    v_mfma_f32_16x16x32_bf16 v[72:75], v[136:139], v[124:127], v[72:75]
    v_mfma_f32_16x16x32_bf16 v[76:79], v[140:143], v[124:127], v[76:79]
    s_waitcnt vmcnt(8)
    s_barrier
    ds_read_b128 v[80:83], v5 offset:32768
    ds_read_b128 v[84:87], v5 offset:34816
    ds_read_b128 v[88:91], v5 offset:36864
    ds_read_b128 v[92:95], v5 offset:38912
    ds_read_b128 v[96:99], v6 offset:32768
    ds_read_b128 v[100:103], v6 offset:34816
    ds_read_b128 v[104:107], v6 offset:36864
    ds_read_b128 v[108:111], v6 offset:38912
    ds_read_b128 v[112:115], v5 offset:33792
    ds_read_b128 v[116:119], v5 offset:35840
    ds_read_b128 v[120:123], v5 offset:37888
    ds_read_b128 v[124:127], v5 offset:39936
    ds_read_b128 v[128:131], v6 offset:33792
    ds_read_b128 v[132:135], v6 offset:35840
    ds_read_b128 v[136:139], v6 offset:37888
    ds_read_b128 v[140:143], v6 offset:39936
    s_waitcnt lgkmcnt(8)
    v_mfma_f32_16x16x32_bf16 v[16:19], v[96:99], v[80:83], v[16:19]
    v_mfma_f32_16x16x32_bf16 v[20:23], v[100:103], v[80:83], v[20:23]
    v_mfma_f32_16x16x32_bf16 v[24:27], v[104:107], v[80:83], v[24:27]
    v_mfma_f32_16x16x32_bf16 v[28:31], v[108:111], v[80:83], v[28:31]
    v_mfma_f32_16x16x32_bf16 v[32:35], v[96:99], v[84:87], v[32:35]
    v_mfma_f32_16x16x32_bf16 v[36:39], v[100:103], v[84:87], v[36:39]
    v_mfma_f32_16x16x32_bf16 v[40:43], v[104:107], v[84:87], v[40:43]
    v_mfma_f32_16x16x32_bf16 v[44:47], v[108:111], v[84:87], v[44:47]
    v_mfma_f32_16x16x32_bf16 v[48:51], v[96:99], v[88:91], v[48:51]
    v_mfma_f32_16x16x32_bf16 v[52:55], v[100:103], v[88:91], v[52:55]
    v_mfma_f32_16x16x32_bf16 v[56:59], v[104:107], v[88:91], v[56:59]
    v_mfma_f32_16x16x32_bf16 v[60:63], v[108:111], v[88:91], v[60:63]
    v_mfma_f32_16x16x32_bf16 v[64:67], v[96:99], v[92:95], v[64:67]
    v_mfma_f32_16x16x32_bf16 v[68:71], v[100:103], v[92:95], v[68:71]
    v_mfma_f32_16x16x32_bf16 v[72:75], v[104:107], v[92:95], v[72:75]
    v_mfma_f32_16x16x32_bf16 v[76:79], v[108:111], v[92:95], v[76:79]
    s_waitcnt lgkmcnt(0)
    v_mfma_f32_16x16x32_bf16 v[16:19], v[128:131], v[112:115], v[16:19]
    v_mfma_f32_16x16x32_bf16 v[20:23], v[132:135], v[112:115], v[20:23]
    v_mfma_f32_16x16x32_bf16 v[24:27], v[136:139], v[112:115], v[24:27]
    v_mfma_f32_16x16x32_bf16 v[28:31], v[140:143], v[112:115], v[28:31]
    v_mfma_f32_16x16x32_bf16 v[32:35], v[128:131], v[116:119], v[32:35]
    v_mfma_f32_16x16x32_bf16 v[36:39], v[132:135], v[116:119], v[36:39]
    v_mfma_f32_16x16x32_bf16 v[40:43], v[136:139], v[116:119], v[40:43]
    v_mfma_f32_16x16x32_bf16 v[44:47], v[140:143], v[116:119], v[44:47]
    v_mfma_f32_16x16x32_bf16 v[48:51], v[128:131], v[120:123], v[48:51]
    v_mfma_f32_16x16x32_bf16 v[52:55], v[132:135], v[120:123], v[52:55]
    v_mfma_f32_16x16x32_bf16 v[56:59], v[136:139], v[120:123], v[56:59]
    v_mfma_f32_16x16x32_bf16 v[60:63], v[140:143], v[120:123], v[60:63]
    v_mfma_f32_16x16x32_bf16 v[64:67], v[128:131], v[124:127], v[64:67]
    v_mfma_f32_16x16x32_bf16 v[68:71], v[132:135], v[124:127], v[68:71]
    v_mfma_f32_16x16x32_bf16 v[72:75], v[136:139], v[124:127], v[72:75]
    v_mfma_f32_16x16x32_bf16 v[76:79], v[140:143], v[124:127], v[76:79]
    s_waitcnt vmcnt(0)
    s_barrier
    ds_read_b128 v[80:83], v7 offset:0
    ds_read_b128 v[84:87], v7 offset:2048
    ds_read_b128 v[88:91], v7 offset:4096
    ds_read_b128 v[92:95], v7 offset:6144
    ds_read_b128 v[96:99], v8 offset:0
    ds_read_b128 v[100:103], v8 offset:2048
    ds_read_b128 v[104:107], v8 offset:4096
    ds_read_b128 v[108:111], v8 offset:6144
    ds_read_b128 v[112:115], v7 offset:1024
    ds_read_b128 v[116:119], v7 offset:3072
    ds_read_b128 v[120:123], v7 offset:5120
    ds_read_b128 v[124:127], v7 offset:7168
    ds_read_b128 v[128:131], v8 offset:1024
    ds_read_b128 v[132:135], v8 offset:3072
    ds_read_b128 v[136:139], v8 offset:5120
    ds_read_b128 v[140:143], v8 offset:7168
    s_waitcnt lgkmcnt(8)
    v_mfma_f32_16x16x32_bf16 v[16:19], v[96:99], v[80:83], v[16:19]
    v_mfma_f32_16x16x32_bf16 v[20:23], v[100:103], v[80:83], v[20:23]
    v_mfma_f32_16x16x32_bf16 v[24:27], v[104:107], v[80:83], v[24:27]
    v_mfma_f32_16x16x32_bf16 v[28:31], v[108:111], v[80:83], v[28:31]
    v_mfma_f32_16x16x32_bf16 v[32:35], v[96:99], v[84:87], v[32:35]
    v_mfma_f32_16x16x32_bf16 v[36:39], v[100:103], v[84:87], v[36:39]
    v_mfma_f32_16x16x32_bf16 v[40:43], v[104:107], v[84:87], v[40:43]
    v_mfma_f32_16x16x32_bf16 v[44:47], v[108:111], v[84:87], v[44:47]
    v_mfma_f32_16x16x32_bf16 v[48:51], v[96:99], v[88:91], v[48:51]
    v_mfma_f32_16x16x32_bf16 v[52:55], v[100:103], v[88:91], v[52:55]
    v_mfma_f32_16x16x32_bf16 v[56:59], v[104:107], v[88:91], v[56:59]
    v_mfma_f32_16x16x32_bf16 v[60:63], v[108:111], v[88:91], v[60:63]
    v_mfma_f32_16x16x32_bf16 v[64:67], v[96:99], v[92:95], v[64:67]
    v_mfma_f32_16x16x32_bf16 v[68:71], v[100:103], v[92:95], v[68:71]
    v_mfma_f32_16x16x32_bf16 v[72:75], v[104:107], v[92:95], v[72:75]
    v_mfma_f32_16x16x32_bf16 v[76:79], v[108:111], v[92:95], v[76:79]
    s_waitcnt lgkmcnt(0)
    v_mfma_f32_16x16x32_bf16 v[16:19], v[128:131], v[112:115], v[16:19]
    v_mfma_f32_16x16x32_bf16 v[20:23], v[132:135], v[112:115], v[20:23]
    v_mfma_f32_16x16x32_bf16 v[24:27], v[136:139], v[112:115], v[24:27]
    v_mfma_f32_16x16x32_bf16 v[28:31], v[140:143], v[112:115], v[28:31]
    v_mfma_f32_16x16x32_bf16 v[32:35], v[128:131], v[116:119], v[32:35]
    v_mfma_f32_16x16x32_bf16 v[36:39], v[132:135], v[116:119], v[36:39]
    v_mfma_f32_16x16x32_bf16 v[40:43], v[136:139], v[116:119], v[40:43]
    v_mfma_f32_16x16x32_bf16 v[44:47], v[140:143], v[116:119], v[44:47]
    v_mfma_f32_16x16x32_bf16 v[48:51], v[128:131], v[120:123], v[48:51]
    v_mfma_f32_16x16x32_bf16 v[52:55], v[132:135], v[120:123], v[52:55]
    v_mfma_f32_16x16x32_bf16 v[56:59], v[136:139], v[120:123], v[56:59]
    v_mfma_f32_16x16x32_bf16 v[60:63], v[140:143], v[120:123], v[60:63]
    v_mfma_f32_16x16x32_bf16 v[64:67], v[128:131], v[124:127], v[64:67]
    v_mfma_f32_16x16x32_bf16 v[68:71], v[132:135], v[124:127], v[68:71]
    v_mfma_f32_16x16x32_bf16 v[72:75], v[136:139], v[124:127], v[72:75]
    v_mfma_f32_16x16x32_bf16 v[76:79], v[140:143], v[124:127], v[76:79]
    s_nop 9
    s_and_b32 s71, s70, 31
    s_cmp_ge_u32 s70, 32
    s_mov_b32 s72, 25165824
    s_cselect_b32 s72, 41943040, s72
    s_mul_i32 s73, s23, 4
    s_add_u32 s73, s73, s21
    s_lshr_b32 s73, s73, 1
    s_lshl_b32 s73, s73, 5
    s_add_u32 s73, s73, s71
    s_lshl_b32 s73, s73, 2
    s_lshl_b32 s74, s24, 1
    s_add_u32 s73, s73, s74
    s_lshl_b32 s73, s73, 11
    s_add_u32 s73, s73, s72
    v_cvt_pk_bf16_f32 v144, v16, v17
    v_cvt_pk_bf16_f32 v145, v18, v19
    v_cvt_pk_bf16_f32 v146, v20, v21
    v_cvt_pk_bf16_f32 v147, v22, v23
    s_add_u32 s74, s73, 0
    buffer_store_dwordx4 v[144:147], v4, s[8:11], s74 offen sc1
    v_cvt_pk_bf16_f32 v148, v24, v25
    v_cvt_pk_bf16_f32 v149, v26, v27
    v_cvt_pk_bf16_f32 v150, v28, v29
    v_cvt_pk_bf16_f32 v151, v30, v31
    s_add_u32 s74, s73, 2048
    buffer_store_dwordx4 v[148:151], v4, s[8:11], s74 offen sc1
    v_cvt_pk_bf16_f32 v144, v32, v33
    v_cvt_pk_bf16_f32 v145, v34, v35
    v_cvt_pk_bf16_f32 v146, v36, v37
    v_cvt_pk_bf16_f32 v147, v38, v39
    s_add_u32 s74, s73, 1024
    buffer_store_dwordx4 v[144:147], v4, s[8:11], s74 offen sc1
    v_cvt_pk_bf16_f32 v148, v40, v41
    v_cvt_pk_bf16_f32 v149, v42, v43
    v_cvt_pk_bf16_f32 v150, v44, v45
    v_cvt_pk_bf16_f32 v151, v46, v47
    s_add_u32 s74, s73, 3072
    buffer_store_dwordx4 v[148:151], v4, s[8:11], s74 offen sc1
    v_cvt_pk_bf16_f32 v144, v48, v49
    v_cvt_pk_bf16_f32 v145, v50, v51
    v_cvt_pk_bf16_f32 v146, v52, v53
    v_cvt_pk_bf16_f32 v147, v54, v55
    s_add_u32 s74, s73, 262144
    buffer_store_dwordx4 v[144:147], v4, s[8:11], s74 offen sc1
    v_cvt_pk_bf16_f32 v148, v56, v57
    v_cvt_pk_bf16_f32 v149, v58, v59
    v_cvt_pk_bf16_f32 v150, v60, v61
    v_cvt_pk_bf16_f32 v151, v62, v63
    s_add_u32 s74, s73, 264192
    buffer_store_dwordx4 v[148:151], v4, s[8:11], s74 offen sc1
    v_cvt_pk_bf16_f32 v144, v64, v65
    v_cvt_pk_bf16_f32 v145, v66, v67
    v_cvt_pk_bf16_f32 v146, v68, v69
    v_cvt_pk_bf16_f32 v147, v70, v71
    s_add_u32 s74, s73, 263168
    buffer_store_dwordx4 v[144:147], v4, s[8:11], s74 offen sc1
    v_cvt_pk_bf16_f32 v148, v72, v73
    v_cvt_pk_bf16_f32 v149, v74, v75
    v_cvt_pk_bf16_f32 v150, v76, v77
    v_cvt_pk_bf16_f32 v151, v78, v79
    s_add_u32 s74, s73, 265216
    buffer_store_dwordx4 v[148:151], v4, s[8:11], s74 offen sc1
    s_branch L_qkv_fin_63
L_qkv_v_64:
    s_waitcnt vmcnt(24)
    s_barrier
    ds_read_b128 v[80:83], v5 offset:0
    ds_read_b128 v[84:87], v5 offset:2048
    ds_read_b128 v[88:91], v5 offset:4096
    ds_read_b128 v[92:95], v5 offset:6144
    ds_read_b128 v[96:99], v6 offset:0
    ds_read_b128 v[100:103], v6 offset:2048
    ds_read_b128 v[104:107], v6 offset:4096
    ds_read_b128 v[108:111], v6 offset:6144
    ds_read_b128 v[112:115], v5 offset:1024
    ds_read_b128 v[116:119], v5 offset:3072
    ds_read_b128 v[120:123], v5 offset:5120
    ds_read_b128 v[124:127], v5 offset:7168
    ds_read_b128 v[128:131], v6 offset:1024
    ds_read_b128 v[132:135], v6 offset:3072
    ds_read_b128 v[136:139], v6 offset:5120
    ds_read_b128 v[140:143], v6 offset:7168
    s_add_u32 m0, 131072, s32
    s_nop 0
    buffer_load_dwordx4 v4, s[8:11], s28 offen offset:0 lds
    buffer_load_dwordx4 v4, s[8:11], s28 offen offset:1024 lds
    s_add_u32 s28, s28, 2048
    s_add_u32 m0, 131072, s33
    s_nop 0
    buffer_load_dwordx4 v4, s[8:11], s29 offen offset:0 lds
    buffer_load_dwordx4 v4, s[8:11], s29 offen offset:1024 lds
    s_add_u32 s29, s29, 2048
    s_add_u32 m0, 131072, s34
    s_nop 0
    buffer_load_dwordx4 v4, s[8:11], s30 offen offset:0 lds
    buffer_load_dwordx4 v4, s[8:11], s30 offen offset:1024 lds
    s_add_u32 s30, s30, 2048
    s_add_u32 m0, 131072, s35
    s_nop 0
    buffer_load_dwordx4 v4, s[8:11], s31 offen offset:0 lds
    buffer_load_dwordx4 v4, s[8:11], s31 offen offset:1024 lds
    s_add_u32 s31, s31, 2048
    s_waitcnt lgkmcnt(8)
    v_mfma_f32_16x16x32_bf16 v[16:19], v[80:83], v[96:99], v[16:19]
    v_mfma_f32_16x16x32_bf16 v[20:23], v[80:83], v[100:103], v[20:23]
    v_mfma_f32_16x16x32_bf16 v[24:27], v[80:83], v[104:107], v[24:27]
    v_mfma_f32_16x16x32_bf16 v[28:31], v[80:83], v[108:111], v[28:31]
    v_mfma_f32_16x16x32_bf16 v[32:35], v[84:87], v[96:99], v[32:35]
    v_mfma_f32_16x16x32_bf16 v[36:39], v[84:87], v[100:103], v[36:39]
    v_mfma_f32_16x16x32_bf16 v[40:43], v[84:87], v[104:107], v[40:43]
    v_mfma_f32_16x16x32_bf16 v[44:47], v[84:87], v[108:111], v[44:47]
    v_mfma_f32_16x16x32_bf16 v[48:51], v[88:91], v[96:99], v[48:51]
    v_mfma_f32_16x16x32_bf16 v[52:55], v[88:91], v[100:103], v[52:55]
    v_mfma_f32_16x16x32_bf16 v[56:59], v[88:91], v[104:107], v[56:59]
    v_mfma_f32_16x16x32_bf16 v[60:63], v[88:91], v[108:111], v[60:63]
    v_mfma_f32_16x16x32_bf16 v[64:67], v[92:95], v[96:99], v[64:67]
    v_mfma_f32_16x16x32_bf16 v[68:71], v[92:95], v[100:103], v[68:71]
    v_mfma_f32_16x16x32_bf16 v[72:75], v[92:95], v[104:107], v[72:75]
    v_mfma_f32_16x16x32_bf16 v[76:79], v[92:95], v[108:111], v[76:79]
    s_waitcnt lgkmcnt(0)
    v_mfma_f32_16x16x32_bf16 v[16:19], v[112:115], v[128:131], v[16:19]
    v_mfma_f32_16x16x32_bf16 v[20:23], v[112:115], v[132:135], v[20:23]
    v_mfma_f32_16x16x32_bf16 v[24:27], v[112:115], v[136:139], v[24:27]
    v_mfma_f32_16x16x32_bf16 v[28:31], v[112:115], v[140:143], v[28:31]
    v_mfma_f32_16x16x32_bf16 v[32:35], v[116:119], v[128:131], v[32:35]
    v_mfma_f32_16x16x32_bf16 v[36:39], v[116:119], v[132:135], v[36:39]
    v_mfma_f32_16x16x32_bf16 v[40:43], v[116:119], v[136:139], v[40:43]
    v_mfma_f32_16x16x32_bf16 v[44:47], v[116:119], v[140:143], v[44:47]
    v_mfma_f32_16x16x32_bf16 v[48:51], v[120:123], v[128:131], v[48:51]
    v_mfma_f32_16x16x32_bf16 v[52:55], v[120:123], v[132:135], v[52:55]
    v_mfma_f32_16x16x32_bf16 v[56:59], v[120:123], v[136:139], v[56:59]
    v_mfma_f32_16x16x32_bf16 v[60:63], v[120:123], v[140:143], v[60:63]
    v_mfma_f32_16x16x32_bf16 v[64:67], v[124:127], v[128:131], v[64:67]
    v_mfma_f32_16x16x32_bf16 v[68:71], v[124:127], v[132:135], v[68:71]
    v_mfma_f32_16x16x32_bf16 v[72:75], v[124:127], v[136:139], v[72:75]
    v_mfma_f32_16x16x32_bf16 v[76:79], v[124:127], v[140:143], v[76:79]
    s_waitcnt vmcnt(24)
    s_barrier
    ds_read_b128 v[80:83], v5 offset:32768
    ds_read_b128 v[84:87], v5 offset:34816
    ds_read_b128 v[88:91], v5 offset:36864
    ds_read_b128 v[92:95], v5 offset:38912
    ds_read_b128 v[96:99], v6 offset:32768
    ds_read_b128 v[100:103], v6 offset:34816
    ds_read_b128 v[104:107], v6 offset:36864
    ds_read_b128 v[108:111], v6 offset:38912
    ds_read_b128 v[112:115], v5 offset:33792
    ds_read_b128 v[116:119], v5 offset:35840
    ds_read_b128 v[120:123], v5 offset:37888
    ds_read_b128 v[124:127], v5 offset:39936
    ds_read_b128 v[128:131], v6 offset:33792
    ds_read_b128 v[132:135], v6 offset:35840
    ds_read_b128 v[136:139], v6 offset:37888
    ds_read_b128 v[140:143], v6 offset:39936
    s_add_u32 m0, 0, s32
    s_nop 0
    buffer_load_dwordx4 v4, s[8:11], s28 offen offset:0 lds
    buffer_load_dwordx4 v4, s[8:11], s28 offen offset:1024 lds
    s_add_u32 s28, s28, 2048
    s_add_u32 m0, 0, s33
    s_nop 0
    buffer_load_dwordx4 v4, s[8:11], s29 offen offset:0 lds
    buffer_load_dwordx4 v4, s[8:11], s29 offen offset:1024 lds
    s_add_u32 s29, s29, 2048
    s_add_u32 m0, 0, s34
    s_nop 0
    buffer_load_dwordx4 v4, s[8:11], s30 offen offset:0 lds
    buffer_load_dwordx4 v4, s[8:11], s30 offen offset:1024 lds
    s_add_u32 s30, s30, 2048
    s_add_u32 m0, 0, s35
    s_nop 0
    buffer_load_dwordx4 v4, s[8:11], s31 offen offset:0 lds
    buffer_load_dwordx4 v4, s[8:11], s31 offen offset:1024 lds
    s_add_u32 s31, s31, 2048
    s_waitcnt lgkmcnt(8)
    v_mfma_f32_16x16x32_bf16 v[16:19], v[80:83], v[96:99], v[16:19]
    v_mfma_f32_16x16x32_bf16 v[20:23], v[80:83], v[100:103], v[20:23]
    v_mfma_f32_16x16x32_bf16 v[24:27], v[80:83], v[104:107], v[24:27]
    v_mfma_f32_16x16x32_bf16 v[28:31], v[80:83], v[108:111], v[28:31]
    v_mfma_f32_16x16x32_bf16 v[32:35], v[84:87], v[96:99], v[32:35]
    v_mfma_f32_16x16x32_bf16 v[36:39], v[84:87], v[100:103], v[36:39]
    v_mfma_f32_16x16x32_bf16 v[40:43], v[84:87], v[104:107], v[40:43]
    v_mfma_f32_16x16x32_bf16 v[44:47], v[84:87], v[108:111], v[44:47]
    v_mfma_f32_16x16x32_bf16 v[48:51], v[88:91], v[96:99], v[48:51]
    v_mfma_f32_16x16x32_bf16 v[52:55], v[88:91], v[100:103], v[52:55]
    v_mfma_f32_16x16x32_bf16 v[56:59], v[88:91], v[104:107], v[56:59]
    v_mfma_f32_16x16x32_bf16 v[60:63], v[88:91], v[108:111], v[60:63]
    v_mfma_f32_16x16x32_bf16 v[64:67], v[92:95], v[96:99], v[64:67]
    v_mfma_f32_16x16x32_bf16 v[68:71], v[92:95], v[100:103], v[68:71]
    v_mfma_f32_16x16x32_bf16 v[72:75], v[92:95], v[104:107], v[72:75]
    v_mfma_f32_16x16x32_bf16 v[76:79], v[92:95], v[108:111], v[76:79]
    s_waitcnt lgkmcnt(0)
    v_mfma_f32_16x16x32_bf16 v[16:19], v[112:115], v[128:131], v[16:19]
    v_mfma_f32_16x16x32_bf16 v[20:23], v[112:115], v[132:135], v[20:23]
    v_mfma_f32_16x16x32_bf16 v[24:27], v[112:115], v[136:139], v[24:27]
    v_mfma_f32_16x16x32_bf16 v[28:31], v[112:115], v[140:143], v[28:31]
    v_mfma_f32_16x16x32_bf16 v[32:35], v[116:119], v[128:131], v[32:35]
    v_mfma_f32_16x16x32_bf16 v[36:39], v[116:119], v[132:135], v[36:39]
    v_mfma_f32_16x16x32_bf16 v[40:43], v[116:119], v[136:139], v[40:43]
    v_mfma_f32_16x16x32_bf16 v[44:47], v[116:119], v[140:143], v[44:47]
    v_mfma_f32_16x16x32_bf16 v[48:51], v[120:123], v[128:131], v[48:51]
    v_mfma_f32_16x16x32_bf16 v[52:55], v[120:123], v[132:135], v[52:55]
    v_mfma_f32_16x16x32_bf16 v[56:59], v[120:123], v[136:139], v[56:59]
    v_mfma_f32_16x16x32_bf16 v[60:63], v[120:123], v[140:143], v[60:63]
    v_mfma_f32_16x16x32_bf16 v[64:67], v[124:127], v[128:131], v[64:67]
    v_mfma_f32_16x16x32_bf16 v[68:71], v[124:127], v[132:135], v[68:71]
    v_mfma_f32_16x16x32_bf16 v[72:75], v[124:127], v[136:139], v[72:75]
    v_mfma_f32_16x16x32_bf16 v[76:79], v[124:127], v[140:143], v[76:79]
    s_waitcnt vmcnt(24)
    s_barrier
    ds_read_b128 v[80:83], v7 offset:0
    ds_read_b128 v[84:87], v7 offset:2048
    ds_read_b128 v[88:91], v7 offset:4096
    ds_read_b128 v[92:95], v7 offset:6144
    ds_read_b128 v[96:99], v8 offset:0
    ds_read_b128 v[100:103], v8 offset:2048
    ds_read_b128 v[104:107], v8 offset:4096
    ds_read_b128 v[108:111], v8 offset:6144
    ds_read_b128 v[112:115], v7 offset:1024
    ds_read_b128 v[116:119], v7 offset:3072
    ds_read_b128 v[120:123], v7 offset:5120
    ds_read_b128 v[124:127], v7 offset:7168
    ds_read_b128 v[128:131], v8 offset:1024
    ds_read_b128 v[132:135], v8 offset:3072
    ds_read_b128 v[136:139], v8 offset:5120
    ds_read_b128 v[140:143], v8 offset:7168
    s_add_u32 m0, 32768, s32
    s_nop 0
    buffer_load_dwordx4 v4, s[8:11], s28 offen offset:0 lds
    buffer_load_dwordx4 v4, s[8:11], s28 offen offset:1024 lds
    s_add_u32 s28, s28, 2048
    s_add_u32 m0, 32768, s33
    s_nop 0
    buffer_load_dwordx4 v4, s[8:11], s29 offen offset:0 lds
    buffer_load_dwordx4 v4, s[8:11], s29 offen offset:1024 lds
    s_add_u32 s29, s29, 2048
    s_add_u32 m0, 32768, s34
    s_nop 0
    buffer_load_dwordx4 v4, s[8:11], s30 offen offset:0 lds
    buffer_load_dwordx4 v4, s[8:11], s30 offen offset:1024 lds
    s_add_u32 s30, s30, 2048
    s_add_u32 m0, 32768, s35
    s_nop 0
    buffer_load_dwordx4 v4, s[8:11], s31 offen offset:0 lds
    buffer_load_dwordx4 v4, s[8:11], s31 offen offset:1024 lds
    s_add_u32 s31, s31, 2048
    s_waitcnt lgkmcnt(8)
    v_mfma_f32_16x16x32_bf16 v[16:19], v[80:83], v[96:99], v[16:19]
    v_mfma_f32_16x16x32_bf16 v[20:23], v[80:83], v[100:103], v[20:23]
    v_mfma_f32_16x16x32_bf16 v[24:27], v[80:83], v[104:107], v[24:27]
    v_mfma_f32_16x16x32_bf16 v[28:31], v[80:83], v[108:111], v[28:31]
    v_mfma_f32_16x16x32_bf16 v[32:35], v[84:87], v[96:99], v[32:35]
    v_mfma_f32_16x16x32_bf16 v[36:39], v[84:87], v[100:103], v[36:39]
    v_mfma_f32_16x16x32_bf16 v[40:43], v[84:87], v[104:107], v[40:43]
    v_mfma_f32_16x16x32_bf16 v[44:47], v[84:87], v[108:111], v[44:47]
    v_mfma_f32_16x16x32_bf16 v[48:51], v[88:91], v[96:99], v[48:51]
    v_mfma_f32_16x16x32_bf16 v[52:55], v[88:91], v[100:103], v[52:55]
    v_mfma_f32_16x16x32_bf16 v[56:59], v[88:91], v[104:107], v[56:59]
    v_mfma_f32_16x16x32_bf16 v[60:63], v[88:91], v[108:111], v[60:63]
    v_mfma_f32_16x16x32_bf16 v[64:67], v[92:95], v[96:99], v[64:67]
    v_mfma_f32_16x16x32_bf16 v[68:71], v[92:95], v[100:103], v[68:71]
    v_mfma_f32_16x16x32_bf16 v[72:75], v[92:95], v[104:107], v[72:75]
    v_mfma_f32_16x16x32_bf16 v[76:79], v[92:95], v[108:111], v[76:79]
    s_waitcnt lgkmcnt(0)
    v_mfma_f32_16x16x32_bf16 v[16:19], v[112:115], v[128:131], v[16:19]
    v_mfma_f32_16x16x32_bf16 v[20:23], v[112:115], v[132:135], v[20:23]
    v_mfma_f32_16x16x32_bf16 v[24:27], v[112:115], v[136:139], v[24:27]
    v_mfma_f32_16x16x32_bf16 v[28:31], v[112:115], v[140:143], v[28:31]
    v_mfma_f32_16x16x32_bf16 v[32:35], v[116:119], v[128:131], v[32:35]
    v_mfma_f32_16x16x32_bf16 v[36:39], v[116:119], v[132:135], v[36:39]
    v_mfma_f32_16x16x32_bf16 v[40:43], v[116:119], v[136:139], v[40:43]
    v_mfma_f32_16x16x32_bf16 v[44:47], v[116:119], v[140:143], v[44:47]
    v_mfma_f32_16x16x32_bf16 v[48:51], v[120:123], v[128:131], v[48:51]
    v_mfma_f32_16x16x32_bf16 v[52:55], v[120:123], v[132:135], v[52:55]
    v_mfma_f32_16x16x32_bf16 v[56:59], v[120:123], v[136:139], v[56:59]
    v_mfma_f32_16x16x32_bf16 v[60:63], v[120:123], v[140:143], v[60:63]
    v_mfma_f32_16x16x32_bf16 v[64:67], v[124:127], v[128:131], v[64:67]
    v_mfma_f32_16x16x32_bf16 v[68:71], v[124:127], v[132:135], v[68:71]
    v_mfma_f32_16x16x32_bf16 v[72:75], v[124:127], v[136:139], v[72:75]
    v_mfma_f32_16x16x32_bf16 v[76:79], v[124:127], v[140:143], v[76:79]
    s_waitcnt vmcnt(24)
    s_barrier
    ds_read_b128 v[80:83], v7 offset:32768
    ds_read_b128 v[84:87], v7 offset:34816
    ds_read_b128 v[88:91], v7 offset:36864
    ds_read_b128 v[92:95], v7 offset:38912
    ds_read_b128 v[96:99], v8 offset:32768
    ds_read_b128 v[100:103], v8 offset:34816
    ds_read_b128 v[104:107], v8 offset:36864
    ds_read_b128 v[108:111], v8 offset:38912
    ds_read_b128 v[112:115], v7 offset:33792
    ds_read_b128 v[116:119], v7 offset:35840
    ds_read_b128 v[120:123], v7 offset:37888
    ds_read_b128 v[124:127], v7 offset:39936
    ds_read_b128 v[128:131], v8 offset:33792
    ds_read_b128 v[132:135], v8 offset:35840
    ds_read_b128 v[136:139], v8 offset:37888
    ds_read_b128 v[140:143], v8 offset:39936
    s_add_u32 m0, 65536, s32
    s_nop 0
    buffer_load_dwordx4 v4, s[8:11], s28 offen offset:0 lds
    buffer_load_dwordx4 v4, s[8:11], s28 offen offset:1024 lds
    s_add_u32 s28, s28, 2048
    s_add_u32 m0, 65536, s33
    s_nop 0
    buffer_load_dwordx4 v4, s[8:11], s29 offen offset:0 lds
    buffer_load_dwordx4 v4, s[8:11], s29 offen offset:1024 lds
    s_add_u32 s29, s29, 2048
    s_add_u32 m0, 65536, s34
    s_nop 0
    buffer_load_dwordx4 v4, s[8:11], s30 offen offset:0 lds
    buffer_load_dwordx4 v4, s[8:11], s30 offen offset:1024 lds
    s_add_u32 s30, s30, 2048
    s_add_u32 m0, 65536, s35
    s_nop 0
    buffer_load_dwordx4 v4, s[8:11], s31 offen offset:0 lds
    buffer_load_dwordx4 v4, s[8:11], s31 offen offset:1024 lds
    s_add_u32 s31, s31, 2048
    s_waitcnt lgkmcnt(8)
    v_mfma_f32_16x16x32_bf16 v[16:19], v[80:83], v[96:99], v[16:19]
    v_mfma_f32_16x16x32_bf16 v[20:23], v[80:83], v[100:103], v[20:23]
    v_mfma_f32_16x16x32_bf16 v[24:27], v[80:83], v[104:107], v[24:27]
    v_mfma_f32_16x16x32_bf16 v[28:31], v[80:83], v[108:111], v[28:31]
    v_mfma_f32_16x16x32_bf16 v[32:35], v[84:87], v[96:99], v[32:35]
    v_mfma_f32_16x16x32_bf16 v[36:39], v[84:87], v[100:103], v[36:39]
    v_mfma_f32_16x16x32_bf16 v[40:43], v[84:87], v[104:107], v[40:43]
    v_mfma_f32_16x16x32_bf16 v[44:47], v[84:87], v[108:111], v[44:47]
    v_mfma_f32_16x16x32_bf16 v[48:51], v[88:91], v[96:99], v[48:51]
    v_mfma_f32_16x16x32_bf16 v[52:55], v[88:91], v[100:103], v[52:55]
    v_mfma_f32_16x16x32_bf16 v[56:59], v[88:91], v[104:107], v[56:59]
    v_mfma_f32_16x16x32_bf16 v[60:63], v[88:91], v[108:111], v[60:63]
    v_mfma_f32_16x16x32_bf16 v[64:67], v[92:95], v[96:99], v[64:67]
    v_mfma_f32_16x16x32_bf16 v[68:71], v[92:95], v[100:103], v[68:71]
    v_mfma_f32_16x16x32_bf16 v[72:75], v[92:95], v[104:107], v[72:75]
    v_mfma_f32_16x16x32_bf16 v[76:79], v[92:95], v[108:111], v[76:79]
    s_waitcnt lgkmcnt(0)
    v_mfma_f32_16x16x32_bf16 v[16:19], v[112:115], v[128:131], v[16:19]
    v_mfma_f32_16x16x32_bf16 v[20:23], v[112:115], v[132:135], v[20:23]
    v_mfma_f32_16x16x32_bf16 v[24:27], v[112:115], v[136:139], v[24:27]
    v_mfma_f32_16x16x32_bf16 v[28:31], v[112:115], v[140:143], v[28:31]
    v_mfma_f32_16x16x32_bf16 v[32:35], v[116:119], v[128:131], v[32:35]
    v_mfma_f32_16x16x32_bf16 v[36:39], v[116:119], v[132:135], v[36:39]
    v_mfma_f32_16x16x32_bf16 v[40:43], v[116:119], v[136:139], v[40:43]
    v_mfma_f32_16x16x32_bf16 v[44:47], v[116:119], v[140:143], v[44:47]
    v_mfma_f32_16x16x32_bf16 v[48:51], v[120:123], v[128:131], v[48:51]
    v_mfma_f32_16x16x32_bf16 v[52:55], v[120:123], v[132:135], v[52:55]
    v_mfma_f32_16x16x32_bf16 v[56:59], v[120:123], v[136:139], v[56:59]
    v_mfma_f32_16x16x32_bf16 v[60:63], v[120:123], v[140:143], v[60:63]
    v_mfma_f32_16x16x32_bf16 v[64:67], v[124:127], v[128:131], v[64:67]
    v_mfma_f32_16x16x32_bf16 v[68:71], v[124:127], v[132:135], v[68:71]
    v_mfma_f32_16x16x32_bf16 v[72:75], v[124:127], v[136:139], v[72:75]
    v_mfma_f32_16x16x32_bf16 v[76:79], v[124:127], v[140:143], v[76:79]
    s_waitcnt vmcnt(24)
    s_barrier
    ds_read_b128 v[80:83], v9 offset:0
    ds_read_b128 v[84:87], v9 offset:2048
    ds_read_b128 v[88:91], v9 offset:4096
    ds_read_b128 v[92:95], v9 offset:6144
    ds_read_b128 v[96:99], v10 offset:0
    ds_read_b128 v[100:103], v10 offset:2048
    ds_read_b128 v[104:107], v10 offset:4096
    ds_read_b128 v[108:111], v10 offset:6144
    ds_read_b128 v[112:115], v9 offset:1024
    ds_read_b128 v[116:119], v9 offset:3072
    ds_read_b128 v[120:123], v9 offset:5120
    ds_read_b128 v[124:127], v9 offset:7168
    ds_read_b128 v[128:131], v10 offset:1024
    ds_read_b128 v[132:135], v10 offset:3072
    ds_read_b128 v[136:139], v10 offset:5120
    ds_read_b128 v[140:143], v10 offset:7168
    s_waitcnt lgkmcnt(8)
    v_mfma_f32_16x16x32_bf16 v[16:19], v[80:83], v[96:99], v[16:19]
    v_mfma_f32_16x16x32_bf16 v[20:23], v[80:83], v[100:103], v[20:23]
    v_mfma_f32_16x16x32_bf16 v[24:27], v[80:83], v[104:107], v[24:27]
    v_mfma_f32_16x16x32_bf16 v[28:31], v[80:83], v[108:111], v[28:31]
    v_mfma_f32_16x16x32_bf16 v[32:35], v[84:87], v[96:99], v[32:35]
    v_mfma_f32_16x16x32_bf16 v[36:39], v[84:87], v[100:103], v[36:39]
    v_mfma_f32_16x16x32_bf16 v[40:43], v[84:87], v[104:107], v[40:43]
    v_mfma_f32_16x16x32_bf16 v[44:47], v[84:87], v[108:111], v[44:47]
    v_mfma_f32_16x16x32_bf16 v[48:51], v[88:91], v[96:99], v[48:51]
    v_mfma_f32_16x16x32_bf16 v[52:55], v[88:91], v[100:103], v[52:55]
    v_mfma_f32_16x16x32_bf16 v[56:59], v[88:91], v[104:107], v[56:59]
    v_mfma_f32_16x16x32_bf16 v[60:63], v[88:91], v[108:111], v[60:63]
    v_mfma_f32_16x16x32_bf16 v[64:67], v[92:95], v[96:99], v[64:67]
    v_mfma_f32_16x16x32_bf16 v[68:71], v[92:95], v[100:103], v[68:71]
    v_mfma_f32_16x16x32_bf16 v[72:75], v[92:95], v[104:107], v[72:75]
    v_mfma_f32_16x16x32_bf16 v[76:79], v[92:95], v[108:111], v[76:79]
    s_waitcnt lgkmcnt(0)
    v_mfma_f32_16x16x32_bf16 v[16:19], v[112:115], v[128:131], v[16:19]
    v_mfma_f32_16x16x32_bf16 v[20:23], v[112:115], v[132:135], v[20:23]
    v_mfma_f32_16x16x32_bf16 v[24:27], v[112:115], v[136:139], v[24:27]
    v_mfma_f32_16x16x32_bf16 v[28:31], v[112:115], v[140:143], v[28:31]
    v_mfma_f32_16x16x32_bf16 v[32:35], v[116:119], v[128:131], v[32:35]
    v_mfma_f32_16x16x32_bf16 v[36:39], v[116:119], v[132:135], v[36:39]
    v_mfma_f32_16x16x32_bf16 v[40:43], v[116:119], v[136:139], v[40:43]
    v_mfma_f32_16x16x32_bf16 v[44:47], v[116:119], v[140:143], v[44:47]
    v_mfma_f32_16x16x32_bf16 v[48:51], v[120:123], v[128:131], v[48:51]
    v_mfma_f32_16x16x32_bf16 v[52:55], v[120:123], v[132:135], v[52:55]
    v_mfma_f32_16x16x32_bf16 v[56:59], v[120:123], v[136:139], v[56:59]
    v_mfma_f32_16x16x32_bf16 v[60:63], v[120:123], v[140:143], v[60:63]
    v_mfma_f32_16x16x32_bf16 v[64:67], v[124:127], v[128:131], v[64:67]
    v_mfma_f32_16x16x32_bf16 v[68:71], v[124:127], v[132:135], v[68:71]
    v_mfma_f32_16x16x32_bf16 v[72:75], v[124:127], v[136:139], v[72:75]
    v_mfma_f32_16x16x32_bf16 v[76:79], v[124:127], v[140:143], v[76:79]
    s_waitcnt vmcnt(16)
    s_barrier
    ds_read_b128 v[80:83], v5 offset:0
    ds_read_b128 v[84:87], v5 offset:2048
    ds_read_b128 v[88:91], v5 offset:4096
    ds_read_b128 v[92:95], v5 offset:6144
    ds_read_b128 v[96:99], v6 offset:0
    ds_read_b128 v[100:103], v6 offset:2048
    ds_read_b128 v[104:107], v6 offset:4096
    ds_read_b128 v[108:111], v6 offset:6144
    ds_read_b128 v[112:115], v5 offset:1024
    ds_read_b128 v[116:119], v5 offset:3072
    ds_read_b128 v[120:123], v5 offset:5120
    ds_read_b128 v[124:127], v5 offset:7168
    ds_read_b128 v[128:131], v6 offset:1024
    ds_read_b128 v[132:135], v6 offset:3072
    ds_read_b128 v[136:139], v6 offset:5120
    ds_read_b128 v[140:143], v6 offset:7168
    s_waitcnt lgkmcnt(8)
    v_mfma_f32_16x16x32_bf16 v[16:19], v[80:83], v[96:99], v[16:19]
    v_mfma_f32_16x16x32_bf16 v[20:23], v[80:83], v[100:103], v[20:23]
    v_mfma_f32_16x16x32_bf16 v[24:27], v[80:83], v[104:107], v[24:27]
    v_mfma_f32_16x16x32_bf16 v[28:31], v[80:83], v[108:111], v[28:31]
    v_mfma_f32_16x16x32_bf16 v[32:35], v[84:87], v[96:99], v[32:35]
    v_mfma_f32_16x16x32_bf16 v[36:39], v[84:87], v[100:103], v[36:39]
    v_mfma_f32_16x16x32_bf16 v[40:43], v[84:87], v[104:107], v[40:43]
    v_mfma_f32_16x16x32_bf16 v[44:47], v[84:87], v[108:111], v[44:47]
    v_mfma_f32_16x16x32_bf16 v[48:51], v[88:91], v[96:99], v[48:51]
    v_mfma_f32_16x16x32_bf16 v[52:55], v[88:91], v[100:103], v[52:55]
    v_mfma_f32_16x16x32_bf16 v[56:59], v[88:91], v[104:107], v[56:59]
    v_mfma_f32_16x16x32_bf16 v[60:63], v[88:91], v[108:111], v[60:63]
    v_mfma_f32_16x16x32_bf16 v[64:67], v[92:95], v[96:99], v[64:67]
    v_mfma_f32_16x16x32_bf16 v[68:71], v[92:95], v[100:103], v[68:71]
    v_mfma_f32_16x16x32_bf16 v[72:75], v[92:95], v[104:107], v[72:75]
    v_mfma_f32_16x16x32_bf16 v[76:79], v[92:95], v[108:111], v[76:79]
    s_waitcnt lgkmcnt(0)
    v_mfma_f32_16x16x32_bf16 v[16:19], v[112:115], v[128:131], v[16:19]
    v_mfma_f32_16x16x32_bf16 v[20:23], v[112:115], v[132:135], v[20:23]
    v_mfma_f32_16x16x32_bf16 v[24:27], v[112:115], v[136:139], v[24:27]
    v_mfma_f32_16x16x32_bf16 v[28:31], v[112:115], v[140:143], v[28:31]
    v_mfma_f32_16x16x32_bf16 v[32:35], v[116:119], v[128:131], v[32:35]
    v_mfma_f32_16x16x32_bf16 v[36:39], v[116:119], v[132:135], v[36:39]
    v_mfma_f32_16x16x32_bf16 v[40:43], v[116:119], v[136:139], v[40:43]
    v_mfma_f32_16x16x32_bf16 v[44:47], v[116:119], v[140:143], v[44:47]
    v_mfma_f32_16x16x32_bf16 v[48:51], v[120:123], v[128:131], v[48:51]
    v_mfma_f32_16x16x32_bf16 v[52:55], v[120:123], v[132:135], v[52:55]
    v_mfma_f32_16x16x32_bf16 v[56:59], v[120:123], v[136:139], v[56:59]
    v_mfma_f32_16x16x32_bf16 v[60:63], v[120:123], v[140:143], v[60:63]
    v_mfma_f32_16x16x32_bf16 v[64:67], v[124:127], v[128:131], v[64:67]
    v_mfma_f32_16x16x32_bf16 v[68:71], v[124:127], v[132:135], v[68:71]
    v_mfma_f32_16x16x32_bf16 v[72:75], v[124:127], v[136:139], v[72:75]
    v_mfma_f32_16x16x32_bf16 v[76:79], v[124:127], v[140:143], v[76:79]
    s_waitcnt vmcnt(8)
    s_barrier
    ds_read_b128 v[80:83], v5 offset:32768
    ds_read_b128 v[84:87], v5 offset:34816
    ds_read_b128 v[88:91], v5 offset:36864
    ds_read_b128 v[92:95], v5 offset:38912
    ds_read_b128 v[96:99], v6 offset:32768
    ds_read_b128 v[100:103], v6 offset:34816
    ds_read_b128 v[104:107], v6 offset:36864
    ds_read_b128 v[108:111], v6 offset:38912
    ds_read_b128 v[112:115], v5 offset:33792
    ds_read_b128 v[116:119], v5 offset:35840
    ds_read_b128 v[120:123], v5 offset:37888
    ds_read_b128 v[124:127], v5 offset:39936
    ds_read_b128 v[128:131], v6 offset:33792
    ds_read_b128 v[132:135], v6 offset:35840
    ds_read_b128 v[136:139], v6 offset:37888
    ds_read_b128 v[140:143], v6 offset:39936
    s_waitcnt lgkmcnt(8)
    v_mfma_f32_16x16x32_bf16 v[16:19], v[80:83], v[96:99], v[16:19]
    v_mfma_f32_16x16x32_bf16 v[20:23], v[80:83], v[100:103], v[20:23]
    v_mfma_f32_16x16x32_bf16 v[24:27], v[80:83], v[104:107], v[24:27]
    v_mfma_f32_16x16x32_bf16 v[28:31], v[80:83], v[108:111], v[28:31]
    v_mfma_f32_16x16x32_bf16 v[32:35], v[84:87], v[96:99], v[32:35]
    v_mfma_f32_16x16x32_bf16 v[36:39], v[84:87], v[100:103], v[36:39]
    v_mfma_f32_16x16x32_bf16 v[40:43], v[84:87], v[104:107], v[40:43]
    v_mfma_f32_16x16x32_bf16 v[44:47], v[84:87], v[108:111], v[44:47]
    v_mfma_f32_16x16x32_bf16 v[48:51], v[88:91], v[96:99], v[48:51]
    v_mfma_f32_16x16x32_bf16 v[52:55], v[88:91], v[100:103], v[52:55]
    v_mfma_f32_16x16x32_bf16 v[56:59], v[88:91], v[104:107], v[56:59]
    v_mfma_f32_16x16x32_bf16 v[60:63], v[88:91], v[108:111], v[60:63]
    v_mfma_f32_16x16x32_bf16 v[64:67], v[92:95], v[96:99], v[64:67]
    v_mfma_f32_16x16x32_bf16 v[68:71], v[92:95], v[100:103], v[68:71]
    v_mfma_f32_16x16x32_bf16 v[72:75], v[92:95], v[104:107], v[72:75]
    v_mfma_f32_16x16x32_bf16 v[76:79], v[92:95], v[108:111], v[76:79]
    s_waitcnt lgkmcnt(0)
    v_mfma_f32_16x16x32_bf16 v[16:19], v[112:115], v[128:131], v[16:19]
    v_mfma_f32_16x16x32_bf16 v[20:23], v[112:115], v[132:135], v[20:23]
    v_mfma_f32_16x16x32_bf16 v[24:27], v[112:115], v[136:139], v[24:27]
    v_mfma_f32_16x16x32_bf16 v[28:31], v[112:115], v[140:143], v[28:31]
    v_mfma_f32_16x16x32_bf16 v[32:35], v[116:119], v[128:131], v[32:35]
    v_mfma_f32_16x16x32_bf16 v[36:39], v[116:119], v[132:135], v[36:39]
    v_mfma_f32_16x16x32_bf16 v[40:43], v[116:119], v[136:139], v[40:43]
    v_mfma_f32_16x16x32_bf16 v[44:47], v[116:119], v[140:143], v[44:47]
    v_mfma_f32_16x16x32_bf16 v[48:51], v[120:123], v[128:131], v[48:51]
    v_mfma_f32_16x16x32_bf16 v[52:55], v[120:123], v[132:135], v[52:55]
    v_mfma_f32_16x16x32_bf16 v[56:59], v[120:123], v[136:139], v[56:59]
    v_mfma_f32_16x16x32_bf16 v[60:63], v[120:123], v[140:143], v[60:63]
    v_mfma_f32_16x16x32_bf16 v[64:67], v[124:127], v[128:131], v[64:67]
    v_mfma_f32_16x16x32_bf16 v[68:71], v[124:127], v[132:135], v[68:71]
    v_mfma_f32_16x16x32_bf16 v[72:75], v[124:127], v[136:139], v[72:75]
    v_mfma_f32_16x16x32_bf16 v[76:79], v[124:127], v[140:143], v[76:79]
    s_waitcnt vmcnt(0)
    s_barrier
    ds_read_b128 v[80:83], v7 offset:0
    ds_read_b128 v[84:87], v7 offset:2048
    ds_read_b128 v[88:91], v7 offset:4096
    ds_read_b128 v[92:95], v7 offset:6144
    ds_read_b128 v[96:99], v8 offset:0
    ds_read_b128 v[100:103], v8 offset:2048
    ds_read_b128 v[104:107], v8 offset:4096
    ds_read_b128 v[108:111], v8 offset:6144
    ds_read_b128 v[112:115], v7 offset:1024
    ds_read_b128 v[116:119], v7 offset:3072
    ds_read_b128 v[120:123], v7 offset:5120
    ds_read_b128 v[124:127], v7 offset:7168
    ds_read_b128 v[128:131], v8 offset:1024
    ds_read_b128 v[132:135], v8 offset:3072
    ds_read_b128 v[136:139], v8 offset:5120
    ds_read_b128 v[140:143], v8 offset:7168
    s_waitcnt lgkmcnt(8)
    v_mfma_f32_16x16x32_bf16 v[16:19], v[80:83], v[96:99], v[16:19]
    v_mfma_f32_16x16x32_bf16 v[20:23], v[80:83], v[100:103], v[20:23]
    v_mfma_f32_16x16x32_bf16 v[24:27], v[80:83], v[104:107], v[24:27]
    v_mfma_f32_16x16x32_bf16 v[28:31], v[80:83], v[108:111], v[28:31]
    v_mfma_f32_16x16x32_bf16 v[32:35], v[84:87], v[96:99], v[32:35]
    v_mfma_f32_16x16x32_bf16 v[36:39], v[84:87], v[100:103], v[36:39]
    v_mfma_f32_16x16x32_bf16 v[40:43], v[84:87], v[104:107], v[40:43]
    v_mfma_f32_16x16x32_bf16 v[44:47], v[84:87], v[108:111], v[44:47]
    v_mfma_f32_16x16x32_bf16 v[48:51], v[88:91], v[96:99], v[48:51]
    v_mfma_f32_16x16x32_bf16 v[52:55], v[88:91], v[100:103], v[52:55]
    v_mfma_f32_16x16x32_bf16 v[56:59], v[88:91], v[104:107], v[56:59]
    v_mfma_f32_16x16x32_bf16 v[60:63], v[88:91], v[108:111], v[60:63]
    v_mfma_f32_16x16x32_bf16 v[64:67], v[92:95], v[96:99], v[64:67]
    v_mfma_f32_16x16x32_bf16 v[68:71], v[92:95], v[100:103], v[68:71]
    v_mfma_f32_16x16x32_bf16 v[72:75], v[92:95], v[104:107], v[72:75]
    v_mfma_f32_16x16x32_bf16 v[76:79], v[92:95], v[108:111], v[76:79]
    s_waitcnt lgkmcnt(0)
    v_mfma_f32_16x16x32_bf16 v[16:19], v[112:115], v[128:131], v[16:19]
    v_mfma_f32_16x16x32_bf16 v[20:23], v[112:115], v[132:135], v[20:23]
    v_mfma_f32_16x16x32_bf16 v[24:27], v[112:115], v[136:139], v[24:27]
    v_mfma_f32_16x16x32_bf16 v[28:31], v[112:115], v[140:143], v[28:31]
    v_mfma_f32_16x16x32_bf16 v[32:35], v[116:119], v[128:131], v[32:35]
    v_mfma_f32_16x16x32_bf16 v[36:39], v[116:119], v[132:135], v[36:39]
    v_mfma_f32_16x16x32_bf16 v[40:43], v[116:119], v[136:139], v[40:43]
    v_mfma_f32_16x16x32_bf16 v[44:47], v[116:119], v[140:143], v[44:47]
    v_mfma_f32_16x16x32_bf16 v[48:51], v[120:123], v[128:131], v[48:51]
    v_mfma_f32_16x16x32_bf16 v[52:55], v[120:123], v[132:135], v[52:55]
    v_mfma_f32_16x16x32_bf16 v[56:59], v[120:123], v[136:139], v[56:59]
    v_mfma_f32_16x16x32_bf16 v[60:63], v[120:123], v[140:143], v[60:63]
    v_mfma_f32_16x16x32_bf16 v[64:67], v[124:127], v[128:131], v[64:67]
    v_mfma_f32_16x16x32_bf16 v[68:71], v[124:127], v[132:135], v[68:71]
    v_mfma_f32_16x16x32_bf16 v[72:75], v[124:127], v[136:139], v[72:75]
    v_mfma_f32_16x16x32_bf16 v[76:79], v[124:127], v[140:143], v[76:79]
    s_nop 9
    s_and_b32 s71, s70, 31
    s_mov_b32 s72, 58720256
    s_mul_i32 s73, s23, 4
    s_add_u32 s73, s73, s21
    s_lshr_b32 s73, s73, 1
    s_lshl_b32 s73, s73, 5
    s_add_u32 s73, s73, s71
    s_lshl_b32 s73, s73, 2
    s_lshl_b32 s74, s24, 1
    s_add_u32 s73, s73, s74
    s_lshl_b32 s73, s73, 11
    s_add_u32 s73, s73, s72
    v_cvt_pk_bf16_f32 v144, v16, v17
    v_cvt_pk_bf16_f32 v145, v18, v19
    v_cvt_pk_bf16_f32 v146, v32, v33
    v_cvt_pk_bf16_f32 v147, v34, v35
    s_add_u32 s74, s73, 0
    buffer_store_dwordx4 v[144:147], v4, s[8:11], s74 offen sc1
    v_cvt_pk_bf16_f32 v148, v20, v21
    v_cvt_pk_bf16_f32 v149, v22, v23
    v_cvt_pk_bf16_f32 v150, v36, v37
    v_cvt_pk_bf16_f32 v151, v38, v39
    s_add_u32 s74, s73, 1024
    buffer_store_dwordx4 v[148:151], v4, s[8:11], s74 offen sc1
    v_cvt_pk_bf16_f32 v144, v24, v25
    v_cvt_pk_bf16_f32 v145, v26, v27
    v_cvt_pk_bf16_f32 v146, v40, v41
    v_cvt_pk_bf16_f32 v147, v42, v43
    s_add_u32 s74, s73, 2048
    buffer_store_dwordx4 v[144:147], v4, s[8:11], s74 offen sc1
    v_cvt_pk_bf16_f32 v148, v28, v29
    v_cvt_pk_bf16_f32 v149, v30, v31
    v_cvt_pk_bf16_f32 v150, v44, v45
    v_cvt_pk_bf16_f32 v151, v46, v47
    s_add_u32 s74, s73, 3072
    buffer_store_dwordx4 v[148:151], v4, s[8:11], s74 offen sc1
    v_cvt_pk_bf16_f32 v144, v48, v49
    v_cvt_pk_bf16_f32 v145, v50, v51
    v_cvt_pk_bf16_f32 v146, v64, v65
    v_cvt_pk_bf16_f32 v147, v66, v67
    s_add_u32 s74, s73, 262144
    buffer_store_dwordx4 v[144:147], v4, s[8:11], s74 offen sc1
    v_cvt_pk_bf16_f32 v148, v52, v53
    v_cvt_pk_bf16_f32 v149, v54, v55
    v_cvt_pk_bf16_f32 v150, v68, v69
    v_cvt_pk_bf16_f32 v151, v70, v71
    s_add_u32 s74, s73, 263168
    buffer_store_dwordx4 v[148:151], v4, s[8:11], s74 offen sc1
    v_cvt_pk_bf16_f32 v144, v56, v57
    v_cvt_pk_bf16_f32 v145, v58, v59
    v_cvt_pk_bf16_f32 v146, v72, v73
    v_cvt_pk_bf16_f32 v147, v74, v75
    s_add_u32 s74, s73, 264192
    buffer_store_dwordx4 v[144:147], v4, s[8:11], s74 offen sc1
    v_cvt_pk_bf16_f32 v148, v60, v61
    v_cvt_pk_bf16_f32 v149, v62, v63
    v_cvt_pk_bf16_f32 v150, v76, v77
    v_cvt_pk_bf16_f32 v151, v78, v79
    s_add_u32 s74, s73, 265216
    buffer_store_dwordx4 v[148:151], v4, s[8:11], s74 offen sc1
L_qkv_fin_63:
    s_waitcnt vmcnt(0)
    s_barrier
    s_lshl_b32 s60, s91, 7
    s_add_u32 s60, s60, 122683392
    s_cmp_lg_u32 s20, 0
    s_cbranch_scc1 L_nosig_66
    v_mov_b32 v7, s60
    v_mov_b32 v8, 1
    s_mov_b64 exec, 1
    buffer_atomic_add v8, v7, s[8:11], 0 offen
    s_mov_b64 exec, -1
L_nosig_66:
    s_cmp_ge_u32 s90, 1024
    s_cbranch_scc1 L_nosigkv_65
    s_lshl_b32 s60, s91, 7
    s_add_u32 s60, s60, 122736640
    s_cmp_lg_u32 s20, 0
    s_cbranch_scc1 L_nosig_67
    v_mov_b32 v7, s60
    v_mov_b32 v8, 1
    s_mov_b64 exec, 1
    buffer_atomic_add v8, v7, s[8:11], 0 offen
    s_mov_b64 exec, -1
L_nosig_67:
    s_mov_b32 s60, 122738688
    s_cmp_lg_u32 s20, 0
    s_cbranch_scc1 L_nosig_68
    v_mov_b32 v7, s60
    v_mov_b32 v8, 1
    s_mov_b64 exec, 1
    buffer_atomic_add v8, v7, s[8:11], 0 offen
    s_mov_b64 exec, -1
L_nosig_68:
L_nosigkv_65:
    s_add_u32 s90, s90, 224
    s_branch L_task_59
L_phase2_60:
    s_sub_u32 s90, s90, 1536
    s_mov_b32 s96, 0
    s_barrier
    s_lshl_b32 s3, s100, 2
    s_add_u32 s3, s3, s20
    s_load_dwordx16 s[36:51], s[0:1], 0
    s_load_dwordx8 s[52:59], s[0:1], 64
    s_load_dwordx2 s[76:77], s[0:1], 0
    s_waitcnt lgkmcnt(0)
    s_and_b32 s77, s77, 0xffff
    s_mov_b32 s78, 2097152
    s_mov_b32 s79, 0x00020000
    s_add_u32 s98, s3, 3072
    s_mul_i32 s21, s20, 4608
    v_lshrrev_b32 v8, 3, v1
    v_and_b32 v9, 7, v1
    v_mul_u32_u24 v10, 144, v8
    v_lshl_add_u32 v10, v9, 4, v10
    v_add_u32 v10, s21, v10
    v_lshrrev_b32 v11, 2, v2
    v_and_b32 v12, 3, v1
    s_mov_b32 s62, -1
    s_cmp_ge_u32 s98, 5152
    s_cbranch_scc1 L_rl_store_69
    s_mov_b32 s27, 0x00020000
    s_mov_b32 s35, 0x7fffffff
    s_cmp_ge_u32 s98, 3072
    s_cbranch_scc1 L_cB_72
    s_lshr_b32 s33, s98, 10
    s_cmp_eq_u32 s33, 1
    s_cselect_b32 s24, s42, s40
    s_cselect_b32 s25, s43, s41
    s_cmp_eq_u32 s33, 2
    s_cselect_b32 s24, s44, s24
    s_cselect_b32 s25, s45, s25
    s_mov_b32 s26, 4194304
    s_mov_b32 s28, 8192
    s_and_b32 s29, s98, 15
    s_lshr_b32 s30, s98, 4
    s_and_b32 s30, s30, 63
    s_mov_b32 s31, 0
    s_mov_b32 s34, 16384
    s_lshl_b32 s32, s33, 22
    s_add_u32 s32, s32, 2097152
    s_branch L_rl_common_71
L_cB_72:
    s_cmp_ge_u32 s98, 4096
    s_cbranch_scc1 L_cC_73
    s_sub_u32 s33, s98, 3072
    s_mov_b32 s24, s46
    s_mov_b32 s25, s47
    s_mov_b32 s26, 4194304
    s_mov_b32 s28, 1024
    s_and_b32 s29, s33, 127
    s_lshr_b32 s30, s33, 7
    s_mov_b32 s31, 1
    s_mov_b32 s34, 131072
    s_mov_b32 s32, 14680064
    s_branch L_rl_common_71
L_cC_73:
    s_cmp_ge_u32 s98, 4800
    s_cbranch_scc1 L_cD_74
    s_sub_u32 s33, s98, 4096
    s_cmp_ge_u32 s33, 352
    s_cselect_b32 s24, s54, s52
    s_cselect_b32 s25, s55, s53
    s_mov_b32 s32, 18874368
    s_cselect_b32 s32, 20971520, s32
    s_cselect_b32 s34, 352, 0
    s_sub_u32 s33, s33, s34
    s_mov_b32 s26, 1409024
    s_mov_b32 s28, 2752
    s_and_b32 s29, s33, 15
    s_lshr_b32 s30, s33, 4
    s_mov_b32 s31, 0
    s_mov_b32 s34, 16384
    s_mov_b32 s35, 1376
    s_branch L_rl_common_71
L_cD_74:
    s_sub_u32 s33, s98, 4800
    s_mov_b32 s24, s56
    s_mov_b32 s25, s57
    s_mul_i32 s30, s33, 1490
    s_lshr_b32 s30, s30, 16
    s_mul_i32 s34, s30, 44
    s_sub_u32 s29, s33, s34
    s_cmp_lt_u32 s29, 43
    s_cselect_b32 s26, 1409024, 0
    s_mov_b32 s28, 1024
    s_mov_b32 s31, 1
    s_mov_b32 s34, 45056
    s_mov_b32 s32, 23068672
L_rl_common_71:
    s_and_b32 s25, s25, 0xffff
    s_lshl_b32 s33, s30, 2
    s_mul_i32 s33, s33, s34
    s_add_u32 s32, s32, s33
    s_lshl_b32 s33, s29, 10
    s_add_u32 s62, s32, s33
    s_mov_b32 s63, s34
    s_mov_b32 s64, s31
    s_lshl_b32 s33, s29, 5
    v_add_u32 v6, s33, v8
    v_mul_lo_u32 v6, v6, s28
    s_lshl_b32 s33, s30, 6
    v_lshl_add_u32 v7, v9, 3, s33
    v_lshl_add_u32 v6, v7, 1, v6
    v_cmp_gt_u32 vcc, s35, v7
    v_mov_b32 v7, 0x7ffffff0
    s_lshl_b32 s33, s28, 3
    v_cndmask_b32 v6, v7, v6, vcc
    s_lshl_b32 s60, s33, 1
    s_add_u32 s61, s60, s33
    buffer_load_dwordx4 v[16:19], v6, s[24:27], 0 offen
    buffer_load_dwordx4 v[20:23], v6, s[24:27], s33 offen
    buffer_load_dwordx4 v[24:27], v6, s[24:27], s60 offen
    buffer_load_dwordx4 v[28:31], v6, s[24:27], s61 offen
    s_add_u32 s98, s98, 896
    s_mov_b32 s65, -1
    s_cmp_ge_u32 s98, 5152
    s_cbranch_scc1 L_rl_store_69
    s_mov_b32 s27, 0x00020000
    s_mov_b32 s35, 0x7fffffff
    s_cmp_ge_u32 s98, 3072
    s_cbranch_scc1 L_cB_76
    s_lshr_b32 s33, s98, 10
    s_cmp_eq_u32 s33, 1
    s_cselect_b32 s24, s42, s40
    s_cselect_b32 s25, s43, s41
    s_cmp_eq_u32 s33, 2
    s_cselect_b32 s24, s44, s24
    s_cselect_b32 s25, s45, s25
    s_mov_b32 s26, 4194304
    s_mov_b32 s28, 8192
    s_and_b32 s29, s98, 15
    s_lshr_b32 s30, s98, 4
    s_and_b32 s30, s30, 63
    s_mov_b32 s31, 0
    s_mov_b32 s34, 16384
    s_lshl_b32 s32, s33, 22
    s_add_u32 s32, s32, 2097152
    s_branch L_rl_common_75
L_cB_76:
    s_cmp_ge_u32 s98, 4096
    s_cbranch_scc1 L_cC_77
    s_sub_u32 s33, s98, 3072
    s_mov_b32 s24, s46
    s_mov_b32 s25, s47
    s_mov_b32 s26, 4194304
    s_mov_b32 s28, 1024
    s_and_b32 s29, s33, 127
    s_lshr_b32 s30, s33, 7
    s_mov_b32 s31, 1
    s_mov_b32 s34, 131072
    s_mov_b32 s32, 14680064
    s_branch L_rl_common_75
L_cC_77:
    s_cmp_ge_u32 s98, 4800
    s_cbranch_scc1 L_cD_78
    s_sub_u32 s33, s98, 4096
    s_cmp_ge_u32 s33, 352
    s_cselect_b32 s24, s54, s52
    s_cselect_b32 s25, s55, s53
    s_mov_b32 s32, 18874368
    s_cselect_b32 s32, 20971520, s32
    s_cselect_b32 s34, 352, 0
    s_sub_u32 s33, s33, s34
    s_mov_b32 s26, 1409024
    s_mov_b32 s28, 2752
    s_and_b32 s29, s33, 15
    s_lshr_b32 s30, s33, 4
    s_mov_b32 s31, 0
    s_mov_b32 s34, 16384
    s_mov_b32 s35, 1376
    s_branch L_rl_common_75
L_cD_78:
    s_sub_u32 s33, s98, 4800
    s_mov_b32 s24, s56
    s_mov_b32 s25, s57
    s_mul_i32 s30, s33, 1490
    s_lshr_b32 s30, s30, 16
    s_mul_i32 s34, s30, 44
    s_sub_u32 s29, s33, s34
    s_cmp_lt_u32 s29, 43
    s_cselect_b32 s26, 1409024, 0
    s_mov_b32 s28, 1024
    s_mov_b32 s31, 1
    s_mov_b32 s34, 45056
    s_mov_b32 s32, 23068672
L_rl_common_75:
    s_and_b32 s25, s25, 0xffff
    s_lshl_b32 s33, s30, 2
    s_mul_i32 s33, s33, s34
    s_add_u32 s32, s32, s33
    s_lshl_b32 s33, s29, 10
    s_add_u32 s65, s32, s33
    s_mov_b32 s66, s34
    s_mov_b32 s67, s31
    s_lshl_b32 s33, s29, 5
    v_add_u32 v6, s33, v8
    v_mul_lo_u32 v6, v6, s28
    s_lshl_b32 s33, s30, 6
    v_lshl_add_u32 v7, v9, 3, s33
    v_lshl_add_u32 v6, v7, 1, v6
    v_cmp_gt_u32 vcc, s35, v7
    v_mov_b32 v7, 0x7ffffff0
    s_lshl_b32 s33, s28, 3
    v_cndmask_b32 v6, v7, v6, vcc
    s_lshl_b32 s60, s33, 1
    s_add_u32 s61, s60, s33
    buffer_load_dwordx4 v[32:35], v6, s[24:27], 0 offen
    buffer_load_dwordx4 v[36:39], v6, s[24:27], s33 offen
    buffer_load_dwordx4 v[40:43], v6, s[24:27], s60 offen
    buffer_load_dwordx4 v[44:47], v6, s[24:27], s61 offen
    s_add_u32 s98, s98, 896
    s_mov_b32 s68, -1
    s_cmp_ge_u32 s98, 5152
    s_cbranch_scc1 L_rl_store_69
    s_mov_b32 s27, 0x00020000
    s_mov_b32 s35, 0x7fffffff
    s_cmp_ge_u32 s98, 3072
    s_cbranch_scc1 L_cB_80
    s_lshr_b32 s33, s98, 10
    s_cmp_eq_u32 s33, 1
    s_cselect_b32 s24, s42, s40
    s_cselect_b32 s25, s43, s41
    s_cmp_eq_u32 s33, 2
    s_cselect_b32 s24, s44, s24
    s_cselect_b32 s25, s45, s25
    s_mov_b32 s26, 4194304
    s_mov_b32 s28, 8192
    s_and_b32 s29, s98, 15
    s_lshr_b32 s30, s98, 4
    s_and_b32 s30, s30, 63
    s_mov_b32 s31, 0
    s_mov_b32 s34, 16384
    s_lshl_b32 s32, s33, 22
    s_add_u32 s32, s32, 2097152
    s_branch L_rl_common_79
L_cB_80:
    s_cmp_ge_u32 s98, 4096
    s_cbranch_scc1 L_cC_81
    s_sub_u32 s33, s98, 3072
    s_mov_b32 s24, s46
    s_mov_b32 s25, s47
    s_mov_b32 s26, 4194304
    s_mov_b32 s28, 1024
    s_and_b32 s29, s33, 127
    s_lshr_b32 s30, s33, 7
    s_mov_b32 s31, 1
    s_mov_b32 s34, 131072
    s_mov_b32 s32, 14680064
    s_branch L_rl_common_79
L_cC_81:
    s_cmp_ge_u32 s98, 4800
    s_cbranch_scc1 L_cD_82
    s_sub_u32 s33, s98, 4096
    s_cmp_ge_u32 s33, 352
    s_cselect_b32 s24, s54, s52
    s_cselect_b32 s25, s55, s53
    s_mov_b32 s32, 18874368
    s_cselect_b32 s32, 20971520, s32
    s_cselect_b32 s34, 352, 0
    s_sub_u32 s33, s33, s34
    s_mov_b32 s26, 1409024
    s_mov_b32 s28, 2752
    s_and_b32 s29, s33, 15
    s_lshr_b32 s30, s33, 4
    s_mov_b32 s31, 0
    s_mov_b32 s34, 16384
    s_mov_b32 s35, 1376
    s_branch L_rl_common_79
L_cD_82:
    s_sub_u32 s33, s98, 4800
    s_mov_b32 s24, s56
    s_mov_b32 s25, s57
    s_mul_i32 s30, s33, 1490
    s_lshr_b32 s30, s30, 16
    s_mul_i32 s34, s30, 44
    s_sub_u32 s29, s33, s34
    s_cmp_lt_u32 s29, 43
    s_cselect_b32 s26, 1409024, 0
    s_mov_b32 s28, 1024
    s_mov_b32 s31, 1
    s_mov_b32 s34, 45056
    s_mov_b32 s32, 23068672
L_rl_common_79:
    s_and_b32 s25, s25, 0xffff
    s_lshl_b32 s33, s30, 2
    s_mul_i32 s33, s33, s34
    s_add_u32 s32, s32, s33
    s_lshl_b32 s33, s29, 10
    s_add_u32 s68, s32, s33
    s_mov_b32 s69, s34
    s_mov_b32 s70, s31
    s_lshl_b32 s33, s29, 5
    v_add_u32 v6, s33, v8
    v_mul_lo_u32 v6, v6, s28
    s_lshl_b32 s33, s30, 6
    v_lshl_add_u32 v7, v9, 3, s33
    v_lshl_add_u32 v6, v7, 1, v6
    v_cmp_gt_u32 vcc, s35, v7
    v_mov_b32 v7, 0x7ffffff0
    s_lshl_b32 s33, s28, 3
    v_cndmask_b32 v6, v7, v6, vcc
    s_lshl_b32 s60, s33, 1
    s_add_u32 s61, s60, s33
    buffer_load_dwordx4 v[48:51], v6, s[24:27], 0 offen
    buffer_load_dwordx4 v[52:55], v6, s[24:27], s33 offen
    buffer_load_dwordx4 v[56:59], v6, s[24:27], s60 offen
    buffer_load_dwordx4 v[60:63], v6, s[24:27], s61 offen
    s_add_u32 s98, s98, 896
L_rl_store_69:
    s_waitcnt vmcnt(0)
    s_cmp_eq_u32 s62, -1
    s_cbranch_scc1 L_rl_fin_70
    s_sub_u32 s33, 3, s64
    v_lshlrev_b32 v13, s33, v3
    v_add_u32 v13, v13, v11
    v_mul_u32_u24 v13, 144, v13
    v_lshl_add_u32 v13, v12, 3, v13
    v_add_u32 v13, s21, v13
    s_mul_i32 s33, s64, 12
    s_add_u32 s33, s33, 4
    s_mul_i32 s33, s33, 144
    v_add_u32 v14, s33, v13
    ds_write_b128 v10, v[16:19] offset:0
    ds_write_b128 v10, v[20:23] offset:1152
    ds_write_b128 v10, v[24:27] offset:2304
    ds_write_b128 v10, v[28:31] offset:3456
    s_waitcnt lgkmcnt(0)
    ds_read_b64_tr_b16 v[16:17], v13 offset:0
    ds_read_b64_tr_b16 v[18:19], v14 offset:0
    ds_read_b64_tr_b16 v[20:21], v13 offset:32
    ds_read_b64_tr_b16 v[22:23], v14 offset:32
    ds_read_b64_tr_b16 v[24:25], v13 offset:64
    ds_read_b64_tr_b16 v[26:27], v14 offset:64
    ds_read_b64_tr_b16 v[28:29], v13 offset:96
    ds_read_b64_tr_b16 v[30:31], v14 offset:96
    s_waitcnt lgkmcnt(0)
    buffer_store_dwordx4 v[16:19], v4, s[8:11], s62 offen sc1
    s_add_u32 s62, s62, s63
    buffer_store_dwordx4 v[20:23], v4, s[8:11], s62 offen sc1
    s_add_u32 s62, s62, s63
    buffer_store_dwordx4 v[24:27], v4, s[8:11], s62 offen sc1
    s_add_u32 s62, s62, s63
    buffer_store_dwordx4 v[28:31], v4, s[8:11], s62 offen sc1
    s_add_u32 s62, s62, s63
    s_cmp_eq_u32 s65, -1
    s_cbranch_scc1 L_rl_fin_70
    s_sub_u32 s33, 3, s67
    v_lshlrev_b32 v13, s33, v3
    v_add_u32 v13, v13, v11
    v_mul_u32_u24 v13, 144, v13
    v_lshl_add_u32 v13, v12, 3, v13
    v_add_u32 v13, s21, v13
    s_mul_i32 s33, s67, 12
    s_add_u32 s33, s33, 4
    s_mul_i32 s33, s33, 144
    v_add_u32 v14, s33, v13
    ds_write_b128 v10, v[32:35] offset:0
    ds_write_b128 v10, v[36:39] offset:1152
    ds_write_b128 v10, v[40:43] offset:2304
    ds_write_b128 v10, v[44:47] offset:3456
    s_waitcnt lgkmcnt(0)
    ds_read_b64_tr_b16 v[32:33], v13 offset:0
    ds_read_b64_tr_b16 v[34:35], v14 offset:0
    ds_read_b64_tr_b16 v[36:37], v13 offset:32
    ds_read_b64_tr_b16 v[38:39], v14 offset:32
    ds_read_b64_tr_b16 v[40:41], v13 offset:64
    ds_read_b64_tr_b16 v[42:43], v14 offset:64
    ds_read_b64_tr_b16 v[44:45], v13 offset:96
    ds_read_b64_tr_b16 v[46:47], v14 offset:96
    s_waitcnt lgkmcnt(0)
    buffer_store_dwordx4 v[32:35], v4, s[8:11], s65 offen sc1
    s_add_u32 s65, s65, s66
    buffer_store_dwordx4 v[36:39], v4, s[8:11], s65 offen sc1
    s_add_u32 s65, s65, s66
    buffer_store_dwordx4 v[40:43], v4, s[8:11], s65 offen sc1
    s_add_u32 s65, s65, s66
    buffer_store_dwordx4 v[44:47], v4, s[8:11], s65 offen sc1
    s_add_u32 s65, s65, s66
    s_cmp_eq_u32 s68, -1
    s_cbranch_scc1 L_rl_fin_70
    s_sub_u32 s33, 3, s70
    v_lshlrev_b32 v13, s33, v3
    v_add_u32 v13, v13, v11
    v_mul_u32_u24 v13, 144, v13
    v_lshl_add_u32 v13, v12, 3, v13
    v_add_u32 v13, s21, v13
    s_mul_i32 s33, s70, 12
    s_add_u32 s33, s33, 4
    s_mul_i32 s33, s33, 144
    v_add_u32 v14, s33, v13
    ds_write_b128 v10, v[48:51] offset:0
    ds_write_b128 v10, v[52:55] offset:1152
    ds_write_b128 v10, v[56:59] offset:2304
    ds_write_b128 v10, v[60:63] offset:3456
    s_waitcnt lgkmcnt(0)
    ds_read_b64_tr_b16 v[48:49], v13 offset:0
    ds_read_b64_tr_b16 v[50:51], v14 offset:0
    ds_read_b64_tr_b16 v[52:53], v13 offset:32
    ds_read_b64_tr_b16 v[54:55], v14 offset:32
    ds_read_b64_tr_b16 v[56:57], v13 offset:64
    ds_read_b64_tr_b16 v[58:59], v14 offset:64
    ds_read_b64_tr_b16 v[60:61], v13 offset:96
    ds_read_b64_tr_b16 v[62:63], v14 offset:96
    s_waitcnt lgkmcnt(0)
    buffer_store_dwordx4 v[48:51], v4, s[8:11], s68 offen sc1
    s_add_u32 s68, s68, s69
    buffer_store_dwordx4 v[52:55], v4, s[8:11], s68 offen sc1
    s_add_u32 s68, s68, s69
    buffer_store_dwordx4 v[56:59], v4, s[8:11], s68 offen sc1
    s_add_u32 s68, s68, s69
    buffer_store_dwordx4 v[60:63], v4, s[8:11], s68 offen sc1
    s_add_u32 s68, s68, s69
L_rl_fin_70:
    s_waitcnt vmcnt(0)
    s_barrier
    s_cmp_lg_u32 s20, 0
    s_cbranch_scc1 L_notlast2_83
    v_mov_b32 v12, 122739712
    v_mov_b32 v13, 1
    s_mov_b64 exec, 1
    buffer_atomic_add v13, v12, s[8:11], 0 offen sc0
    s_waitcnt vmcnt(0)
    v_readfirstlane_b32 s60, v13
    s_cmp_lg_u32 s60, 223
    s_cbranch_scc1 L_notlast3_84
    v_mov_b32 v12, 122739840
    v_mov_b32 v13, 1
    buffer_store_dword v13, v12, s[8:11], 0 offen sc1
L_notlast3_84:
    s_mov_b64 exec, -1
L_notlast2_83:
    s_mov_b32 s94, 122739840
    s_cmp_lg_u32 s20, 0
    s_cbranch_scc1 L_depok_86
    v_mov_b32 v12, 0
L_dep_85:
    buffer_load_dword v13, v12, s[8:11], s94 offen sc1
    s_add_u32 s96, s96, 1
    s_cmp_gt_u32 s96, 4194304
    s_cbranch_scc1 L_depok_86
    s_waitcnt vmcnt(0)
    v_readfirstlane_b32 s60, v13
    s_cmp_ge_u32 s60, 1
    s_cbranch_scc1 L_depok_86
    s_sleep 6
    s_branch L_dep_85
L_depok_86:
    s_barrier
L_task2_87:
    s_cmp_ge_u32 s90, 6192
    s_cbranch_scc1 L_fused_done_1
    s_mul_hi_u32 s91, s90, 24970741
    s_mul_i32 s60, s91, 172
    s_sub_u32 s92, s90, s60
    s_cmp_ge_u32 s92, 16
    s_cbranch_scc1 L_stB_89
    s_sub_u32 s93, s91, 0
    s_cmp_ge_u32 s93, 32
    s_cbranch_scc1 L_next2_88
    s_lshr_b32 s95, s92, 3
    s_lshl_b32 s60, s93, 1
    s_add_u32 s95, s95, s60
    s_lshr_b32 s61, s95, 2
    s_lshl_b32 s94, s61, 7
    s_add_u32 s94, s94, 122683392
    s_cmp_lg_u32 s20, 0
    s_cbranch_scc1 L_depok_94
    v_mov_b32 v12, 0
L_dep_93:
    buffer_load_dword v13, v12, s[8:11], s94 offen sc1
    s_add_u32 s96, s96, 1
    s_cmp_gt_u32 s96, 4194304
    s_cbranch_scc1 L_depok_94
    s_waitcnt vmcnt(0)
    v_readfirstlane_b32 s60, v13
    s_cmp_ge_u32 s60, 96
    s_cbranch_scc1 L_depok_94
    s_sleep 6
    s_branch L_dep_93
L_depok_94:
    s_barrier
    s_lshl_b32 s94, s95, 9
    s_and_b32 s60, s92, 7
    s_lshl_b32 s60, s60, 6
    s_add_u32 s94, s94, s60
    s_add_u32 s94, s94, 122748928
    s_and_b32 s3, s92, 7
    s_lshl_b32 s3, s3, 2
    s_add_u32 s3, s3, s20
    s_lshl_b32 s60, s95, 5
    s_add_u32 s3, s3, s60
    s_lshl_b32 s4, s3, 13
    s_add_u32 s5, s4, 25165824
    buffer_load_dwordx4 v[16:19], v4, s[8:11], s5 offen offset:0 sc1
    buffer_load_dwordx4 v[20:23], v4, s[8:11], s5 offen offset:1024 sc1
    buffer_load_dwordx4 v[24:27], v4, s[8:11], s5 offen offset:2048 sc1
    buffer_load_dwordx4 v[28:31], v4, s[8:11], s5 offen offset:3072 sc1
    s_add_u32 s5, s5, 4096
    buffer_load_dwordx4 v[32:35], v4, s[8:11], s5 offen offset:0 sc1
    buffer_load_dwordx4 v[36:39], v4, s[8:11], s5 offen offset:1024 sc1
    buffer_load_dwordx4 v[40:43], v4, s[8:11], s5 offen offset:2048 sc1
    buffer_load_dwordx4 v[44:47], v4, s[8:11], s5 offen offset:3072 sc1
    s_add_u32 s5, s4, 41943040
    buffer_load_dwordx4 v[48:51], v4, s[8:11], s5 offen offset:0 sc1
    buffer_load_dwordx4 v[52:55], v4, s[8:11], s5 offen offset:1024 sc1
    buffer_load_dwordx4 v[56:59], v4, s[8:11], s5 offen offset:2048 sc1
    buffer_load_dwordx4 v[60:63], v4, s[8:11], s5 offen offset:3072 sc1
    s_add_u32 s5, s5, 4096
    buffer_load_dwordx4 v[64:67], v4, s[8:11], s5 offen offset:0 sc1
    buffer_load_dwordx4 v[68:71], v4, s[8:11], s5 offen offset:1024 sc1
    buffer_load_dwordx4 v[72:75], v4, s[8:11], s5 offen offset:2048 sc1
    buffer_load_dwordx4 v[76:79], v4, s[8:11], s5 offen offset:3072 sc1
    s_add_u32 s5, s4, 58720256
    buffer_load_dwordx4 v[80:83], v4, s[8:11], s5 offen offset:0 sc1
    buffer_load_dwordx4 v[84:87], v4, s[8:11], s5 offen offset:1024 sc1
    buffer_load_dwordx4 v[88:91], v4, s[8:11], s5 offen offset:2048 sc1
    buffer_load_dwordx4 v[92:95], v4, s[8:11], s5 offen offset:3072 sc1
    s_add_u32 s5, s5, 4096
    buffer_load_dwordx4 v[96:99], v4, s[8:11], s5 offen offset:0 sc1
    buffer_load_dwordx4 v[100:103], v4, s[8:11], s5 offen offset:1024 sc1
    buffer_load_dwordx4 v[104:107], v4, s[8:11], s5 offen offset:2048 sc1
    buffer_load_dwordx4 v[108:111], v4, s[8:11], s5 offen offset:3072 sc1
    s_cmp_lg_u32 s20, 0
    s_cbranch_scc1 L_depok_96
    v_and_b32 v12, 15, v1
    v_lshlrev_b32 v12, 2, v12
L_dep_95:
    buffer_load_dword v13, v12, s[8:11], s94 offen sc1
    s_add_u32 s96, s96, 1
    s_cmp_gt_u32 s96, 4194304
    s_cbranch_scc1 L_depok_96
    s_waitcnt vmcnt(0)
    v_cmp_eq_u32 vcc, 0, v13
    s_cbranch_vccz L_depok_96
    s_sleep 6
    s_branch L_dep_95
L_depok_96:
    s_barrier
    s_lshl_b32 s4, s3, 12
    s_add_u32 s5, s4, 75497472
    buffer_load_dwordx4 v[112:115], v4, s[8:11], s5 offen offset:0 sc1
    buffer_load_dwordx4 v[116:119], v4, s[8:11], s5 offen offset:1024 sc1
    buffer_load_dwordx4 v[120:123], v4, s[8:11], s5 offen offset:2048 sc1
    buffer_load_dwordx4 v[124:127], v4, s[8:11], s5 offen offset:3072 sc1
    s_add_u32 s5, s4, 83886080
    v_lshlrev_b32 v5, 3, v1
    buffer_load_dwordx2 v[128:129], v5, s[8:11], s5 offen offset:0 sc1
    buffer_load_dwordx2 v[130:131], v5, s[8:11], s5 offen offset:512 sc1
    buffer_load_dwordx2 v[132:133], v5, s[8:11], s5 offen offset:1024 sc1
    buffer_load_dwordx2 v[134:135], v5, s[8:11], s5 offen offset:1536 sc1
    buffer_load_dwordx2 v[136:137], v5, s[8:11], s5 offen offset:2048 sc1
    buffer_load_dwordx2 v[138:139], v5, s[8:11], s5 offen offset:2560 sc1
    buffer_load_dwordx2 v[140:141], v5, s[8:11], s5 offen offset:3072 sc1
    buffer_load_dwordx2 v[142:143], v5, s[8:11], s5 offen offset:3584 sc1
    v_mov_b32 v144, 0
    v_mov_b32 v145, 0
    v_mov_b32 v146, 0
    v_mov_b32 v147, 0
    v_mov_b32 v148, 0
    v_mov_b32 v149, 0
    v_mov_b32 v150, 0
    v_mov_b32 v151, 0
    v_mov_b32 v152, 0
    v_mov_b32 v153, 0
    v_mov_b32 v154, 0
    v_mov_b32 v155, 0
    v_mov_b32 v156, 0
    v_mov_b32 v157, 0
    v_mov_b32 v158, 0
    v_mov_b32 v159, 0
    v_mov_b32 v160, 0
    v_mov_b32 v161, 0
    v_mov_b32 v162, 0
    v_mov_b32 v163, 0
    v_mov_b32 v164, 0
    v_mov_b32 v165, 0
    v_mov_b32 v166, 0
    v_mov_b32 v167, 0
    s_waitcnt vmcnt(0)
    v_mfma_f32_16x16x32_bf16 v[144:147], v[112:115], v[16:19], v[144:147]
    v_mfma_f32_16x16x32_bf16 v[144:147], v[116:119], v[24:27], v[144:147]
    v_mfma_f32_16x16x32_bf16 v[144:147], v[120:123], v[32:35], v[144:147]
    v_mfma_f32_16x16x32_bf16 v[144:147], v[124:127], v[40:43], v[144:147]
    v_mfma_f32_16x16x32_bf16 v[148:151], v[48:51], v[16:19], v[148:151]
    v_mfma_f32_16x16x32_bf16 v[148:151], v[56:59], v[24:27], v[148:151]
    v_mfma_f32_16x16x32_bf16 v[148:151], v[64:67], v[32:35], v[148:151]
    v_mfma_f32_16x16x32_bf16 v[148:151], v[72:75], v[40:43], v[148:151]
    v_mfma_f32_16x16x32_bf16 v[156:159], v[112:115], v[20:23], v[156:159]
    v_mfma_f32_16x16x32_bf16 v[156:159], v[116:119], v[28:31], v[156:159]
    v_mfma_f32_16x16x32_bf16 v[156:159], v[120:123], v[36:39], v[156:159]
    v_mfma_f32_16x16x32_bf16 v[156:159], v[124:127], v[44:47], v[156:159]
    v_mfma_f32_16x16x32_bf16 v[160:163], v[48:51], v[20:23], v[160:163]
    v_mfma_f32_16x16x32_bf16 v[160:163], v[56:59], v[28:31], v[160:163]
    v_mfma_f32_16x16x32_bf16 v[160:163], v[64:67], v[36:39], v[160:163]
    v_mfma_f32_16x16x32_bf16 v[160:163], v[72:75], v[44:47], v[160:163]
    v_mfma_f32_16x16x32_bf16 v[164:167], v[52:55], v[20:23], v[164:167]
    v_mfma_f32_16x16x32_bf16 v[164:167], v[60:63], v[28:31], v[164:167]
    v_mfma_f32_16x16x32_bf16 v[164:167], v[68:71], v[36:39], v[164:167]
    v_mfma_f32_16x16x32_bf16 v[164:167], v[76:79], v[44:47], v[164:167]
    s_nop 9
    v_mov_b32 v6, 0xff800000
    v_lshlrev_b32 v7, 2, v3
    v_cmp_gt_u32 vcc, 2, v3
    s_nop 1
    v_cndmask_b32 v144, v6, v144, vcc
    v_cndmask_b32 v145, v6, v145, vcc
    v_cndmask_b32 v146, v6, v146, vcc
    v_cndmask_b32 v147, v6, v147, vcc
    v_cndmask_b32 v156, v6, v156, vcc
    v_cndmask_b32 v157, v6, v157, vcc
    v_cndmask_b32 v158, v6, v158, vcc
    v_cndmask_b32 v159, v6, v159, vcc
    v_add_u32 v8, 0, v7
    v_cmp_ge_u32 vcc, v2, v8
    s_nop 1
    v_cndmask_b32 v148, v6, v148, vcc
    v_cndmask_b32 v164, v6, v164, vcc
    v_add_u32 v8, 1, v7
    v_cmp_ge_u32 vcc, v2, v8
    s_nop 1
    v_cndmask_b32 v149, v6, v149, vcc
    v_cndmask_b32 v165, v6, v165, vcc
    v_add_u32 v8, 2, v7
    v_cmp_ge_u32 vcc, v2, v8
    s_nop 1
    v_cndmask_b32 v150, v6, v150, vcc
    v_cndmask_b32 v166, v6, v166, vcc
    v_add_u32 v8, 3, v7
    v_cmp_ge_u32 vcc, v2, v8
    s_nop 1
    v_cndmask_b32 v151, v6, v151, vcc
    v_cndmask_b32 v167, v6, v167, vcc
    v_max_f32 v244, v144, v145
    v_max3_f32 v244, v244, v146, v147
    v_max3_f32 v244, v244, v148, v149
    v_max3_f32 v244, v244, v150, v151
    v_mov_b32 v245, v244
    s_nop 1
    v_permlane16_swap_b32 v244, v245
    v_max_f32 v244, v244, v245
    v_mov_b32 v245, v244
    s_nop 1
    v_permlane32_swap_b32 v244, v245
    v_max_f32 v244, v244, v245
    v_mul_f32 v244, 0xbe0293ee, v244
    v_mov_b32 v246, 0x3e0293ee
    v_fma_f32 v144, v144, v246, v244
    v_fma_f32 v145, v145, v246, v244
    v_fma_f32 v146, v146, v246, v244
    v_fma_f32 v147, v147, v246, v244
    v_fma_f32 v148, v148, v246, v244
    v_fma_f32 v149, v149, v246, v244
    v_fma_f32 v150, v150, v246, v244
    v_fma_f32 v151, v151, v246, v244
    v_exp_f32 v144, v144
    v_exp_f32 v145, v145
    v_exp_f32 v146, v146
    v_exp_f32 v147, v147
    v_exp_f32 v148, v148
    v_exp_f32 v149, v149
    v_exp_f32 v150, v150
    v_exp_f32 v151, v151
    s_nop 0
    v_add_f32 v244, v144, v145
    v_add_f32 v244, v244, v146
    v_add_f32 v244, v244, v147
    v_add_f32 v244, v244, v148
    v_add_f32 v244, v244, v149
    v_add_f32 v244, v244, v150
    v_add_f32 v244, v244, v151
    v_mov_b32 v245, v244
    s_nop 1
    v_permlane16_swap_b32 v244, v245
    v_add_f32 v244, v244, v245
    v_mov_b32 v245, v244
    s_nop 1
    v_permlane32_swap_b32 v244, v245
    v_add_f32 v244, v244, v245
    v_rcp_f32 v244, v244
    s_nop 0
    v_mul_f32 v144, v144, v244
    v_mul_f32 v145, v145, v244
    v_mul_f32 v146, v146, v244
    v_mul_f32 v147, v147, v244
    v_mul_f32 v148, v148, v244
    v_mul_f32 v149, v149, v244
    v_mul_f32 v150, v150, v244
    v_mul_f32 v151, v151, v244
    v_max_f32 v244, v156, v157
    v_max3_f32 v244, v244, v158, v159
    v_max3_f32 v244, v244, v160, v161
    v_max3_f32 v244, v244, v162, v163
    v_max3_f32 v244, v244, v164, v165
    v_max3_f32 v244, v244, v166, v167
    v_mov_b32 v245, v244
    s_nop 1
    v_permlane16_swap_b32 v244, v245
    v_max_f32 v244, v244, v245
    v_mov_b32 v245, v244
    s_nop 1
    v_permlane32_swap_b32 v244, v245
    v_max_f32 v244, v244, v245
    v_mul_f32 v244, 0xbe0293ee, v244
    v_mov_b32 v246, 0x3e0293ee
    v_fma_f32 v156, v156, v246, v244
    v_fma_f32 v157, v157, v246, v244
    v_fma_f32 v158, v158, v246, v244
    v_fma_f32 v159, v159, v246, v244
    v_fma_f32 v160, v160, v246, v244
    v_fma_f32 v161, v161, v246, v244
    v_fma_f32 v162, v162, v246, v244
    v_fma_f32 v163, v163, v246, v244
    v_fma_f32 v164, v164, v246, v244
    v_fma_f32 v165, v165, v246, v244
    v_fma_f32 v166, v166, v246, v244
    v_fma_f32 v167, v167, v246, v244
    v_exp_f32 v156, v156
    v_exp_f32 v157, v157
    v_exp_f32 v158, v158
    v_exp_f32 v159, v159
    v_exp_f32 v160, v160
    v_exp_f32 v161, v161
    v_exp_f32 v162, v162
    v_exp_f32 v163, v163
    v_exp_f32 v164, v164
    v_exp_f32 v165, v165
    v_exp_f32 v166, v166
    v_exp_f32 v167, v167
    s_nop 0
    v_add_f32 v244, v156, v157
    v_add_f32 v244, v244, v158
    v_add_f32 v244, v244, v159
    v_add_f32 v244, v244, v160
    v_add_f32 v244, v244, v161
    v_add_f32 v244, v244, v162
    v_add_f32 v244, v244, v163
    v_add_f32 v244, v244, v164
    v_add_f32 v244, v244, v165
    v_add_f32 v244, v244, v166
    v_add_f32 v244, v244, v167
    v_mov_b32 v245, v244
    s_nop 1
    v_permlane16_swap_b32 v244, v245
    v_add_f32 v244, v244, v245
    v_mov_b32 v245, v244
    s_nop 1
    v_permlane32_swap_b32 v244, v245
    v_add_f32 v244, v244, v245
    v_rcp_f32 v244, v244
    s_nop 0
    v_mul_f32 v156, v156, v244
    v_mul_f32 v157, v157, v244
    v_mul_f32 v158, v158, v244
    v_mul_f32 v159, v159, v244
    v_mul_f32 v160, v160, v244
    v_mul_f32 v161, v161, v244
    v_mul_f32 v162, v162, v244
    v_mul_f32 v163, v163, v244
    v_mul_f32 v164, v164, v244
    v_mul_f32 v165, v165, v244
    v_mul_f32 v166, v166, v244
    v_mul_f32 v167, v167, v244
    v_cvt_pk_bf16_f32 v168, v148, v149
    v_cvt_pk_bf16_f32 v169, v150, v151
    v_mov_b32 v170, 0
    v_mov_b32 v171, 0
    v_cvt_pk_bf16_f32 v172, v144, v145
    v_cvt_pk_bf16_f32 v173, v146, v147
    v_cvt_pk_bf16_f32 v174, v160, v161
    v_cvt_pk_bf16_f32 v175, v162, v163
    v_cvt_pk_bf16_f32 v176, v164, v165
    v_cvt_pk_bf16_f32 v177, v166, v167
    v_cvt_pk_bf16_f32 v178, v156, v157
    v_cvt_pk_bf16_f32 v179, v158, v159
    v_mov_b32 v180, 0
    v_mov_b32 v181, 0
    v_mov_b32 v182, 0
    v_mov_b32 v183, 0
    v_mov_b32 v184, 0
    v_mov_b32 v185, 0
    v_mov_b32 v186, 0
    v_mov_b32 v187, 0
    v_mov_b32 v188, 0
    v_mov_b32 v189, 0
    v_mov_b32 v190, 0
    v_mov_b32 v191, 0
    v_mov_b32 v192, 0
    v_mov_b32 v193, 0
    v_mov_b32 v194, 0
    v_mov_b32 v195, 0
    v_mov_b32 v196, 0
    v_mov_b32 v197, 0
    v_mov_b32 v198, 0
    v_mov_b32 v199, 0
    v_mov_b32 v200, 0
    v_mov_b32 v201, 0
    v_mov_b32 v202, 0
    v_mov_b32 v203, 0
    v_mov_b32 v204, 0
    v_mov_b32 v205, 0
    v_mov_b32 v206, 0
    v_mov_b32 v207, 0
    v_mov_b32 v208, 0
    v_mov_b32 v209, 0
    v_mov_b32 v210, 0
    v_mov_b32 v211, 0
    v_mov_b32 v212, 0
    v_mov_b32 v213, 0
    v_mov_b32 v214, 0
    v_mov_b32 v215, 0
    v_mov_b32 v216, 0
    v_mov_b32 v217, 0
    v_mov_b32 v218, 0
    v_mov_b32 v219, 0
    v_mov_b32 v220, 0
    v_mov_b32 v221, 0
    v_mov_b32 v222, 0
    v_mov_b32 v223, 0
    v_mov_b32 v224, 0
    v_mov_b32 v225, 0
    v_mov_b32 v226, 0
    v_mov_b32 v227, 0
    v_mov_b32 v228, 0
    v_mov_b32 v229, 0
    v_mov_b32 v230, 0
    v_mov_b32 v231, 0
    v_mov_b32 v232, 0
    v_mov_b32 v233, 0
    v_mov_b32 v234, 0
    v_mov_b32 v235, 0
    v_mov_b32 v236, 0
    v_mov_b32 v237, 0
    v_mov_b32 v238, 0
    v_mov_b32 v239, 0
    v_mov_b32 v240, 0
    v_mov_b32 v241, 0
    v_mov_b32 v242, 0
    v_mov_b32 v243, 0
    s_nop 1
    v_mfma_f32_16x16x32_bf16 v[180:183], v[80:83], v[168:171], v[180:183]
    v_mfma_f32_16x16x32_bf16 v[184:187], v[84:87], v[168:171], v[184:187]
    v_mfma_f32_16x16x32_bf16 v[188:191], v[88:91], v[168:171], v[188:191]
    v_mfma_f32_16x16x32_bf16 v[192:195], v[92:95], v[168:171], v[192:195]
    v_mfma_f32_16x16x32_bf16 v[196:199], v[96:99], v[168:171], v[196:199]
    v_mfma_f32_16x16x32_bf16 v[200:203], v[100:103], v[168:171], v[200:203]
    v_mfma_f32_16x16x32_bf16 v[204:207], v[104:107], v[168:171], v[204:207]
    v_mfma_f32_16x16x32_bf16 v[208:211], v[108:111], v[168:171], v[208:211]
    v_mfma_f32_16x16x32_bf16 v[212:215], v[80:83], v[174:177], v[212:215]
    v_mfma_f32_16x16x32_bf16 v[216:219], v[84:87], v[174:177], v[216:219]
    v_mfma_f32_16x16x32_bf16 v[220:223], v[88:91], v[174:177], v[220:223]
    v_mfma_f32_16x16x32_bf16 v[224:227], v[92:95], v[174:177], v[224:227]
    v_mfma_f32_16x16x32_bf16 v[228:231], v[96:99], v[174:177], v[228:231]
    v_mfma_f32_16x16x32_bf16 v[232:235], v[100:103], v[174:177], v[232:235]
    v_mfma_f32_16x16x32_bf16 v[236:239], v[104:107], v[174:177], v[236:239]
    v_mfma_f32_16x16x32_bf16 v[240:243], v[108:111], v[174:177], v[240:243]
    v_mfma_f32_16x16x16_bf16 v[180:183], v[128:129], v[172:173], v[180:183]
    v_mfma_f32_16x16x16_bf16 v[184:187], v[130:131], v[172:173], v[184:187]
    v_mfma_f32_16x16x16_bf16 v[188:191], v[132:133], v[172:173], v[188:191]
    v_mfma_f32_16x16x16_bf16 v[192:195], v[134:135], v[172:173], v[192:195]
    v_mfma_f32_16x16x16_bf16 v[196:199], v[136:137], v[172:173], v[196:199]
    v_mfma_f32_16x16x16_bf16 v[200:203], v[138:139], v[172:173], v[200:203]
    v_mfma_f32_16x16x16_bf16 v[204:207], v[140:141], v[172:173], v[204:207]
    v_mfma_f32_16x16x16_bf16 v[208:211], v[142:143], v[172:173], v[208:211]
    v_mfma_f32_16x16x16_bf16 v[212:215], v[128:129], v[178:179], v[212:215]
    v_mfma_f32_16x16x16_bf16 v[216:219], v[130:131], v[178:179], v[216:219]
    v_mfma_f32_16x16x16_bf16 v[220:223], v[132:133], v[178:179], v[220:223]
    v_mfma_f32_16x16x16_bf16 v[224:227], v[134:135], v[178:179], v[224:227]
    v_mfma_f32_16x16x16_bf16 v[228:231], v[136:137], v[178:179], v[228:231]
    v_mfma_f32_16x16x16_bf16 v[232:235], v[138:139], v[178:179], v[232:235]
    v_mfma_f32_16x16x16_bf16 v[236:239], v[140:141], v[178:179], v[236:239]
    v_mfma_f32_16x16x16_bf16 v[240:243], v[142:143], v[178:179], v[240:243]
    s_nop 9
    s_lshr_b32 s4, s3, 5
    s_lshl_b32 s4, s4, 18
    s_and_b32 s5, s3, 31
    s_lshl_b32 s5, s5, 12
    s_add_u32 s4, s4, s5
    s_add_u32 s4, s4, 92274688
    v_cvt_pk_bf16_f32 v180, v180, v181
    v_cvt_pk_bf16_f32 v181, v182, v183
    v_cvt_pk_bf16_f32 v182, v184, v185
    v_cvt_pk_bf16_f32 v183, v186, v187
    buffer_store_dwordx4 v[180:183], v4, s[8:11], s4 offen offset:0 sc1
    v_cvt_pk_bf16_f32 v188, v188, v189
    v_cvt_pk_bf16_f32 v189, v190, v191
    v_cvt_pk_bf16_f32 v190, v192, v193
    v_cvt_pk_bf16_f32 v191, v194, v195
    buffer_store_dwordx4 v[188:191], v4, s[8:11], s4 offen offset:1024 sc1
    v_cvt_pk_bf16_f32 v196, v196, v197
    v_cvt_pk_bf16_f32 v197, v198, v199
    v_cvt_pk_bf16_f32 v198, v200, v201
    v_cvt_pk_bf16_f32 v199, v202, v203
    buffer_store_dwordx4 v[196:199], v4, s[8:11], s4 offen offset:2048 sc1
    v_cvt_pk_bf16_f32 v204, v204, v205
    v_cvt_pk_bf16_f32 v205, v206, v207
    v_cvt_pk_bf16_f32 v206, v208, v209
    v_cvt_pk_bf16_f32 v207, v210, v211
    buffer_store_dwordx4 v[204:207], v4, s[8:11], s4 offen offset:3072 sc1
    s_add_u32 s4, s4, 131072
    v_cvt_pk_bf16_f32 v212, v212, v213
    v_cvt_pk_bf16_f32 v213, v214, v215
    v_cvt_pk_bf16_f32 v214, v216, v217
    v_cvt_pk_bf16_f32 v215, v218, v219
    buffer_store_dwordx4 v[212:215], v4, s[8:11], s4 offen offset:0 sc1
    v_cvt_pk_bf16_f32 v220, v220, v221
    v_cvt_pk_bf16_f32 v221, v222, v223
    v_cvt_pk_bf16_f32 v222, v224, v225
    v_cvt_pk_bf16_f32 v223, v226, v227
    buffer_store_dwordx4 v[220:223], v4, s[8:11], s4 offen offset:1024 sc1
    v_cvt_pk_bf16_f32 v228, v228, v229
    v_cvt_pk_bf16_f32 v229, v230, v231
    v_cvt_pk_bf16_f32 v230, v232, v233
    v_cvt_pk_bf16_f32 v231, v234, v235
    buffer_store_dwordx4 v[228:231], v4, s[8:11], s4 offen offset:2048 sc1
    v_cvt_pk_bf16_f32 v236, v236, v237
    v_cvt_pk_bf16_f32 v237, v238, v239
    v_cvt_pk_bf16_f32 v238, v240, v241
    v_cvt_pk_bf16_f32 v239, v242, v243
    buffer_store_dwordx4 v[236:239], v4, s[8:11], s4 offen offset:3072 sc1
    s_and_b32 s61, s92, 7
    s_lshl_b32 s62, s93, 3
    s_add_u32 s61, s61, s62
    s_waitcnt vmcnt(0)
    s_barrier
    s_lshl_b32 s60, s61, 7
    s_add_u32 s60, s60, 122687488
    s_cmp_lg_u32 s20, 0
    s_cbranch_scc1 L_nosig_97
    v_mov_b32 v7, s60
    v_mov_b32 v8, 1
    s_mov_b64 exec, 1
    buffer_atomic_add v8, v7, s[8:11], 0 offen
    s_mov_b64 exec, -1
L_nosig_97:
    s_branch L_next2_88
L_stB_89:
    s_cmp_ge_u32 s92, 80
    s_cbranch_scc1 L_stL_90
    s_sub_u32 s93, s91, 1
    s_cmp_ge_u32 s93, 32
    s_cbranch_scc1 L_next2_88
    s_sub_u32 s92, s92, 16
    s_lshr_b32 s95, s92, 3
    s_lshl_b32 s61, s93, 3
    s_add_u32 s61, s61, s95
    s_mov_b32 s99, s61
    s_lshl_b32 s21, s93, 2
    s_and_b32 s22, s92, 7
    s_lshl_b32 s22, s22, 2
    s_lshl_b32 s97, s95, 14
    s_lshr_b32 s23, s20, 1
    s_and_b32 s24, s20, 1
    s_add_u32 s60, s21, s20
    s_add_u32 s60, s60, 0
    s_mul_i32 s60, s60, 131072
    s_add_u32 s28, s60, 92274688
    s_add_u32 s60, s22, s20
    s_add_u32 s60, s60, 0
    s_mul_i32 s60, s60, 131072
    s_add_u32 s29, s60, 14680064
    s_add_u32 s60, s20, 0
    s_mul_i32 s30, s60, 4096
    s_add_u32 s60, s20, 4
    s_mul_i32 s31, s60, 4096
    s_add_u32 s28, s28, s97
    s_add_u32 s29, s29, s97
    s_mul_i32 s60, s23, 8192
    v_add_u32 v5, s60, v4
    s_mul_i32 s60, s24, 8192
    s_add_u32 s60, s60, 16384
    v_add_u32 v6, s60, v4
    v_add_u32 v7, 0x10000, v5
    v_add_u32 v8, 0x10000, v6
    v_add_u32 v9, 0x20000, v5
    v_add_u32 v10, 0x20000, v6
    v_mov_b64 v[16:17], 0
    v_mov_b64 v[18:19], 0
    v_mov_b64 v[20:21], 0
    v_mov_b64 v[22:23], 0
    v_mov_b64 v[24:25], 0
    v_mov_b64 v[26:27], 0
    v_mov_b64 v[28:29], 0
    v_mov_b64 v[30:31], 0
    s_barrier
    s_add_u32 m0, 0, s31
    s_nop 0
    buffer_load_dwordx4 v4, s[8:11], s29 offen offset:0 lds
    buffer_load_dwordx4 v4, s[8:11], s29 offen offset:1024 lds
    buffer_load_dwordx4 v4, s[8:11], s29 offen offset:2048 lds
    buffer_load_dwordx4 v4, s[8:11], s29 offen offset:3072 lds
    s_add_u32 s29, s29, 4096
    s_add_u32 m0, 32768, s31
    s_nop 0
    buffer_load_dwordx4 v4, s[8:11], s29 offen offset:0 lds
    buffer_load_dwordx4 v4, s[8:11], s29 offen offset:1024 lds
    buffer_load_dwordx4 v4, s[8:11], s29 offen offset:2048 lds
    buffer_load_dwordx4 v4, s[8:11], s29 offen offset:3072 lds
    s_add_u32 s29, s29, 4096
    s_add_u32 m0, 65536, s31
    s_nop 0
    buffer_load_dwordx4 v4, s[8:11], s29 offen offset:0 lds
    buffer_load_dwordx4 v4, s[8:11], s29 offen offset:1024 lds
    buffer_load_dwordx4 v4, s[8:11], s29 offen offset:2048 lds
    buffer_load_dwordx4 v4, s[8:11], s29 offen offset:3072 lds
    s_add_u32 s29, s29, 4096
    s_add_u32 m0, 98304, s31
    s_nop 0
    buffer_load_dwordx4 v4, s[8:11], s29 offen offset:0 lds
    buffer_load_dwordx4 v4, s[8:11], s29 offen offset:1024 lds
    buffer_load_dwordx4 v4, s[8:11], s29 offen offset:2048 lds
    buffer_load_dwordx4 v4, s[8:11], s29 offen offset:3072 lds
    s_add_u32 s29, s29, 4096
    s_lshl_b32 s94, s99, 7
    s_add_u32 s94, s94, 122687488
    s_cmp_lg_u32 s20, 0
    s_cbranch_scc1 L_depok_99
    v_mov_b32 v12, 0
L_dep_98:
    buffer_load_dword v13, v12, s[8:11], s94 offen sc1
    s_add_u32 s96, s96, 1
    s_cmp_gt_u32 s96, 4194304
    s_cbranch_scc1 L_depok_99
    s_waitcnt vmcnt(0)
    v_readfirstlane_b32 s60, v13
    s_cmp_ge_u32 s60, 2
    s_cbranch_scc1 L_depok_99
    s_sleep 6
    s_branch L_dep_98
L_depok_99:
    s_barrier
    s_add_u32 m0, 0, s30
    s_nop 0
    buffer_load_dwordx4 v4, s[8:11], s28 offen offset:0 sc1 lds
    buffer_load_dwordx4 v4, s[8:11], s28 offen offset:1024 sc1 lds
    buffer_load_dwordx4 v4, s[8:11], s28 offen offset:2048 sc1 lds
    buffer_load_dwordx4 v4, s[8:11], s28 offen offset:3072 sc1 lds
    s_add_u32 s28, s28, 4096
    s_add_u32 m0, 32768, s30
    s_nop 0
    buffer_load_dwordx4 v4, s[8:11], s28 offen offset:0 sc1 lds
    buffer_load_dwordx4 v4, s[8:11], s28 offen offset:1024 sc1 lds
    buffer_load_dwordx4 v4, s[8:11], s28 offen offset:2048 sc1 lds
    buffer_load_dwordx4 v4, s[8:11], s28 offen offset:3072 sc1 lds
    s_add_u32 s28, s28, 4096
    s_add_u32 m0, 65536, s30
    s_nop 0
    buffer_load_dwordx4 v4, s[8:11], s28 offen offset:0 sc1 lds
    buffer_load_dwordx4 v4, s[8:11], s28 offen offset:1024 sc1 lds
    buffer_load_dwordx4 v4, s[8:11], s28 offen offset:2048 sc1 lds
    buffer_load_dwordx4 v4, s[8:11], s28 offen offset:3072 sc1 lds
    s_add_u32 s28, s28, 4096
    s_add_u32 m0, 98304, s30
    s_nop 0
    buffer_load_dwordx4 v4, s[8:11], s28 offen offset:0 sc1 lds
    buffer_load_dwordx4 v4, s[8:11], s28 offen offset:1024 sc1 lds
    buffer_load_dwordx4 v4, s[8:11], s28 offen offset:2048 sc1 lds
    buffer_load_dwordx4 v4, s[8:11], s28 offen offset:3072 sc1 lds
    s_add_u32 s28, s28, 4096
    s_waitcnt vmcnt(12)
    s_barrier
    ds_read_b128 v[32:35], v5 offset:0
    ds_read_b128 v[36:39], v5 offset:4096
    ds_read_b128 v[40:43], v6 offset:0
    ds_read_b128 v[44:47], v6 offset:4096
    ds_read_b128 v[48:51], v5 offset:1024
    ds_read_b128 v[52:55], v5 offset:5120
    ds_read_b128 v[56:59], v6 offset:1024
    ds_read_b128 v[60:63], v6 offset:5120
    ds_read_b128 v[64:67], v5 offset:2048
    ds_read_b128 v[68:71], v5 offset:6144
    ds_read_b128 v[72:75], v6 offset:2048
    ds_read_b128 v[76:79], v6 offset:6144
    ds_read_b128 v[80:83], v5 offset:3072
    ds_read_b128 v[84:87], v5 offset:7168
    ds_read_b128 v[88:91], v6 offset:3072
    ds_read_b128 v[92:95], v6 offset:7168
    s_waitcnt lgkmcnt(12)
    v_mfma_f32_16x16x32_bf16 v[16:19], v[40:43], v[32:35], v[16:19]
    v_mfma_f32_16x16x32_bf16 v[20:23], v[44:47], v[32:35], v[20:23]
    v_mfma_f32_16x16x32_bf16 v[24:27], v[40:43], v[36:39], v[24:27]
    v_mfma_f32_16x16x32_bf16 v[28:31], v[44:47], v[36:39], v[28:31]
    s_waitcnt lgkmcnt(8)
    v_mfma_f32_16x16x32_bf16 v[16:19], v[56:59], v[48:51], v[16:19]
    v_mfma_f32_16x16x32_bf16 v[20:23], v[60:63], v[48:51], v[20:23]
    v_mfma_f32_16x16x32_bf16 v[24:27], v[56:59], v[52:55], v[24:27]
    v_mfma_f32_16x16x32_bf16 v[28:31], v[60:63], v[52:55], v[28:31]
    s_waitcnt lgkmcnt(4)
    v_mfma_f32_16x16x32_bf16 v[16:19], v[72:75], v[64:67], v[16:19]
    v_mfma_f32_16x16x32_bf16 v[20:23], v[76:79], v[64:67], v[20:23]
    v_mfma_f32_16x16x32_bf16 v[24:27], v[72:75], v[68:71], v[24:27]
    v_mfma_f32_16x16x32_bf16 v[28:31], v[76:79], v[68:71], v[28:31]
    s_waitcnt lgkmcnt(0)
    v_mfma_f32_16x16x32_bf16 v[16:19], v[88:91], v[80:83], v[16:19]
    v_mfma_f32_16x16x32_bf16 v[20:23], v[92:95], v[80:83], v[20:23]
    v_mfma_f32_16x16x32_bf16 v[24:27], v[88:91], v[84:87], v[24:27]
    v_mfma_f32_16x16x32_bf16 v[28:31], v[92:95], v[84:87], v[28:31]
    s_waitcnt vmcnt(8)
    s_barrier
    ds_read_b128 v[32:35], v5 offset:32768
    ds_read_b128 v[36:39], v5 offset:36864
    ds_read_b128 v[40:43], v6 offset:32768
    ds_read_b128 v[44:47], v6 offset:36864
    ds_read_b128 v[48:51], v5 offset:33792
    ds_read_b128 v[52:55], v5 offset:37888
    ds_read_b128 v[56:59], v6 offset:33792
    ds_read_b128 v[60:63], v6 offset:37888
    ds_read_b128 v[64:67], v5 offset:34816
    ds_read_b128 v[68:71], v5 offset:38912
    ds_read_b128 v[72:75], v6 offset:34816
    ds_read_b128 v[76:79], v6 offset:38912
    ds_read_b128 v[80:83], v5 offset:35840
    ds_read_b128 v[84:87], v5 offset:39936
    ds_read_b128 v[88:91], v6 offset:35840
    ds_read_b128 v[92:95], v6 offset:39936
    s_waitcnt lgkmcnt(12)
    v_mfma_f32_16x16x32_bf16 v[16:19], v[40:43], v[32:35], v[16:19]
    v_mfma_f32_16x16x32_bf16 v[20:23], v[44:47], v[32:35], v[20:23]
    v_mfma_f32_16x16x32_bf16 v[24:27], v[40:43], v[36:39], v[24:27]
    v_mfma_f32_16x16x32_bf16 v[28:31], v[44:47], v[36:39], v[28:31]
    s_waitcnt lgkmcnt(8)
    v_mfma_f32_16x16x32_bf16 v[16:19], v[56:59], v[48:51], v[16:19]
    v_mfma_f32_16x16x32_bf16 v[20:23], v[60:63], v[48:51], v[20:23]
    v_mfma_f32_16x16x32_bf16 v[24:27], v[56:59], v[52:55], v[24:27]
    v_mfma_f32_16x16x32_bf16 v[28:31], v[60:63], v[52:55], v[28:31]
    s_waitcnt lgkmcnt(4)
    v_mfma_f32_16x16x32_bf16 v[16:19], v[72:75], v[64:67], v[16:19]
    v_mfma_f32_16x16x32_bf16 v[20:23], v[76:79], v[64:67], v[20:23]
    v_mfma_f32_16x16x32_bf16 v[24:27], v[72:75], v[68:71], v[24:27]
    v_mfma_f32_16x16x32_bf16 v[28:31], v[76:79], v[68:71], v[28:31]
    s_waitcnt lgkmcnt(0)
    v_mfma_f32_16x16x32_bf16 v[16:19], v[88:91], v[80:83], v[16:19]
    v_mfma_f32_16x16x32_bf16 v[20:23], v[92:95], v[80:83], v[20:23]
    v_mfma_f32_16x16x32_bf16 v[24:27], v[88:91], v[84:87], v[24:27]
    v_mfma_f32_16x16x32_bf16 v[28:31], v[92:95], v[84:87], v[28:31]
    s_waitcnt vmcnt(4)
    s_barrier
    ds_read_b128 v[32:35], v7 offset:0
    ds_read_b128 v[36:39], v7 offset:4096
    ds_read_b128 v[40:43], v8 offset:0
    ds_read_b128 v[44:47], v8 offset:4096
    ds_read_b128 v[48:51], v7 offset:1024
    ds_read_b128 v[52:55], v7 offset:5120
    ds_read_b128 v[56:59], v8 offset:1024
    ds_read_b128 v[60:63], v8 offset:5120
    ds_read_b128 v[64:67], v7 offset:2048
    ds_read_b128 v[68:71], v7 offset:6144
    ds_read_b128 v[72:75], v8 offset:2048
    ds_read_b128 v[76:79], v8 offset:6144
    ds_read_b128 v[80:83], v7 offset:3072
    ds_read_b128 v[84:87], v7 offset:7168
    ds_read_b128 v[88:91], v8 offset:3072
    ds_read_b128 v[92:95], v8 offset:7168
    s_waitcnt lgkmcnt(12)
    v_mfma_f32_16x16x32_bf16 v[16:19], v[40:43], v[32:35], v[16:19]
    v_mfma_f32_16x16x32_bf16 v[20:23], v[44:47], v[32:35], v[20:23]
    v_mfma_f32_16x16x32_bf16 v[24:27], v[40:43], v[36:39], v[24:27]
    v_mfma_f32_16x16x32_bf16 v[28:31], v[44:47], v[36:39], v[28:31]
    s_waitcnt lgkmcnt(8)
    v_mfma_f32_16x16x32_bf16 v[16:19], v[56:59], v[48:51], v[16:19]
    v_mfma_f32_16x16x32_bf16 v[20:23], v[60:63], v[48:51], v[20:23]
    v_mfma_f32_16x16x32_bf16 v[24:27], v[56:59], v[52:55], v[24:27]
    v_mfma_f32_16x16x32_bf16 v[28:31], v[60:63], v[52:55], v[28:31]
    s_waitcnt lgkmcnt(4)
    v_mfma_f32_16x16x32_bf16 v[16:19], v[72:75], v[64:67], v[16:19]
    v_mfma_f32_16x16x32_bf16 v[20:23], v[76:79], v[64:67], v[20:23]
    v_mfma_f32_16x16x32_bf16 v[24:27], v[72:75], v[68:71], v[24:27]
    v_mfma_f32_16x16x32_bf16 v[28:31], v[76:79], v[68:71], v[28:31]
    s_waitcnt lgkmcnt(0)
    v_mfma_f32_16x16x32_bf16 v[16:19], v[88:91], v[80:83], v[16:19]
    v_mfma_f32_16x16x32_bf16 v[20:23], v[92:95], v[80:83], v[20:23]
    v_mfma_f32_16x16x32_bf16 v[24:27], v[88:91], v[84:87], v[24:27]
    v_mfma_f32_16x16x32_bf16 v[28:31], v[92:95], v[84:87], v[28:31]
    s_waitcnt vmcnt(0)
    s_barrier
    ds_read_b128 v[32:35], v7 offset:32768
    ds_read_b128 v[36:39], v7 offset:36864
    ds_read_b128 v[40:43], v8 offset:32768
    ds_read_b128 v[44:47], v8 offset:36864
    ds_read_b128 v[48:51], v7 offset:33792
    ds_read_b128 v[52:55], v7 offset:37888
    ds_read_b128 v[56:59], v8 offset:33792
    ds_read_b128 v[60:63], v8 offset:37888
    ds_read_b128 v[64:67], v7 offset:34816
    ds_read_b128 v[68:71], v7 offset:38912
    ds_read_b128 v[72:75], v8 offset:34816
    ds_read_b128 v[76:79], v8 offset:38912
    ds_read_b128 v[80:83], v7 offset:35840
    ds_read_b128 v[84:87], v7 offset:39936
    ds_read_b128 v[88:91], v8 offset:35840
    ds_read_b128 v[92:95], v8 offset:39936
    s_waitcnt lgkmcnt(12)
    v_mfma_f32_16x16x32_bf16 v[16:19], v[40:43], v[32:35], v[16:19]
    v_mfma_f32_16x16x32_bf16 v[20:23], v[44:47], v[32:35], v[20:23]
    v_mfma_f32_16x16x32_bf16 v[24:27], v[40:43], v[36:39], v[24:27]
    v_mfma_f32_16x16x32_bf16 v[28:31], v[44:47], v[36:39], v[28:31]
    s_waitcnt lgkmcnt(8)
    v_mfma_f32_16x16x32_bf16 v[16:19], v[56:59], v[48:51], v[16:19]
    v_mfma_f32_16x16x32_bf16 v[20:23], v[60:63], v[48:51], v[20:23]
    v_mfma_f32_16x16x32_bf16 v[24:27], v[56:59], v[52:55], v[24:27]
    v_mfma_f32_16x16x32_bf16 v[28:31], v[60:63], v[52:55], v[28:31]
    s_waitcnt lgkmcnt(4)
    v_mfma_f32_16x16x32_bf16 v[16:19], v[72:75], v[64:67], v[16:19]
    v_mfma_f32_16x16x32_bf16 v[20:23], v[76:79], v[64:67], v[20:23]
    v_mfma_f32_16x16x32_bf16 v[24:27], v[72:75], v[68:71], v[24:27]
    v_mfma_f32_16x16x32_bf16 v[28:31], v[76:79], v[68:71], v[28:31]
    s_waitcnt lgkmcnt(0)
    v_mfma_f32_16x16x32_bf16 v[16:19], v[88:91], v[80:83], v[16:19]
    v_mfma_f32_16x16x32_bf16 v[20:23], v[92:95], v[80:83], v[20:23]
    v_mfma_f32_16x16x32_bf16 v[24:27], v[88:91], v[84:87], v[24:27]
    v_mfma_f32_16x16x32_bf16 v[28:31], v[92:95], v[84:87], v[28:31]
    s_nop 9
    v_lshlrev_b32 v5, 11, v2
    v_lshl_add_u32 v5, v3, 4, v5
    s_lshl_b32 s60, s23, 1
    s_add_u32 s60, s60, s21
    s_lshl_b32 s60, s60, 15
    s_lshl_b32 s61, s24, 1
    s_add_u32 s61, s61, s22
    s_lshl_b32 s61, s61, 6
    s_add_u32 s60, s60, s61
    s_lshl_b32 s61, s95, 22
    s_add_u32 s60, s60, s61
    s_add_u32 s60, s60, 134217728
    s_add_u32 s61, s60, 0
    buffer_store_dwordx4 v[16:19], v5, s[8:11], s61 offen offset:0 sc1
    s_add_u32 s61, s60, 0
    buffer_store_dwordx4 v[20:23], v5, s[8:11], s61 offen offset:64 sc1
    s_add_u32 s61, s60, 32768
    buffer_store_dwordx4 v[24:27], v5, s[8:11], s61 offen offset:0 sc1
    s_add_u32 s61, s60, 32768
    buffer_store_dwordx4 v[28:31], v5, s[8:11], s61 offen offset:64 sc1
L_wo_fin_100:
    s_waitcnt vmcnt(0)
    s_barrier
    s_lshl_b32 s60, s93, 7
    s_add_u32 s60, s60, 122724352
    s_cmp_lg_u32 s20, 0
    s_cbranch_scc1 L_nosig_101
    v_mov_b32 v7, s60
    v_mov_b32 v8, 1
    s_mov_b64 exec, 1
    buffer_atomic_add v8, v7, s[8:11], 0 offen
    s_mov_b64 exec, -1
L_nosig_101:
    s_branch L_next2_88
L_stL_90:
    s_cmp_ge_u32 s92, 96
    s_cbranch_scc1 L_stC_91
    s_sub_u32 s93, s91, 2
    s_cmp_ge_u32 s93, 32
    s_cbranch_scc1 L_next2_88
    s_sub_u32 s92, s92, 80
    s_lshl_b32 s94, s93, 7
    s_add_u32 s94, s94, 122724352
    s_cmp_lg_u32 s20, 0
    s_cbranch_scc1 L_depok_103
    v_mov_b32 v12, 0
L_dep_102:
    buffer_load_dword v13, v12, s[8:11], s94 offen sc1
    s_add_u32 s96, s96, 1
    s_cmp_gt_u32 s96, 4194304
    s_cbranch_scc1 L_depok_103
    s_waitcnt vmcnt(0)
    v_readfirstlane_b32 s60, v13
    s_cmp_ge_u32 s60, 64
    s_cbranch_scc1 L_depok_103
    s_sleep 6
    s_branch L_dep_102
L_depok_103:
    s_barrier
    s_load_dwordx2 s[12:13], s[0:1], 0
    s_waitcnt lgkmcnt(0)
    s_and_b32 s13, s13, 0xffff
    s_mov_b32 s14, 2097152
    s_mov_b32 s15, 0x00020000
    s_lshl_b32 s4, s93, 6
    s_lshl_b32 s60, s92, 2
    s_add_u32 s4, s4, s60
    s_add_u32 s4, s4, s20
    v_lshlrev_b32 v5, 5, v1
    s_lshl_b32 s5, s4, 11
    s_add_u32 s5, s5, 134217728
    buffer_load_dwordx4 v[16:19], v5, s[8:11], s5 offen sc1
    buffer_load_dwordx4 v[20:23], v5, s[8:11], s5 offen offset:16 sc1
    s_add_u32 s5, s5, 4194304
    buffer_load_dwordx4 v[24:27], v5, s[8:11], s5 offen sc1
    buffer_load_dwordx4 v[28:31], v5, s[8:11], s5 offen offset:16 sc1
    s_add_u32 s5, s5, 4194304
    buffer_load_dwordx4 v[32:35], v5, s[8:11], s5 offen sc1
    buffer_load_dwordx4 v[36:39], v5, s[8:11], s5 offen offset:16 sc1
    s_add_u32 s5, s5, 4194304
    buffer_load_dwordx4 v[40:43], v5, s[8:11], s5 offen sc1
    buffer_load_dwordx4 v[44:47], v5, s[8:11], s5 offen offset:16 sc1
    s_add_u32 s5, s5, 4194304
    buffer_load_dwordx4 v[48:51], v5, s[8:11], s5 offen sc1
    buffer_load_dwordx4 v[52:55], v5, s[8:11], s5 offen offset:16 sc1
    s_add_u32 s5, s5, 4194304
    buffer_load_dwordx4 v[56:59], v5, s[8:11], s5 offen sc1
    buffer_load_dwordx4 v[60:63], v5, s[8:11], s5 offen offset:16 sc1
    s_add_u32 s5, s5, 4194304
    buffer_load_dwordx4 v[64:67], v5, s[8:11], s5 offen sc1
    buffer_load_dwordx4 v[68:71], v5, s[8:11], s5 offen offset:16 sc1
    s_add_u32 s5, s5, 4194304
    buffer_load_dwordx4 v[72:75], v5, s[8:11], s5 offen sc1
    buffer_load_dwordx4 v[76:79], v5, s[8:11], s5 offen offset:16 sc1
    s_lshl_b32 s5, s4, 10
    buffer_load_dwordx4 v[80:83], v4, s[12:15], s5 offen
    s_waitcnt vmcnt(0)
    v_pk_add_f32 v[16:17], v[16:17], v[24:25]
    v_pk_add_f32 v[18:19], v[18:19], v[26:27]
    v_pk_add_f32 v[20:21], v[20:21], v[28:29]
    v_pk_add_f32 v[22:23], v[22:23], v[30:31]
    v_pk_add_f32 v[16:17], v[16:17], v[32:33]
    v_pk_add_f32 v[18:19], v[18:19], v[34:35]
    v_pk_add_f32 v[20:21], v[20:21], v[36:37]
    v_pk_add_f32 v[22:23], v[22:23], v[38:39]
    v_pk_add_f32 v[16:17], v[16:17], v[40:41]
    v_pk_add_f32 v[18:19], v[18:19], v[42:43]
    v_pk_add_f32 v[20:21], v[20:21], v[44:45]
    v_pk_add_f32 v[22:23], v[22:23], v[46:47]
    v_pk_add_f32 v[16:17], v[16:17], v[48:49]
    v_pk_add_f32 v[18:19], v[18:19], v[50:51]
    v_pk_add_f32 v[20:21], v[20:21], v[52:53]
    v_pk_add_f32 v[22:23], v[22:23], v[54:55]
    v_pk_add_f32 v[16:17], v[16:17], v[56:57]
    v_pk_add_f32 v[18:19], v[18:19], v[58:59]
    v_pk_add_f32 v[20:21], v[20:21], v[60:61]
    v_pk_add_f32 v[22:23], v[22:23], v[62:63]
    v_pk_add_f32 v[16:17], v[16:17], v[64:65]
    v_pk_add_f32 v[18:19], v[18:19], v[66:67]
    v_pk_add_f32 v[20:21], v[20:21], v[68:69]
    v_pk_add_f32 v[22:23], v[22:23], v[70:71]
    v_pk_add_f32 v[16:17], v[16:17], v[72:73]
    v_pk_add_f32 v[18:19], v[18:19], v[74:75]
    v_pk_add_f32 v[20:21], v[20:21], v[76:77]
    v_pk_add_f32 v[22:23], v[22:23], v[78:79]
    v_lshlrev_b32 v24, 16, v80
    v_and_b32 v25, 0xffff0000, v80
    v_lshlrev_b32 v26, 16, v81
    v_and_b32 v27, 0xffff0000, v81
    v_lshlrev_b32 v28, 16, v82
    v_and_b32 v29, 0xffff0000, v82
    v_lshlrev_b32 v30, 16, v83
    v_and_b32 v31, 0xffff0000, v83
    v_pk_add_f32 v[16:17], v[16:17], v[24:25]
    v_pk_add_f32 v[18:19], v[18:19], v[26:27]
    v_pk_add_f32 v[20:21], v[20:21], v[28:29]
    v_pk_add_f32 v[22:23], v[22:23], v[30:31]
    v_cvt_pk_bf16_f32 v80, v16, v17
    v_cvt_pk_bf16_f32 v81, v18, v19
    v_cvt_pk_bf16_f32 v82, v20, v21
    v_cvt_pk_bf16_f32 v83, v22, v23
    s_add_u32 s5, s5, 109051904
    buffer_store_dwordx4 v[80:83], v4, s[8:11], s5 offen sc1
    v_lshlrev_b32 v16, 16, v80
    v_and_b32 v17, 0xffff0000, v80
    v_lshlrev_b32 v18, 16, v81
    v_and_b32 v19, 0xffff0000, v81
    v_lshlrev_b32 v20, 16, v82
    v_and_b32 v21, 0xffff0000, v82
    v_lshlrev_b32 v22, 16, v83
    v_and_b32 v23, 0xffff0000, v83
    v_pk_add_f32 v[24:25], v[16:17], v[18:19]
    v_pk_add_f32 v[26:27], v[20:21], v[22:23]
    v_pk_add_f32 v[24:25], v[24:25], v[26:27]
    v_add_f32 v24, v24, v25
    s_nop 1
    v_add_f32_dpp v24, v24, v24 row_ror:1 row_mask:0xf bank_mask:0xf
    s_nop 1
    v_add_f32_dpp v24, v24, v24 row_ror:2 row_mask:0xf bank_mask:0xf
    s_nop 1
    v_add_f32_dpp v24, v24, v24 row_ror:4 row_mask:0xf bank_mask:0xf
    s_nop 1
    v_add_f32_dpp v24, v24, v24 row_ror:8 row_mask:0xf bank_mask:0xf
    s_nop 1
    v_mov_b32 v25, v24
    s_nop 1
    v_permlane16_swap_b32 v24, v25
    v_add_f32 v24, v24, v25
    v_mov_b32 v25, v24
    s_nop 1
    v_permlane32_swap_b32 v24, v25
    v_add_f32 v24, v24, v25
    v_mul_f32 v24, 0x3b000000, v24
    v_mov_b32 v26, 0
    v_sub_f32 v16, v16, v24
    v_fmac_f32 v26, v16, v16
    v_sub_f32 v17, v17, v24
    v_fmac_f32 v26, v17, v17
    v_sub_f32 v18, v18, v24
    v_fmac_f32 v26, v18, v18
    v_sub_f32 v19, v19, v24
    v_fmac_f32 v26, v19, v19
    v_sub_f32 v20, v20, v24
    v_fmac_f32 v26, v20, v20
    v_sub_f32 v21, v21, v24
    v_fmac_f32 v26, v21, v21
    v_sub_f32 v22, v22, v24
    v_fmac_f32 v26, v22, v22
    v_sub_f32 v23, v23, v24
    v_fmac_f32 v26, v23, v23
    s_nop 1
    v_add_f32_dpp v26, v26, v26 row_ror:1 row_mask:0xf bank_mask:0xf
    s_nop 1
    v_add_f32_dpp v26, v26, v26 row_ror:2 row_mask:0xf bank_mask:0xf
    s_nop 1
    v_add_f32_dpp v26, v26, v26 row_ror:4 row_mask:0xf bank_mask:0xf
    s_nop 1
    v_add_f32_dpp v26, v26, v26 row_ror:8 row_mask:0xf bank_mask:0xf
    s_nop 1
    v_mov_b32 v25, v26
    s_nop 1
    v_permlane16_swap_b32 v26, v25
    v_add_f32 v26, v26, v25
    v_mov_b32 v25, v26
    s_nop 1
    v_permlane32_swap_b32 v26, v25
    v_add_f32 v26, v26, v25
    v_mov_b32 v27, 0x3727c5ac
    v_fmac_f32 v27, 0x3b000000, v26
    v_rsq_f32 v27, v27
    s_nop 0
    v_mul_f32 v16, v16, v27
    v_mul_f32 v17, v17, v27
    v_mul_f32 v18, v18, v27
    v_mul_f32 v19, v19, v27
    v_mul_f32 v20, v20, v27
    v_mul_f32 v21, v21, v27
    v_mul_f32 v22, v22, v27
    v_mul_f32 v23, v23, v27
    v_cvt_pk_bf16_f32 v80, v16, v17
    v_cvt_pk_bf16_f32 v81, v18, v19
    v_cvt_pk_bf16_f32 v82, v20, v21
    v_cvt_pk_bf16_f32 v83, v22, v23
    v_lshrrev_b32 v5, 2, v1
    v_lshlrev_b32 v5, 10, v5
    v_and_b32 v6, 3, v1
    v_lshl_add_u32 v5, v6, 8, v5
    s_lshr_b32 s5, s4, 4
    s_lshl_b32 s5, s5, 14
    s_and_b32 s60, s4, 15
    s_lshl_b32 s60, s60, 4
    s_add_u32 s5, s5, s60
    s_add_u32 s5, s5, 111149056
    buffer_store_dwordx4 v[80:83], v5, s[8:11], s5 offen sc1
    s_waitcnt vmcnt(0)
    s_barrier
    s_lshl_b32 s60, s93, 7
    s_add_u32 s60, s60, 122728448
    s_cmp_lg_u32 s20, 0
    s_cbranch_scc1 L_nosig_104
    v_mov_b32 v7, s60
    v_mov_b32 v8, 1
    s_mov_b64 exec, 1
    buffer_atomic_add v8, v7, s[8:11], 0 offen
    s_mov_b64 exec, -1
L_nosig_104:
    s_branch L_next2_88
L_stC_91:
    s_cmp_ge_u32 s92, 140
    s_cbranch_scc1 L_stD_92
    s_sub_u32 s93, s91, 3
    s_cmp_ge_u32 s93, 32
    s_cbranch_scc1 L_next2_88
    s_sub_u32 s92, s92, 96
    s_lshl_b32 s21, s93, 2
    s_lshl_b32 s22, s92, 1
    s_mov_b32 s23, s20
    s_mov_b32 s24, 0
    s_add_u32 s60, s21, s20
    s_lshl_b32 s60, s60, 14
    s_add_u32 s28, s60, 111149056
    s_and_b32 s60, s20, 1
    s_add_u32 s60, s60, s22
    s_lshl_b32 s60, s60, 14
    s_lshr_b32 s61, s20, 1
    s_mul_i32 s61, s61, 2097152
    s_add_u32 s60, s60, s61
    s_add_u32 s29, s60, 18874368
    s_add_u32 s60, s20, 0
    s_mul_i32 s30, s60, 4096
    s_add_u32 s60, s20, 4
    s_mul_i32 s31, s60, 4096
    s_mul_i32 s60, s23, 4096
    v_add_u32 v5, s60, v4
    s_mul_i32 s60, s24, 16384
    s_add_u32 s60, s60, 16384
    v_add_u32 v6, s60, v4
    v_add_u32 v7, 0x10000, v5
    v_add_u32 v8, 0x10000, v6
    v_add_u32 v9, 0x20000, v5
    v_add_u32 v10, 0x20000, v6
    v_mov_b64 v[16:17], 0
    v_mov_b64 v[18:19], 0
    v_mov_b64 v[20:21], 0
    v_mov_b64 v[22:23], 0
    v_mov_b64 v[24:25], 0
    v_mov_b64 v[26:27], 0
    v_mov_b64 v[28:29], 0
    v_mov_b64 v[30:31], 0
    s_barrier
    s_add_u32 m0, 0, s31
    s_nop 0
    buffer_load_dwordx4 v4, s[8:11], s29 offen offset:0 lds
    buffer_load_dwordx4 v4, s[8:11], s29 offen offset:1024 lds
    buffer_load_dwordx4 v4, s[8:11], s29 offen offset:2048 lds
    buffer_load_dwordx4 v4, s[8:11], s29 offen offset:3072 lds
    s_add_u32 s29, s29, 4096
    s_add_u32 m0, 32768, s31
    s_nop 0
    buffer_load_dwordx4 v4, s[8:11], s29 offen offset:0 lds
    buffer_load_dwordx4 v4, s[8:11], s29 offen offset:1024 lds
    buffer_load_dwordx4 v4, s[8:11], s29 offen offset:2048 lds
    buffer_load_dwordx4 v4, s[8:11], s29 offen offset:3072 lds
    s_add_u32 s29, s29, 4096
    s_add_u32 m0, 65536, s31
    s_nop 0
    buffer_load_dwordx4 v4, s[8:11], s29 offen offset:0 lds
    buffer_load_dwordx4 v4, s[8:11], s29 offen offset:1024 lds
    buffer_load_dwordx4 v4, s[8:11], s29 offen offset:2048 lds
    buffer_load_dwordx4 v4, s[8:11], s29 offen offset:3072 lds
    s_add_u32 s29, s29, 4096
    s_add_u32 m0, 98304, s31
    s_nop 0
    buffer_load_dwordx4 v4, s[8:11], s29 offen offset:0 lds
    buffer_load_dwordx4 v4, s[8:11], s29 offen offset:1024 lds
    buffer_load_dwordx4 v4, s[8:11], s29 offen offset:2048 lds
    buffer_load_dwordx4 v4, s[8:11], s29 offen offset:3072 lds
    s_add_u32 s29, s29, 4096
    s_lshl_b32 s94, s93, 7
    s_add_u32 s94, s94, 122728448
    s_cmp_lg_u32 s20, 0
    s_cbranch_scc1 L_depok_106
    v_mov_b32 v12, 0
L_dep_105:
    buffer_load_dword v13, v12, s[8:11], s94 offen sc1
    s_add_u32 s96, s96, 1
    s_cmp_gt_u32 s96, 4194304
    s_cbranch_scc1 L_depok_106
    s_waitcnt vmcnt(0)
    v_readfirstlane_b32 s60, v13
    s_cmp_ge_u32 s60, 16
    s_cbranch_scc1 L_depok_106
    s_sleep 6
    s_branch L_dep_105
L_depok_106:
    s_barrier
    s_add_u32 m0, 0, s30
    s_nop 0
    buffer_load_dwordx4 v4, s[8:11], s28 offen offset:0 sc1 lds
    buffer_load_dwordx4 v4, s[8:11], s28 offen offset:1024 sc1 lds
    buffer_load_dwordx4 v4, s[8:11], s28 offen offset:2048 sc1 lds
    buffer_load_dwordx4 v4, s[8:11], s28 offen offset:3072 sc1 lds
    s_add_u32 s28, s28, 4096
    s_add_u32 m0, 32768, s30
    s_nop 0
    buffer_load_dwordx4 v4, s[8:11], s28 offen offset:0 sc1 lds
    buffer_load_dwordx4 v4, s[8:11], s28 offen offset:1024 sc1 lds
    buffer_load_dwordx4 v4, s[8:11], s28 offen offset:2048 sc1 lds
    buffer_load_dwordx4 v4, s[8:11], s28 offen offset:3072 sc1 lds
    s_add_u32 s28, s28, 4096
    s_add_u32 m0, 65536, s30
    s_nop 0
    buffer_load_dwordx4 v4, s[8:11], s28 offen offset:0 sc1 lds
    buffer_load_dwordx4 v4, s[8:11], s28 offen offset:1024 sc1 lds
    buffer_load_dwordx4 v4, s[8:11], s28 offen offset:2048 sc1 lds
    buffer_load_dwordx4 v4, s[8:11], s28 offen offset:3072 sc1 lds
    s_add_u32 s28, s28, 4096
    s_add_u32 m0, 98304, s30
    s_nop 0
    buffer_load_dwordx4 v4, s[8:11], s28 offen offset:0 sc1 lds
    buffer_load_dwordx4 v4, s[8:11], s28 offen offset:1024 sc1 lds
    buffer_load_dwordx4 v4, s[8:11], s28 offen offset:2048 sc1 lds
    buffer_load_dwordx4 v4, s[8:11], s28 offen offset:3072 sc1 lds
    s_add_u32 s28, s28, 4096
    s_waitcnt vmcnt(12)
    s_barrier
    ds_read_b128 v[32:35], v5 offset:0
    ds_read_b128 v[36:39], v6 offset:0
    ds_read_b128 v[40:43], v6 offset:4096
    ds_read_b128 v[44:47], v6 offset:8192
    ds_read_b128 v[48:51], v6 offset:12288
    ds_read_b128 v[52:55], v5 offset:1024
    ds_read_b128 v[56:59], v6 offset:1024
    ds_read_b128 v[60:63], v6 offset:5120
    ds_read_b128 v[64:67], v6 offset:9216
    ds_read_b128 v[68:71], v6 offset:13312
    ds_read_b128 v[72:75], v5 offset:2048
    ds_read_b128 v[76:79], v6 offset:2048
    ds_read_b128 v[80:83], v6 offset:6144
    ds_read_b128 v[84:87], v6 offset:10240
    ds_read_b128 v[88:91], v6 offset:14336
    ds_read_b128 v[92:95], v5 offset:3072
    ds_read_b128 v[96:99], v6 offset:3072
    ds_read_b128 v[100:103], v6 offset:7168
    ds_read_b128 v[104:107], v6 offset:11264
    ds_read_b128 v[108:111], v6 offset:15360
    s_waitcnt lgkmcnt(15)
    v_mfma_f32_16x16x32_bf16 v[16:19], v[36:39], v[32:35], v[16:19]
    v_mfma_f32_16x16x32_bf16 v[20:23], v[40:43], v[32:35], v[20:23]
    v_mfma_f32_16x16x32_bf16 v[24:27], v[44:47], v[32:35], v[24:27]
    v_mfma_f32_16x16x32_bf16 v[28:31], v[48:51], v[32:35], v[28:31]
    s_waitcnt lgkmcnt(10)
    v_mfma_f32_16x16x32_bf16 v[16:19], v[56:59], v[52:55], v[16:19]
    v_mfma_f32_16x16x32_bf16 v[20:23], v[60:63], v[52:55], v[20:23]
    v_mfma_f32_16x16x32_bf16 v[24:27], v[64:67], v[52:55], v[24:27]
    v_mfma_f32_16x16x32_bf16 v[28:31], v[68:71], v[52:55], v[28:31]
    s_waitcnt lgkmcnt(5)
    v_mfma_f32_16x16x32_bf16 v[16:19], v[76:79], v[72:75], v[16:19]
    v_mfma_f32_16x16x32_bf16 v[20:23], v[80:83], v[72:75], v[20:23]
    v_mfma_f32_16x16x32_bf16 v[24:27], v[84:87], v[72:75], v[24:27]
    v_mfma_f32_16x16x32_bf16 v[28:31], v[88:91], v[72:75], v[28:31]
    s_waitcnt lgkmcnt(0)
    v_mfma_f32_16x16x32_bf16 v[16:19], v[96:99], v[92:95], v[16:19]
    v_mfma_f32_16x16x32_bf16 v[20:23], v[100:103], v[92:95], v[20:23]
    v_mfma_f32_16x16x32_bf16 v[24:27], v[104:107], v[92:95], v[24:27]
    v_mfma_f32_16x16x32_bf16 v[28:31], v[108:111], v[92:95], v[28:31]
    s_waitcnt vmcnt(8)
    s_barrier
    ds_read_b128 v[32:35], v5 offset:32768
    ds_read_b128 v[36:39], v6 offset:32768
    ds_read_b128 v[40:43], v6 offset:36864
    ds_read_b128 v[44:47], v6 offset:40960
    ds_read_b128 v[48:51], v6 offset:45056
    ds_read_b128 v[52:55], v5 offset:33792
    ds_read_b128 v[56:59], v6 offset:33792
    ds_read_b128 v[60:63], v6 offset:37888
    ds_read_b128 v[64:67], v6 offset:41984
    ds_read_b128 v[68:71], v6 offset:46080
    ds_read_b128 v[72:75], v5 offset:34816
    ds_read_b128 v[76:79], v6 offset:34816
    ds_read_b128 v[80:83], v6 offset:38912
    ds_read_b128 v[84:87], v6 offset:43008
    ds_read_b128 v[88:91], v6 offset:47104
    ds_read_b128 v[92:95], v5 offset:35840
    ds_read_b128 v[96:99], v6 offset:35840
    ds_read_b128 v[100:103], v6 offset:39936
    ds_read_b128 v[104:107], v6 offset:44032
    ds_read_b128 v[108:111], v6 offset:48128
    s_waitcnt lgkmcnt(15)
    v_mfma_f32_16x16x32_bf16 v[16:19], v[36:39], v[32:35], v[16:19]
    v_mfma_f32_16x16x32_bf16 v[20:23], v[40:43], v[32:35], v[20:23]
    v_mfma_f32_16x16x32_bf16 v[24:27], v[44:47], v[32:35], v[24:27]
    v_mfma_f32_16x16x32_bf16 v[28:31], v[48:51], v[32:35], v[28:31]
    s_waitcnt lgkmcnt(10)
    v_mfma_f32_16x16x32_bf16 v[16:19], v[56:59], v[52:55], v[16:19]
    v_mfma_f32_16x16x32_bf16 v[20:23], v[60:63], v[52:55], v[20:23]
    v_mfma_f32_16x16x32_bf16 v[24:27], v[64:67], v[52:55], v[24:27]
    v_mfma_f32_16x16x32_bf16 v[28:31], v[68:71], v[52:55], v[28:31]
    s_waitcnt lgkmcnt(5)
    v_mfma_f32_16x16x32_bf16 v[16:19], v[76:79], v[72:75], v[16:19]
    v_mfma_f32_16x16x32_bf16 v[20:23], v[80:83], v[72:75], v[20:23]
    v_mfma_f32_16x16x32_bf16 v[24:27], v[84:87], v[72:75], v[24:27]
    v_mfma_f32_16x16x32_bf16 v[28:31], v[88:91], v[72:75], v[28:31]
    s_waitcnt lgkmcnt(0)
    v_mfma_f32_16x16x32_bf16 v[16:19], v[96:99], v[92:95], v[16:19]
    v_mfma_f32_16x16x32_bf16 v[20:23], v[100:103], v[92:95], v[20:23]
    v_mfma_f32_16x16x32_bf16 v[24:27], v[104:107], v[92:95], v[24:27]
    v_mfma_f32_16x16x32_bf16 v[28:31], v[108:111], v[92:95], v[28:31]
    s_waitcnt vmcnt(4)
    s_barrier
    ds_read_b128 v[32:35], v7 offset:0
    ds_read_b128 v[36:39], v8 offset:0
    ds_read_b128 v[40:43], v8 offset:4096
    ds_read_b128 v[44:47], v8 offset:8192
    ds_read_b128 v[48:51], v8 offset:12288
    ds_read_b128 v[52:55], v7 offset:1024
    ds_read_b128 v[56:59], v8 offset:1024
    ds_read_b128 v[60:63], v8 offset:5120
    ds_read_b128 v[64:67], v8 offset:9216
    ds_read_b128 v[68:71], v8 offset:13312
    ds_read_b128 v[72:75], v7 offset:2048
    ds_read_b128 v[76:79], v8 offset:2048
    ds_read_b128 v[80:83], v8 offset:6144
    ds_read_b128 v[84:87], v8 offset:10240
    ds_read_b128 v[88:91], v8 offset:14336
    ds_read_b128 v[92:95], v7 offset:3072
    ds_read_b128 v[96:99], v8 offset:3072
    ds_read_b128 v[100:103], v8 offset:7168
    ds_read_b128 v[104:107], v8 offset:11264
    ds_read_b128 v[108:111], v8 offset:15360
    s_waitcnt lgkmcnt(15)
    v_mfma_f32_16x16x32_bf16 v[16:19], v[36:39], v[32:35], v[16:19]
    v_mfma_f32_16x16x32_bf16 v[20:23], v[40:43], v[32:35], v[20:23]
    v_mfma_f32_16x16x32_bf16 v[24:27], v[44:47], v[32:35], v[24:27]
    v_mfma_f32_16x16x32_bf16 v[28:31], v[48:51], v[32:35], v[28:31]
    s_waitcnt lgkmcnt(10)
    v_mfma_f32_16x16x32_bf16 v[16:19], v[56:59], v[52:55], v[16:19]
    v_mfma_f32_16x16x32_bf16 v[20:23], v[60:63], v[52:55], v[20:23]
    v_mfma_f32_16x16x32_bf16 v[24:27], v[64:67], v[52:55], v[24:27]
    v_mfma_f32_16x16x32_bf16 v[28:31], v[68:71], v[52:55], v[28:31]
    s_waitcnt lgkmcnt(5)
    v_mfma_f32_16x16x32_bf16 v[16:19], v[76:79], v[72:75], v[16:19]
    v_mfma_f32_16x16x32_bf16 v[20:23], v[80:83], v[72:75], v[20:23]
    v_mfma_f32_16x16x32_bf16 v[24:27], v[84:87], v[72:75], v[24:27]
    v_mfma_f32_16x16x32_bf16 v[28:31], v[88:91], v[72:75], v[28:31]
    s_waitcnt lgkmcnt(0)
    v_mfma_f32_16x16x32_bf16 v[16:19], v[96:99], v[92:95], v[16:19]
    v_mfma_f32_16x16x32_bf16 v[20:23], v[100:103], v[92:95], v[20:23]
    v_mfma_f32_16x16x32_bf16 v[24:27], v[104:107], v[92:95], v[24:27]
    v_mfma_f32_16x16x32_bf16 v[28:31], v[108:111], v[92:95], v[28:31]
    s_waitcnt vmcnt(0)
    s_barrier
    ds_read_b128 v[32:35], v7 offset:32768
    ds_read_b128 v[36:39], v8 offset:32768
    ds_read_b128 v[40:43], v8 offset:36864
    ds_read_b128 v[44:47], v8 offset:40960
    ds_read_b128 v[48:51], v8 offset:45056
    ds_read_b128 v[52:55], v7 offset:33792
    ds_read_b128 v[56:59], v8 offset:33792
    ds_read_b128 v[60:63], v8 offset:37888
    ds_read_b128 v[64:67], v8 offset:41984
    ds_read_b128 v[68:71], v8 offset:46080
    ds_read_b128 v[72:75], v7 offset:34816
    ds_read_b128 v[76:79], v8 offset:34816
    ds_read_b128 v[80:83], v8 offset:38912
    ds_read_b128 v[84:87], v8 offset:43008
    ds_read_b128 v[88:91], v8 offset:47104
    ds_read_b128 v[92:95], v7 offset:35840
    ds_read_b128 v[96:99], v8 offset:35840
    ds_read_b128 v[100:103], v8 offset:39936
    ds_read_b128 v[104:107], v8 offset:44032
    ds_read_b128 v[108:111], v8 offset:48128
    s_waitcnt lgkmcnt(15)
    v_mfma_f32_16x16x32_bf16 v[16:19], v[36:39], v[32:35], v[16:19]
    v_mfma_f32_16x16x32_bf16 v[20:23], v[40:43], v[32:35], v[20:23]
    v_mfma_f32_16x16x32_bf16 v[24:27], v[44:47], v[32:35], v[24:27]
    v_mfma_f32_16x16x32_bf16 v[28:31], v[48:51], v[32:35], v[28:31]
    s_waitcnt lgkmcnt(10)
    v_mfma_f32_16x16x32_bf16 v[16:19], v[56:59], v[52:55], v[16:19]
    v_mfma_f32_16x16x32_bf16 v[20:23], v[60:63], v[52:55], v[20:23]
    v_mfma_f32_16x16x32_bf16 v[24:27], v[64:67], v[52:55], v[24:27]
    v_mfma_f32_16x16x32_bf16 v[28:31], v[68:71], v[52:55], v[28:31]
    s_waitcnt lgkmcnt(5)
    v_mfma_f32_16x16x32_bf16 v[16:19], v[76:79], v[72:75], v[16:19]
    v_mfma_f32_16x16x32_bf16 v[20:23], v[80:83], v[72:75], v[20:23]
    v_mfma_f32_16x16x32_bf16 v[24:27], v[84:87], v[72:75], v[24:27]
    v_mfma_f32_16x16x32_bf16 v[28:31], v[88:91], v[72:75], v[28:31]
    s_waitcnt lgkmcnt(0)
    v_mfma_f32_16x16x32_bf16 v[16:19], v[96:99], v[92:95], v[16:19]
    v_mfma_f32_16x16x32_bf16 v[20:23], v[100:103], v[92:95], v[20:23]
    v_mfma_f32_16x16x32_bf16 v[24:27], v[104:107], v[92:95], v[24:27]
    v_mfma_f32_16x16x32_bf16 v[28:31], v[108:111], v[92:95], v[28:31]
    s_nop 9
    s_mov_b32 s62, 0xc0135761
    s_mov_b32 s63, 0xbdd2d3e8
    v_mul_f32 v112, v16, v16
    v_mov_b32 v113, s62
    v_fmac_f32 v113, s63, v112
    v_mul_f32 v113, v113, v16
    v_exp_f32 v113, v113
    s_nop 0
    v_add_f32 v113, 1.0, v113
    v_rcp_f32 v113, v113
    s_nop 0
    v_mul_f32 v16, v16, v113
    v_mul_f32 v16, v16, v24
    v_mul_f32 v112, v17, v17
    v_mov_b32 v113, s62
    v_fmac_f32 v113, s63, v112
    v_mul_f32 v113, v113, v17
    v_exp_f32 v113, v113
    s_nop 0
    v_add_f32 v113, 1.0, v113
    v_rcp_f32 v113, v113
    s_nop 0
    v_mul_f32 v17, v17, v113
    v_mul_f32 v17, v17, v25
    v_mul_f32 v112, v18, v18
    v_mov_b32 v113, s62
    v_fmac_f32 v113, s63, v112
    v_mul_f32 v113, v113, v18
    v_exp_f32 v113, v113
    s_nop 0
    v_add_f32 v113, 1.0, v113
    v_rcp_f32 v113, v113
    s_nop 0
    v_mul_f32 v18, v18, v113
    v_mul_f32 v18, v18, v26
    v_mul_f32 v112, v19, v19
    v_mov_b32 v113, s62
    v_fmac_f32 v113, s63, v112
    v_mul_f32 v113, v113, v19
    v_exp_f32 v113, v113
    s_nop 0
    v_add_f32 v113, 1.0, v113
    v_rcp_f32 v113, v113
    s_nop 0
    v_mul_f32 v19, v19, v113
    v_mul_f32 v19, v19, v27
    v_mul_f32 v112, v20, v20
    v_mov_b32 v113, s62
    v_fmac_f32 v113, s63, v112
    v_mul_f32 v113, v113, v20
    v_exp_f32 v113, v113
    s_nop 0
    v_add_f32 v113, 1.0, v113
    v_rcp_f32 v113, v113
    s_nop 0
    v_mul_f32 v20, v20, v113
    v_mul_f32 v20, v20, v28
    v_mul_f32 v112, v21, v21
    v_mov_b32 v113, s62
    v_fmac_f32 v113, s63, v112
    v_mul_f32 v113, v113, v21
    v_exp_f32 v113, v113
    s_nop 0
    v_add_f32 v113, 1.0, v113
    v_rcp_f32 v113, v113
    s_nop 0
    v_mul_f32 v21, v21, v113
    v_mul_f32 v21, v21, v29
    v_mul_f32 v112, v22, v22
    v_mov_b32 v113, s62
    v_fmac_f32 v113, s63, v112
    v_mul_f32 v113, v113, v22
    v_exp_f32 v113, v113
    s_nop 0
    v_add_f32 v113, 1.0, v113
    v_rcp_f32 v113, v113
    s_nop 0
    v_mul_f32 v22, v22, v113
    v_mul_f32 v22, v22, v30
    v_mul_f32 v112, v23, v23
    v_mov_b32 v113, s62
    v_fmac_f32 v113, s63, v112
    v_mul_f32 v113, v113, v23
    v_exp_f32 v113, v113
    s_nop 0
    v_add_f32 v113, 1.0, v113
    v_rcp_f32 v113, v113
    s_nop 0
    v_mul_f32 v23, v23, v113
    v_mul_f32 v23, v23, v31
    v_cvt_pk_bf16_f32 v112, v16, v17
    v_cvt_pk_bf16_f32 v113, v18, v19
    v_cvt_pk_bf16_f32 v114, v20, v21
    v_cvt_pk_bf16_f32 v115, v22, v23
    s_add_u32 s60, s21, s20
    s_mul_i32 s60, s60, 44
    s_add_u32 s60, s60, s92
    s_lshl_b32 s60, s60, 10
    s_add_u32 s60, s60, 113246208
    buffer_store_dwordx4 v[112:115], v4, s[8:11], s60 offen sc1
L_ffn1_fin_107:
    s_waitcnt vmcnt(0)
    s_barrier
    s_lshl_b32 s60, s93, 7
    s_add_u32 s60, s60, 122732544
    s_cmp_lg_u32 s20, 0
    s_cbranch_scc1 L_nosig_108
    v_mov_b32 v7, s60
    v_mov_b32 v8, 1
    s_mov_b64 exec, 1
    buffer_atomic_add v8, v7, s[8:11], 0 offen
    s_mov_b64 exec, -1
L_nosig_108:
    s_branch L_next2_88
L_stD_92:
    s_sub_u32 s93, s91, 4
    s_cmp_ge_u32 s93, 32
    s_cbranch_scc1 L_next2_88
    s_sub_u32 s92, s92, 140
    s_lshl_b32 s21, s93, 2
    s_lshr_b32 s60, s92, 4
    s_lshl_b32 s60, s60, 1
    s_add_u32 s21, s21, s60
    s_and_b32 s22, s92, 15
    s_lshl_b32 s22, s22, 1
    s_lshr_b32 s23, s20, 1
    s_and_b32 s24, s20, 1
    s_and_b32 s60, s20, 1
    s_cmp_ge_u32 s20, 2
    s_cselect_b32 s61, s22, s21
    s_add_u32 s60, s60, s61
    s_mul_i32 s60, s60, 45056
    s_mov_b32 s61, 113246208
    s_cmp_ge_u32 s20, 2
    s_cselect_b32 s61, 23068672, s61
    s_add_u32 s28, s60, s61
    s_add_u32 s60, s20, 0
    s_mul_i32 s29, s60, 4096
    s_mul_i32 s60, s23, 4096
    v_add_u32 v5, s60, v4
    s_mul_i32 s60, s24, 4096
    s_add_u32 s60, s60, 8192
    v_add_u32 v6, s60, v4
    v_add_u32 v7, 0x10000, v5
    v_add_u32 v8, 0x10000, v6
    v_add_u32 v9, 0x20000, v5
    v_add_u32 v10, 0x20000, v6
    v_mov_b64 v[16:17], 0
    v_mov_b64 v[18:19], 0
    s_barrier
    s_cmp_lt_u32 s20, 2
    s_cbranch_scc1 L_bw_109
    s_add_u32 m0, 0, s29
    s_nop 0
    buffer_load_dwordx4 v4, s[8:11], s28 offen offset:0 sc1 lds
    buffer_load_dwordx4 v4, s[8:11], s28 offen offset:1024 sc1 lds
    buffer_load_dwordx4 v4, s[8:11], s28 offen offset:2048 sc1 lds
    buffer_load_dwordx4 v4, s[8:11], s28 offen offset:3072 sc1 lds
    s_add_u32 s28, s28, 4096
    s_add_u32 m0, 16384, s29
    s_nop 0
    buffer_load_dwordx4 v4, s[8:11], s28 offen offset:0 sc1 lds
    buffer_load_dwordx4 v4, s[8:11], s28 offen offset:1024 sc1 lds
    buffer_load_dwordx4 v4, s[8:11], s28 offen offset:2048 sc1 lds
    buffer_load_dwordx4 v4, s[8:11], s28 offen offset:3072 sc1 lds
    s_add_u32 s28, s28, 4096
    s_add_u32 m0, 32768, s29
    s_nop 0
    buffer_load_dwordx4 v4, s[8:11], s28 offen offset:0 sc1 lds
    buffer_load_dwordx4 v4, s[8:11], s28 offen offset:1024 sc1 lds
    buffer_load_dwordx4 v4, s[8:11], s28 offen offset:2048 sc1 lds
    buffer_load_dwordx4 v4, s[8:11], s28 offen offset:3072 sc1 lds
    s_add_u32 s28, s28, 4096
    s_add_u32 m0, 49152, s29
    s_nop 0
    buffer_load_dwordx4 v4, s[8:11], s28 offen offset:0 sc1 lds
    buffer_load_dwordx4 v4, s[8:11], s28 offen offset:1024 sc1 lds
    buffer_load_dwordx4 v4, s[8:11], s28 offen offset:2048 sc1 lds
    buffer_load_dwordx4 v4, s[8:11], s28 offen offset:3072 sc1 lds
    s_add_u32 s28, s28, 4096
    s_add_u32 m0, 65536, s29
    s_nop 0
    buffer_load_dwordx4 v4, s[8:11], s28 offen offset:0 sc1 lds
    buffer_load_dwordx4 v4, s[8:11], s28 offen offset:1024 sc1 lds
    buffer_load_dwordx4 v4, s[8:11], s28 offen offset:2048 sc1 lds
    buffer_load_dwordx4 v4, s[8:11], s28 offen offset:3072 sc1 lds
    s_add_u32 s28, s28, 4096
    s_add_u32 m0, 81920, s29
    s_nop 0
    buffer_load_dwordx4 v4, s[8:11], s28 offen offset:0 sc1 lds
    buffer_load_dwordx4 v4, s[8:11], s28 offen offset:1024 sc1 lds
    buffer_load_dwordx4 v4, s[8:11], s28 offen offset:2048 sc1 lds
    buffer_load_dwordx4 v4, s[8:11], s28 offen offset:3072 sc1 lds
    s_add_u32 s28, s28, 4096
    s_add_u32 m0, 98304, s29
    s_nop 0
    buffer_load_dwordx4 v4, s[8:11], s28 offen offset:0 sc1 lds
    buffer_load_dwordx4 v4, s[8:11], s28 offen offset:1024 sc1 lds
    buffer_load_dwordx4 v4, s[8:11], s28 offen offset:2048 sc1 lds
    buffer_load_dwordx4 v4, s[8:11], s28 offen offset:3072 sc1 lds
    s_add_u32 s28, s28, 4096
    s_add_u32 m0, 114688, s29
    s_nop 0
    buffer_load_dwordx4 v4, s[8:11], s28 offen offset:0 sc1 lds
    buffer_load_dwordx4 v4, s[8:11], s28 offen offset:1024 sc1 lds
    buffer_load_dwordx4 v4, s[8:11], s28 offen offset:2048 sc1 lds
    buffer_load_dwordx4 v4, s[8:11], s28 offen offset:3072 sc1 lds
    s_add_u32 s28, s28, 4096
    s_add_u32 m0, 131072, s29
    s_nop 0
    buffer_load_dwordx4 v4, s[8:11], s28 offen offset:0 sc1 lds
    buffer_load_dwordx4 v4, s[8:11], s28 offen offset:1024 sc1 lds
    buffer_load_dwordx4 v4, s[8:11], s28 offen offset:2048 sc1 lds
    buffer_load_dwordx4 v4, s[8:11], s28 offen offset:3072 sc1 lds
    s_add_u32 s28, s28, 4096
L_bw_109:
    s_lshl_b32 s94, s93, 7
    s_add_u32 s94, s94, 122732544
    s_cmp_lg_u32 s20, 0
    s_cbranch_scc1 L_depok_112
    v_mov_b32 v12, 0
L_dep_111:
    buffer_load_dword v13, v12, s[8:11], s94 offen sc1
    s_add_u32 s96, s96, 1
    s_cmp_gt_u32 s96, 4194304
    s_cbranch_scc1 L_depok_112
    s_waitcnt vmcnt(0)
    v_readfirstlane_b32 s60, v13
    s_cmp_ge_u32 s60, 44
    s_cbranch_scc1 L_depok_112
    s_sleep 6
    s_branch L_dep_111
L_depok_112:
    s_barrier
    s_cmp_ge_u32 s20, 2
    s_cbranch_scc1 L_aw_110
    s_add_u32 m0, 0, s29
    s_nop 0
    buffer_load_dwordx4 v4, s[8:11], s28 offen offset:0 sc1 lds
    buffer_load_dwordx4 v4, s[8:11], s28 offen offset:1024 sc1 lds
    buffer_load_dwordx4 v4, s[8:11], s28 offen offset:2048 sc1 lds
    buffer_load_dwordx4 v4, s[8:11], s28 offen offset:3072 sc1 lds
    s_add_u32 s28, s28, 4096
    s_add_u32 m0, 16384, s29
    s_nop 0
    buffer_load_dwordx4 v4, s[8:11], s28 offen offset:0 sc1 lds
    buffer_load_dwordx4 v4, s[8:11], s28 offen offset:1024 sc1 lds
    buffer_load_dwordx4 v4, s[8:11], s28 offen offset:2048 sc1 lds
    buffer_load_dwordx4 v4, s[8:11], s28 offen offset:3072 sc1 lds
    s_add_u32 s28, s28, 4096
    s_add_u32 m0, 32768, s29
    s_nop 0
    buffer_load_dwordx4 v4, s[8:11], s28 offen offset:0 sc1 lds
    buffer_load_dwordx4 v4, s[8:11], s28 offen offset:1024 sc1 lds
    buffer_load_dwordx4 v4, s[8:11], s28 offen offset:2048 sc1 lds
    buffer_load_dwordx4 v4, s[8:11], s28 offen offset:3072 sc1 lds
    s_add_u32 s28, s28, 4096
    s_add_u32 m0, 49152, s29
    s_nop 0
    buffer_load_dwordx4 v4, s[8:11], s28 offen offset:0 sc1 lds
    buffer_load_dwordx4 v4, s[8:11], s28 offen offset:1024 sc1 lds
    buffer_load_dwordx4 v4, s[8:11], s28 offen offset:2048 sc1 lds
    buffer_load_dwordx4 v4, s[8:11], s28 offen offset:3072 sc1 lds
    s_add_u32 s28, s28, 4096
    s_add_u32 m0, 65536, s29
    s_nop 0
    buffer_load_dwordx4 v4, s[8:11], s28 offen offset:0 sc1 lds
    buffer_load_dwordx4 v4, s[8:11], s28 offen offset:1024 sc1 lds
    buffer_load_dwordx4 v4, s[8:11], s28 offen offset:2048 sc1 lds
    buffer_load_dwordx4 v4, s[8:11], s28 offen offset:3072 sc1 lds
    s_add_u32 s28, s28, 4096
    s_add_u32 m0, 81920, s29
    s_nop 0
    buffer_load_dwordx4 v4, s[8:11], s28 offen offset:0 sc1 lds
    buffer_load_dwordx4 v4, s[8:11], s28 offen offset:1024 sc1 lds
    buffer_load_dwordx4 v4, s[8:11], s28 offen offset:2048 sc1 lds
    buffer_load_dwordx4 v4, s[8:11], s28 offen offset:3072 sc1 lds
    s_add_u32 s28, s28, 4096
    s_add_u32 m0, 98304, s29
    s_nop 0
    buffer_load_dwordx4 v4, s[8:11], s28 offen offset:0 sc1 lds
    buffer_load_dwordx4 v4, s[8:11], s28 offen offset:1024 sc1 lds
    buffer_load_dwordx4 v4, s[8:11], s28 offen offset:2048 sc1 lds
    buffer_load_dwordx4 v4, s[8:11], s28 offen offset:3072 sc1 lds
    s_add_u32 s28, s28, 4096
    s_add_u32 m0, 114688, s29
    s_nop 0
    buffer_load_dwordx4 v4, s[8:11], s28 offen offset:0 sc1 lds
    buffer_load_dwordx4 v4, s[8:11], s28 offen offset:1024 sc1 lds
    buffer_load_dwordx4 v4, s[8:11], s28 offen offset:2048 sc1 lds
    buffer_load_dwordx4 v4, s[8:11], s28 offen offset:3072 sc1 lds
    s_add_u32 s28, s28, 4096
    s_add_u32 m0, 131072, s29
    s_nop 0
    buffer_load_dwordx4 v4, s[8:11], s28 offen offset:0 sc1 lds
    buffer_load_dwordx4 v4, s[8:11], s28 offen offset:1024 sc1 lds
    buffer_load_dwordx4 v4, s[8:11], s28 offen offset:2048 sc1 lds
    buffer_load_dwordx4 v4, s[8:11], s28 offen offset:3072 sc1 lds
    s_add_u32 s28, s28, 4096
L_aw_110:
    s_waitcnt vmcnt(32)
    s_barrier
    ds_read_b128 v[20:23], v5 offset:0
    ds_read_b128 v[24:27], v6 offset:0
    ds_read_b128 v[28:31], v5 offset:1024
    ds_read_b128 v[32:35], v6 offset:1024
    ds_read_b128 v[36:39], v5 offset:2048
    ds_read_b128 v[40:43], v6 offset:2048
    ds_read_b128 v[44:47], v5 offset:3072
    ds_read_b128 v[48:51], v6 offset:3072
    s_add_u32 m0, 147456, s29
    s_nop 0
    buffer_load_dwordx4 v4, s[8:11], s28 offen offset:0 sc1 lds
    buffer_load_dwordx4 v4, s[8:11], s28 offen offset:1024 sc1 lds
    buffer_load_dwordx4 v4, s[8:11], s28 offen offset:2048 sc1 lds
    buffer_load_dwordx4 v4, s[8:11], s28 offen offset:3072 sc1 lds
    s_add_u32 s28, s28, 4096
    s_waitcnt lgkmcnt(6)
    v_mfma_f32_16x16x32_bf16 v[16:19], v[24:27], v[20:23], v[16:19]
    s_waitcnt lgkmcnt(4)
    v_mfma_f32_16x16x32_bf16 v[16:19], v[32:35], v[28:31], v[16:19]
    s_waitcnt lgkmcnt(2)
    v_mfma_f32_16x16x32_bf16 v[16:19], v[40:43], v[36:39], v[16:19]
    s_waitcnt lgkmcnt(0)
    v_mfma_f32_16x16x32_bf16 v[16:19], v[48:51], v[44:47], v[16:19]
    s_waitcnt vmcnt(32)
    s_barrier
    ds_read_b128 v[20:23], v5 offset:16384
    ds_read_b128 v[24:27], v6 offset:16384
    ds_read_b128 v[28:31], v5 offset:17408
    ds_read_b128 v[32:35], v6 offset:17408
    ds_read_b128 v[36:39], v5 offset:18432
    ds_read_b128 v[40:43], v6 offset:18432
    ds_read_b128 v[44:47], v5 offset:19456
    ds_read_b128 v[48:51], v6 offset:19456
    s_add_u32 m0, 0, s29
    s_nop 0
    buffer_load_dwordx4 v4, s[8:11], s28 offen offset:0 sc1 lds
    buffer_load_dwordx4 v4, s[8:11], s28 offen offset:1024 sc1 lds
    buffer_load_dwordx4 v4, s[8:11], s28 offen offset:2048 sc1 lds
    buffer_load_dwordx4 v4, s[8:11], s28 offen offset:3072 sc1 lds
    s_add_u32 s28, s28, 4096
    s_waitcnt lgkmcnt(6)
    v_mfma_f32_16x16x32_bf16 v[16:19], v[24:27], v[20:23], v[16:19]
    s_waitcnt lgkmcnt(4)
    v_mfma_f32_16x16x32_bf16 v[16:19], v[32:35], v[28:31], v[16:19]
    s_waitcnt lgkmcnt(2)
    v_mfma_f32_16x16x32_bf16 v[16:19], v[40:43], v[36:39], v[16:19]
    s_waitcnt lgkmcnt(0)
    v_mfma_f32_16x16x32_bf16 v[16:19], v[48:51], v[44:47], v[16:19]
    s_waitcnt vmcnt(32)
    s_barrier
    ds_read_b128 v[20:23], v5 offset:32768
    ds_read_b128 v[24:27], v6 offset:32768
    ds_read_b128 v[28:31], v5 offset:33792
    ds_read_b128 v[32:35], v6 offset:33792
    ds_read_b128 v[36:39], v5 offset:34816
    ds_read_b128 v[40:43], v6 offset:34816
    ds_read_b128 v[44:47], v5 offset:35840
    ds_read_b128 v[48:51], v6 offset:35840
    s_waitcnt lgkmcnt(6)
    v_mfma_f32_16x16x32_bf16 v[16:19], v[24:27], v[20:23], v[16:19]
    s_waitcnt lgkmcnt(4)
    v_mfma_f32_16x16x32_bf16 v[16:19], v[32:35], v[28:31], v[16:19]
    s_waitcnt lgkmcnt(2)
    v_mfma_f32_16x16x32_bf16 v[16:19], v[40:43], v[36:39], v[16:19]
    s_waitcnt lgkmcnt(0)
    v_mfma_f32_16x16x32_bf16 v[16:19], v[48:51], v[44:47], v[16:19]
    s_waitcnt vmcnt(28)
    s_barrier
    ds_read_b128 v[20:23], v5 offset:49152
    ds_read_b128 v[24:27], v6 offset:49152
    ds_read_b128 v[28:31], v5 offset:50176
    ds_read_b128 v[32:35], v6 offset:50176
    ds_read_b128 v[36:39], v5 offset:51200
    ds_read_b128 v[40:43], v6 offset:51200
    ds_read_b128 v[44:47], v5 offset:52224
    ds_read_b128 v[48:51], v6 offset:52224
    s_waitcnt lgkmcnt(6)
    v_mfma_f32_16x16x32_bf16 v[16:19], v[24:27], v[20:23], v[16:19]
    s_waitcnt lgkmcnt(4)
    v_mfma_f32_16x16x32_bf16 v[16:19], v[32:35], v[28:31], v[16:19]
    s_waitcnt lgkmcnt(2)
    v_mfma_f32_16x16x32_bf16 v[16:19], v[40:43], v[36:39], v[16:19]
    s_waitcnt lgkmcnt(0)
    v_mfma_f32_16x16x32_bf16 v[16:19], v[48:51], v[44:47], v[16:19]
    s_waitcnt vmcnt(24)
    s_barrier
    ds_read_b128 v[20:23], v7 offset:0
    ds_read_b128 v[24:27], v8 offset:0
    ds_read_b128 v[28:31], v7 offset:1024
    ds_read_b128 v[32:35], v8 offset:1024
    ds_read_b128 v[36:39], v7 offset:2048
    ds_read_b128 v[40:43], v8 offset:2048
    ds_read_b128 v[44:47], v7 offset:3072
    ds_read_b128 v[48:51], v8 offset:3072
    s_waitcnt lgkmcnt(6)
    v_mfma_f32_16x16x32_bf16 v[16:19], v[24:27], v[20:23], v[16:19]
    s_waitcnt lgkmcnt(4)
    v_mfma_f32_16x16x32_bf16 v[16:19], v[32:35], v[28:31], v[16:19]
    s_waitcnt lgkmcnt(2)
    v_mfma_f32_16x16x32_bf16 v[16:19], v[40:43], v[36:39], v[16:19]
    s_waitcnt lgkmcnt(0)
    v_mfma_f32_16x16x32_bf16 v[16:19], v[48:51], v[44:47], v[16:19]
    s_waitcnt vmcnt(20)
    s_barrier
    ds_read_b128 v[20:23], v7 offset:16384
    ds_read_b128 v[24:27], v8 offset:16384
    ds_read_b128 v[28:31], v7 offset:17408
    ds_read_b128 v[32:35], v8 offset:17408
    ds_read_b128 v[36:39], v7 offset:18432
    ds_read_b128 v[40:43], v8 offset:18432
    ds_read_b128 v[44:47], v7 offset:19456
    ds_read_b128 v[48:51], v8 offset:19456
    s_waitcnt lgkmcnt(6)
    v_mfma_f32_16x16x32_bf16 v[16:19], v[24:27], v[20:23], v[16:19]
    s_waitcnt lgkmcnt(4)
    v_mfma_f32_16x16x32_bf16 v[16:19], v[32:35], v[28:31], v[16:19]
    s_waitcnt lgkmcnt(2)
    v_mfma_f32_16x16x32_bf16 v[16:19], v[40:43], v[36:39], v[16:19]
    s_waitcnt lgkmcnt(0)
    v_mfma_f32_16x16x32_bf16 v[16:19], v[48:51], v[44:47], v[16:19]
    s_waitcnt vmcnt(16)
    s_barrier
    ds_read_b128 v[20:23], v7 offset:32768
    ds_read_b128 v[24:27], v8 offset:32768
    ds_read_b128 v[28:31], v7 offset:33792
    ds_read_b128 v[32:35], v8 offset:33792
    ds_read_b128 v[36:39], v7 offset:34816
    ds_read_b128 v[40:43], v8 offset:34816
    ds_read_b128 v[44:47], v7 offset:35840
    ds_read_b128 v[48:51], v8 offset:35840
    s_waitcnt lgkmcnt(6)
    v_mfma_f32_16x16x32_bf16 v[16:19], v[24:27], v[20:23], v[16:19]
    s_waitcnt lgkmcnt(4)
    v_mfma_f32_16x16x32_bf16 v[16:19], v[32:35], v[28:31], v[16:19]
    s_waitcnt lgkmcnt(2)
    v_mfma_f32_16x16x32_bf16 v[16:19], v[40:43], v[36:39], v[16:19]
    s_waitcnt lgkmcnt(0)
    v_mfma_f32_16x16x32_bf16 v[16:19], v[48:51], v[44:47], v[16:19]
    s_waitcnt vmcnt(12)
    s_barrier
    ds_read_b128 v[20:23], v7 offset:49152
    ds_read_b128 v[24:27], v8 offset:49152
    ds_read_b128 v[28:31], v7 offset:50176
    ds_read_b128 v[32:35], v8 offset:50176
    ds_read_b128 v[36:39], v7 offset:51200
    ds_read_b128 v[40:43], v8 offset:51200
    ds_read_b128 v[44:47], v7 offset:52224
    ds_read_b128 v[48:51], v8 offset:52224
    s_waitcnt lgkmcnt(6)
    v_mfma_f32_16x16x32_bf16 v[16:19], v[24:27], v[20:23], v[16:19]
    s_waitcnt lgkmcnt(4)
    v_mfma_f32_16x16x32_bf16 v[16:19], v[32:35], v[28:31], v[16:19]
    s_waitcnt lgkmcnt(2)
    v_mfma_f32_16x16x32_bf16 v[16:19], v[40:43], v[36:39], v[16:19]
    s_waitcnt lgkmcnt(0)
    v_mfma_f32_16x16x32_bf16 v[16:19], v[48:51], v[44:47], v[16:19]
    s_waitcnt vmcnt(8)
    s_barrier
    ds_read_b128 v[20:23], v9 offset:0
    ds_read_b128 v[24:27], v10 offset:0
    ds_read_b128 v[28:31], v9 offset:1024
    ds_read_b128 v[32:35], v10 offset:1024
    ds_read_b128 v[36:39], v9 offset:2048
    ds_read_b128 v[40:43], v10 offset:2048
    ds_read_b128 v[44:47], v9 offset:3072
    ds_read_b128 v[48:51], v10 offset:3072
    s_waitcnt lgkmcnt(6)
    v_mfma_f32_16x16x32_bf16 v[16:19], v[24:27], v[20:23], v[16:19]
    s_waitcnt lgkmcnt(4)
    v_mfma_f32_16x16x32_bf16 v[16:19], v[32:35], v[28:31], v[16:19]
    s_waitcnt lgkmcnt(2)
    v_mfma_f32_16x16x32_bf16 v[16:19], v[40:43], v[36:39], v[16:19]
    s_waitcnt lgkmcnt(0)
    v_mfma_f32_16x16x32_bf16 v[16:19], v[48:51], v[44:47], v[16:19]
    s_waitcnt vmcnt(4)
    s_barrier
    ds_read_b128 v[20:23], v9 offset:16384
    ds_read_b128 v[24:27], v10 offset:16384
    ds_read_b128 v[28:31], v9 offset:17408
    ds_read_b128 v[32:35], v10 offset:17408
    ds_read_b128 v[36:39], v9 offset:18432
    ds_read_b128 v[40:43], v10 offset:18432
    ds_read_b128 v[44:47], v9 offset:19456
    ds_read_b128 v[48:51], v10 offset:19456
    s_waitcnt lgkmcnt(6)
    v_mfma_f32_16x16x32_bf16 v[16:19], v[24:27], v[20:23], v[16:19]
    s_waitcnt lgkmcnt(4)
    v_mfma_f32_16x16x32_bf16 v[16:19], v[32:35], v[28:31], v[16:19]
    s_waitcnt lgkmcnt(2)
    v_mfma_f32_16x16x32_bf16 v[16:19], v[40:43], v[36:39], v[16:19]
    s_waitcnt lgkmcnt(0)
    v_mfma_f32_16x16x32_bf16 v[16:19], v[48:51], v[44:47], v[16:19]
    s_waitcnt vmcnt(0)
    s_barrier
    ds_read_b128 v[20:23], v5 offset:0
    ds_read_b128 v[24:27], v6 offset:0
    ds_read_b128 v[28:31], v5 offset:1024
    ds_read_b128 v[32:35], v6 offset:1024
    ds_read_b128 v[36:39], v5 offset:2048
    ds_read_b128 v[40:43], v6 offset:2048
    ds_read_b128 v[44:47], v5 offset:3072
    ds_read_b128 v[48:51], v6 offset:3072
    s_waitcnt lgkmcnt(6)
    v_mfma_f32_16x16x32_bf16 v[16:19], v[24:27], v[20:23], v[16:19]
    s_waitcnt lgkmcnt(4)
    v_mfma_f32_16x16x32_bf16 v[16:19], v[32:35], v[28:31], v[16:19]
    s_waitcnt lgkmcnt(2)
    v_mfma_f32_16x16x32_bf16 v[16:19], v[40:43], v[36:39], v[16:19]
    s_waitcnt lgkmcnt(0)
    v_mfma_f32_16x16x32_bf16 v[16:19], v[48:51], v[44:47], v[16:19]
    s_nop 9
    s_load_dwordx2 s[16:17], s[0:1], 88
    s_waitcnt lgkmcnt(0)
    s_and_b32 s17, s17, 0xffff
    s_mov_b32 s18, 2097152
    s_mov_b32 s19, 0x00020000
    v_lshlrev_b32 v5, 10, v2
    v_lshl_add_u32 v5, v3, 3, v5
    s_mul_i32 s60, s23, 1
    s_add_u32 s60, s60, s21
    s_lshl_b32 s60, s60, 14
    s_mul_i32 s61, s24, 1
    s_add_u32 s61, s61, s22
    s_lshl_b32 s61, s61, 5
    s_add_u32 s60, s60, s61
    s_add_u32 s61, s60, 109051904
    buffer_load_dwordx2 v[52:53], v5, s[8:11], s61 offen sc1
    s_waitcnt vmcnt(0)
    v_lshlrev_b32 v54, 16, v52
    v_and_b32 v55, 0xffff0000, v52
    v_add_f32 v16, v16, v54
    v_add_f32 v17, v17, v55
    v_lshlrev_b32 v54, 16, v53
    v_and_b32 v55, 0xffff0000, v53
    v_add_f32 v18, v18, v54
    v_add_f32 v19, v19, v55
    v_cvt_pk_bf16_f32 v16, v16, v17
    v_cvt_pk_bf16_f32 v17, v18, v19
    s_add_u32 s61, s60, 0
    buffer_store_dwordx2 v[16:17], v5, s[16:19], s61 offen
L_down_fin_113:
L_next2_88:
    s_add_u32 s90, s90, 224
    s_branch L_task2_87
L_fused_done_1:
    s_endpgm
.section .rodata,"a"
.p2align 6
.amdhsa_kernel fused_kernel
  .amdhsa_next_free_vgpr 512
  .amdhsa_next_free_sgpr 102
  .amdhsa_accum_offset 256
  .amdhsa_group_segment_fixed_size 0
  .amdhsa_kernarg_size 112
  .amdhsa_user_sgpr_count 2
  .amdhsa_user_sgpr_kernarg_segment_ptr 1
  .amdhsa_system_sgpr_workgroup_id_x 1
.end_amdhsa_kernel
```
